```python
import torch

def _softmax(x, axis=-1):
    return torch.softmax(x, dim=axis)
def _gelu(x):
    return torch.nn.functional.gelu(x, approximate="tanh")
def _silu(x):
    return torch.nn.functional.silu(x)
def _sigmoid(x):
    return torch.sigmoid(x)
def _layernorm(x, axis=-1, eps=1e-5):
    m = x.mean(dim=axis, keepdim=True)
    v = x.var(dim=axis, keepdim=True, unbiased=False)
    return (x - m) / torch.sqrt(v + eps)
def _scatter_add(tgt, idx, src, axis=0):
    return tgt.clone().index_add_(axis, idx, src)
def _segment_sum(src, seg, n):
    out = torch.zeros((n,) + src.shape[1:], dtype=src.dtype)
    return out.index_add_(0, seg, src)
def _pad(x, pw):
    flat = tuple(v for pair in reversed(pw) for v in pair)
    return torch.nn.functional.pad(x, flat)

kernel_name = 'interleave_layers__ssm_conv_h3__glu_gated_reglu__prompt'

def setup_inputs():

    _w = (lambda a: (lambda t: t.to(torch.bfloat16) if t.is_floating_point() else t)(torch.as_tensor(a)))
    def _A_setup():
        B, S, D = 1, 2048, 448
        ks = 4
        return {
            "q": _w((lambda *s: torch.randn(*s, dtype=torch.bfloat16) * 0.05)(B, S, D)),
            "k": _w((lambda *s: torch.randn(*s, dtype=torch.bfloat16) * 0.2)(B, S, D)),
            "v": _w((lambda *s: torch.randn(*s, dtype=torch.bfloat16) * 0.2)(B, S, D)),
            "shift_k": _w((lambda *s: torch.randn(*s, dtype=torch.bfloat16) * 0.2)(D, ks) * 0.5),
            "ssm_k": _w((lambda *s: torch.randn(*s, dtype=torch.bfloat16) * 0.2)(D, S) * (1.0 / S ** 0.5)),
            "ssm_D": _w((lambda *s: torch.randn(*s, dtype=torch.bfloat16) * 0.2)(D)),
        }
    _A_in = _A_setup()

    def _B_setup():
        B, S, D, F = 1, 2048, 448, 1792
        return {
            "x": _w((lambda *s: torch.randn(*s, dtype=torch.bfloat16) * 0.05)(B, S, D)),
            "W_gate": _w((lambda *s: torch.randn(*s, dtype=torch.bfloat16) * 0.2)(D, F) * (2.0 / D) ** 0.5),
            "W_up": _w((lambda *s: torch.randn(*s, dtype=torch.bfloat16) * 0.2)(D, F) * (2.0 / D) ** 0.5),
            "W_down": _w((lambda *s: torch.randn(*s, dtype=torch.bfloat16) * 0.2)(F, D) * (1.0 / F) ** 0.5),
        }
    _B_in = _B_setup()

    return {
        "A_q": _A_in["q"],
        "A_k": _A_in["k"],
        "A_v": _A_in["v"],
        "A_shift_k": _A_in["shift_k"],
        "A_ssm_k": _A_in["ssm_k"],
        "A_ssm_D": _A_in["ssm_D"],
        "B_x": _B_in["x"],
        "B_W_gate": _B_in["W_gate"],
        "B_W_up": _B_in["W_up"],
        "B_W_down": _B_in["W_down"],
    }

def reference(A_q, A_k, A_v, A_shift_k, A_ssm_k, A_ssm_D, B_x, B_W_gate, B_W_up, B_W_down):
    def _A_ref(q, k, v, shift_k, ssm_k, ssm_D):
        B, S, D = q.shape
        ks = shift_k.shape[-1]
        k_pad = _pad(k, ((0, 0), (ks - 1, 0), (0, 0)))
        k_shift = torch.zeros_like(k)
        for t in range(ks):
            k_shift = k_shift + k_pad[:, t:t + S, :] * shift_k[:, ks - 1 - t][None, None, :]
        kv = k_shift * v
        L = 2 * S
        kv_pad = _pad(kv, ((0, 0), (0, S), (0, 0)))
        kf_pad = _pad(ssm_k, ((0, 0), (0, S)))
        kv_f = (lambda x, axes=(-2,-1): torch.fft.rfft2(x.float(), dim=axes))(kv_pad[:, None, :, :], axes=(1, 2))
        kf_f = (lambda x, axes=(-2,-1): torch.fft.rfft2(x.float(), dim=axes))(kf_pad[:, None, :], axes=(1, 2))
        kf_f = (lambda x, *d: x.permute(*d))(kf_f, 1, 2, 0)
        y_f = kv_f * kf_f[None, :, :, :]
        y = (lambda x, s, axes=(-2,-1): torch.fft.irfft2(x, s=s, dim=axes).to(torch.bfloat16))(y_f, (1, L), axes=(1, 2))[:, 0, :S, :]
        y = y + kv * ssm_D[None, None, :]
        return q * y

    def _B_ref(x, W_gate, W_up, W_down):
        gate = torch.einsum("bsd,df->bsf", x, W_gate)
        up = torch.einsum("bsd,df->bsf", x, W_up)
        gate = gate * (lambda x, dt: x.to(dt))(gate > 0, gate.dtype)
        h = gate * up
        return torch.einsum("bsf,fd->bsd", h, W_down)

    x = A_q
    x = x + _A_ref(_layernorm(x, axis=-1), A_k, A_v, A_shift_k, A_ssm_k, A_ssm_D)
    x = x + _B_ref(_layernorm(x, axis=-1), B_W_gate, B_W_up, B_W_down)
    x = x + _A_ref(_layernorm(x, axis=-1), A_k, A_v, A_shift_k, A_ssm_k, A_ssm_D)
    x = x + _B_ref(_layernorm(x, axis=-1), B_W_gate, B_W_up, B_W_down)
    return x
```

```asm
; @launch kernel=prep_kernel grid=(256,1,1) block=(512,1,1) lds=32768
; @launch kernel=main_kernel grid=(256,1,1) block=(256,1,1) lds=163840
.amdgcn_target "amdgcn-amd-amdhsa--gfx950"
.text
.globl prep_kernel
.p2align 8
.type prep_kernel,@function
prep_kernel:
    s_cmp_ge_u32 s2, 256
    s_cbranch_scc1 L_end0
    s_load_dwordx2 s[44:45], s[0:1], 96
    s_load_dwordx8 s[4:11], s[0:1], 0
    s_load_dwordx4 s[12:15], s[0:1], 32
    s_load_dwordx4 s[96:99], s[0:1], 56
    s_load_dwordx4 s[60:63], s[0:1], 72
    v_lshrrev_b32 v1, 6, v0
    v_and_b32 v0, 63, v0
    v_readfirstlane_b32 s59, v1
    v_lshlrev_b32 v1, 4, v0
    s_and_b32 s3, s59, 3
    s_mov_b32 s43, s59
    s_and_b32 s64, s2, 7
    s_lshr_b32 s65, s2, 3
    s_and_b32 s49, s65, 15
    s_lshr_b32 s65, s65, 4
    s_lshl_b32 s66, s64, 1
    s_add_u32 s66, s66, s65
    s_lshl_b32 s48, s66, 2
    s_add_u32 s48, s48, s3
    s_cmp_ge_u32 s49, 7
    s_cselect_b32 s65, 1, 0
    s_mul_i32 s64, s65, 7
    s_sub_u32 s51, s49, s64
    s_lshl_b32 s50, s66, 1
    s_add_u32 s50, s50, s65
    s_lshl_b32 s50, s50, 1
    s_lshr_b32 s52, s3, 1
    s_add_u32 s52, s52, s50
    s_and_b32 s53, s3, 1
    s_lshl_b32 s64, s51, 1
    s_add_u32 s53, s53, s64
    s_mul_i32 s54, s52, 28672
    s_lshl_b32 s64, s53, 9
    s_add_u32 s54, s54, s64
    s_lshl_b32 s55, s3, 12
    s_mov_b32 s56, 0x3f803f80
    s_mov_b32 s57, 0xffff0000
    s_mul_i32 s58, s66, 14
    s_add_u32 s58, s58, s49
    s_mov_b32 s18, 0x1c0000
    s_mov_b32 s19, 0x00020000
    s_mov_b32 s22, 0x1c0000
    s_mov_b32 s23, 0x00020000
    s_mov_b32 s26, 0x1c0000
    s_mov_b32 s27, 0x00020000
    s_mov_b32 s30, 0xe00
    s_mov_b32 s31, 0x00020000
    s_mov_b32 s34, 0x1c0000
    s_mov_b32 s35, 0x00020000
    s_mov_b32 s38, 0x188000
    s_mov_b32 s39, 0x00020000
    s_mov_b32 s46, 0x13e0000
    s_mov_b32 s47, 0x00020000
    s_mov_b32 s70, 0x1c0000
    s_mov_b32 s71, 0x00020000
    v_and_b32 v12, 7, v0
    v_lshrrev_b32 v13, 3, v0
    v_mov_b32 v234, 0
    v_and_b32 v124, 3, v0
    v_lshrrev_b32 v125, 2, v0
    s_waitcnt lgkmcnt(0)
    s_mov_b32 s42, 1
    s_mov_b64 s[16:17], s[4:5]
    s_mov_b64 s[20:21], s[6:7]
    s_mov_b64 s[24:25], s[8:9]
    s_mov_b64 s[28:29], s[10:11]
    s_mov_b64 s[32:33], s[12:13]
    s_mov_b64 s[40:41], s[14:15]
    s_mov_b64 s[100:101], s[60:61]
    s_mov_b64 s[68:69], s[62:63]
    s_cmp_ge_u32 s59, 4
    s_cbranch_scc1 L_p_help
    s_cmp_ge_u32 s49, 14
    s_cbranch_scc1 L_end0
    s_mov_b32 s6, 0x24924925
    s_mul_hi_u32 s4, s58, s6
    s_mul_i32 s6, s4, 7
    s_sub_u32 s5, s58, s6
    s_lshl_b32 s6, s4, 6
    s_lshl_b32 s7, s3, 4
    s_add_u32 s6, s6, s7
    v_lshrrev_b32 v2, 5, v0
    v_lshl_add_u32 v3, v2, 3, s6
    v_and_b32 v4, 31, v0
    v_mul_u32_u24 v3, 896, v3
    s_lshl_b32 s7, s5, 7
    v_lshl_add_u32 v3, v4, 2, v3
    v_add_u32 v3, s7, v3
    v_subrev_u32 v5, 2688, v3
    s_movk_i32 s8, 3584
    s_lshl_b32 s9, s5, 9
    v_lshlrev_b32 v6, 4, v4
    buffer_load_dwordx4 v[36:39], v6, s[28:31], s9 offen
    buffer_load_dword v16, v5, s[20:23], 0 offen offset:0
    buffer_load_dword v17, v5, s[20:23], 0 offen offset:896
    buffer_load_dword v18, v5, s[20:23], 0 offen offset:1792
    buffer_load_dword v19, v3, s[20:23], 0 offen offset:0
    buffer_load_dword v28, v3, s[24:27], 0 offen offset:0
    buffer_load_dword v20, v3, s[20:23], 0 offen offset:896
    buffer_load_dword v29, v3, s[24:27], 0 offen offset:896
    buffer_load_dword v21, v3, s[20:23], 0 offen offset:1792
    buffer_load_dword v30, v3, s[24:27], 0 offen offset:1792
    buffer_load_dword v22, v3, s[20:23], 0 offen offset:2688
    buffer_load_dword v31, v3, s[24:27], 0 offen offset:2688
    buffer_load_dword v23, v3, s[20:23], s8 offen offset:0
    buffer_load_dword v32, v3, s[24:27], s8 offen offset:0
    buffer_load_dword v24, v3, s[20:23], s8 offen offset:896
    buffer_load_dword v33, v3, s[24:27], s8 offen offset:896
    buffer_load_dword v25, v3, s[20:23], s8 offen offset:1792
    buffer_load_dword v34, v3, s[24:27], s8 offen offset:1792
    buffer_load_dword v26, v3, s[20:23], s8 offen offset:2688
    buffer_load_dword v35, v3, s[24:27], s8 offen offset:2688
    s_waitcnt vmcnt(19)
    v_lshlrev_b32 v40, 16, v36
    v_and_b32 v41, s57, v36
    v_lshlrev_b32 v42, 16, v37
    v_and_b32 v43, s57, v37
    v_lshlrev_b32 v44, 16, v38
    v_and_b32 v45, s57, v38
    v_lshlrev_b32 v46, 16, v39
    v_and_b32 v47, s57, v39
    s_waitcnt vmcnt(18)
    v_lshlrev_b32 v48, 16, v16
    v_and_b32 v59, s57, v16
    s_waitcnt vmcnt(17)
    v_lshlrev_b32 v49, 16, v17
    v_and_b32 v60, s57, v17
    s_waitcnt vmcnt(16)
    v_lshlrev_b32 v50, 16, v18
    v_and_b32 v61, s57, v18
    s_waitcnt vmcnt(15)
    v_lshlrev_b32 v51, 16, v19
    v_and_b32 v62, s57, v19
    s_waitcnt vmcnt(13)
    v_lshlrev_b32 v52, 16, v20
    v_and_b32 v63, s57, v20
    s_waitcnt vmcnt(11)
    v_lshlrev_b32 v53, 16, v21
    v_and_b32 v64, s57, v21
    s_waitcnt vmcnt(9)
    v_lshlrev_b32 v54, 16, v22
    v_and_b32 v65, s57, v22
    s_waitcnt vmcnt(7)
    v_lshlrev_b32 v55, 16, v23
    v_and_b32 v66, s57, v23
    s_waitcnt vmcnt(5)
    v_lshlrev_b32 v56, 16, v24
    v_and_b32 v67, s57, v24
    s_waitcnt vmcnt(3)
    v_lshlrev_b32 v57, 16, v25
    v_and_b32 v68, s57, v25
    s_waitcnt vmcnt(1)
    v_lshlrev_b32 v58, 16, v26
    v_and_b32 v69, s57, v26
    v_mul_f32 v72, v43, v48
    v_fmac_f32 v72, v42, v49
    v_fmac_f32 v72, v41, v50
    v_fmac_f32 v72, v40, v51
    v_mul_f32 v73, v43, v49
    v_fmac_f32 v73, v42, v50
    v_fmac_f32 v73, v41, v51
    v_fmac_f32 v73, v40, v52
    v_mul_f32 v74, v43, v50
    v_fmac_f32 v74, v42, v51
    v_fmac_f32 v74, v41, v52
    v_fmac_f32 v74, v40, v53
    v_mul_f32 v75, v43, v51
    v_fmac_f32 v75, v42, v52
    v_fmac_f32 v75, v41, v53
    v_fmac_f32 v75, v40, v54
    v_mul_f32 v76, v43, v52
    v_fmac_f32 v76, v42, v53
    v_fmac_f32 v76, v41, v54
    v_fmac_f32 v76, v40, v55
    v_mul_f32 v77, v43, v53
    v_fmac_f32 v77, v42, v54
    v_fmac_f32 v77, v41, v55
    v_fmac_f32 v77, v40, v56
    v_mul_f32 v78, v43, v54
    v_fmac_f32 v78, v42, v55
    v_fmac_f32 v78, v41, v56
    v_fmac_f32 v78, v40, v57
    v_mul_f32 v79, v43, v55
    v_fmac_f32 v79, v42, v56
    v_fmac_f32 v79, v41, v57
    v_fmac_f32 v79, v40, v58
    v_mul_f32 v80, v47, v59
    v_fmac_f32 v80, v46, v60
    v_fmac_f32 v80, v45, v61
    v_fmac_f32 v80, v44, v62
    v_mul_f32 v81, v47, v60
    v_fmac_f32 v81, v46, v61
    v_fmac_f32 v81, v45, v62
    v_fmac_f32 v81, v44, v63
    v_mul_f32 v82, v47, v61
    v_fmac_f32 v82, v46, v62
    v_fmac_f32 v82, v45, v63
    v_fmac_f32 v82, v44, v64
    v_mul_f32 v83, v47, v62
    v_fmac_f32 v83, v46, v63
    v_fmac_f32 v83, v45, v64
    v_fmac_f32 v83, v44, v65
    v_mul_f32 v84, v47, v63
    v_fmac_f32 v84, v46, v64
    v_fmac_f32 v84, v45, v65
    v_fmac_f32 v84, v44, v66
    v_mul_f32 v85, v47, v64
    v_fmac_f32 v85, v46, v65
    v_fmac_f32 v85, v45, v66
    v_fmac_f32 v85, v44, v67
    v_mul_f32 v86, v47, v65
    v_fmac_f32 v86, v46, v66
    v_fmac_f32 v86, v45, v67
    v_fmac_f32 v86, v44, v68
    v_mul_f32 v87, v47, v66
    v_fmac_f32 v87, v46, v67
    v_fmac_f32 v87, v45, v68
    v_fmac_f32 v87, v44, v69
    v_lshlrev_b32 v5, 16, v28
    v_and_b32 v6, s57, v28
    v_mul_f32 v72, v72, v5
    v_mul_f32 v80, v80, v6
    v_lshlrev_b32 v5, 16, v29
    v_and_b32 v6, s57, v29
    v_mul_f32 v73, v73, v5
    v_mul_f32 v81, v81, v6
    v_lshlrev_b32 v5, 16, v30
    v_and_b32 v6, s57, v30
    v_mul_f32 v74, v74, v5
    v_mul_f32 v82, v82, v6
    v_lshlrev_b32 v5, 16, v31
    v_and_b32 v6, s57, v31
    v_mul_f32 v75, v75, v5
    v_mul_f32 v83, v83, v6
    v_lshlrev_b32 v5, 16, v32
    v_and_b32 v6, s57, v32
    v_mul_f32 v76, v76, v5
    v_mul_f32 v84, v84, v6
    v_lshlrev_b32 v5, 16, v33
    v_and_b32 v6, s57, v33
    v_mul_f32 v77, v77, v5
    v_mul_f32 v85, v85, v6
    v_lshlrev_b32 v5, 16, v34
    v_and_b32 v6, s57, v34
    v_mul_f32 v78, v78, v5
    v_mul_f32 v86, v86, v6
    s_waitcnt vmcnt(0)
    v_lshlrev_b32 v5, 16, v35
    v_and_b32 v6, s57, v35
    v_mul_f32 v79, v79, v5
    v_mul_f32 v87, v87, v6
    v_cvt_pk_bf16_f32 v88, v79, v78
    v_cvt_pk_bf16_f32 v89, v77, v76
    v_cvt_pk_bf16_f32 v90, v75, v74
    v_cvt_pk_bf16_f32 v91, v73, v72
    v_cvt_pk_bf16_f32 v92, v87, v86
    v_cvt_pk_bf16_f32 v93, v85, v84
    v_cvt_pk_bf16_f32 v94, v83, v82
    v_cvt_pk_bf16_f32 v95, v81, v80
    s_lshl_b32 s10, s3, 5
    s_sub_u32 s10, 112, s10
    v_lshlrev_b32 v5, 8, v4
    v_lshlrev_b32 v6, 4, v2
    v_sub_u32 v5, v5, v6
    v_add_u32 v5, s10, v5
    ds_write_b128 v5, v[88:91]
    ds_write_b128 v5, v[92:95] offset:128
    s_waitcnt lgkmcnt(0)
    s_barrier
    s_lshl_b32 s10, s3, 11
    v_add_u32 v5, s10, v1
    ds_read_b128 v[16:19], v5
    ds_read_b128 v[20:23], v5 offset:1024
    s_lshl_b32 s10, s5, 18
    s_lshl_b32 s11, s3, 16
    s_add_u32 s10, s10, s11
    s_lshl_b32 s11, s4, 7
    s_sub_u32 s10, s10, s11
    s_add_u32 s10, s10, 1183616
    s_add_u32 s11, s10, 32768
    v_lshlrev_b32 v6, 12, v13
    v_lshl_add_u32 v6, v12, 4, v6
    s_waitcnt lgkmcnt(1)
    buffer_store_dwordx4 v[16:19], v6, s[44:47], s10 offen
    s_waitcnt lgkmcnt(0)
    buffer_store_dwordx4 v[20:23], v6, s[44:47], s11 offen
    s_endpgm
L_p_help:
    s_cmp_eq_u32 s3, 3
    s_cbranch_scc1 L_p_clr
    s_lshl_b32 s72, s2, 1
    s_add_u32 s72, s72, s3
    s_add_u32 s10, s2, 448
    s_cmp_eq_u32 s3, 2
    s_cselect_b32 s72, s10, s72
    s_cmp_ge_u32 s2, 224
    s_cbranch_scc1 L_end0
    v_cmp_gt_u32 vcc, 14, v125
    v_mov_b32 v127, 0x7ff00000
    s_cmp_ge_u32 s72, 448
    s_cbranch_scc1 L_wi0_d
    s_lshr_b32 s10, s72, 1
    s_mov_b32 s11, 0x9249250
    s_mul_hi_u32 s12, s10, s11
    s_mul_i32 s11, s12, 28
    s_sub_u32 s10, s10, s11
    s_lshl_b32 s10, s10, 1
    s_and_b32 s11, s72, 1
    s_add_u32 s13, s10, s11
    s_and_b32 s14, s12, 3
    s_lshr_b32 s15, s12, 2
    s_cmp_eq_u32 s15, 0
    s_cselect_b32 s36, s96, s98
    s_cselect_b32 s37, s97, s99
    s_mul_i32 s10, s14, 112*3584
    s_lshl_b32 s11, s13, 6
    s_add_u32 s10, s10, s11
    v_mul_u32_u24 v126, 8*3584, v125
    v_lshl_add_u32 v126, v124, 4, v126
    v_cndmask_b32 v126, v127, v126, vcc
    buffer_load_dwordx4 v[128:131], v126, s[36:39], s10 offen
    s_add_u32 s10, s10, 3584
    buffer_load_dwordx4 v[132:135], v126, s[36:39], s10 offen
    s_add_u32 s10, s10, 3584
    buffer_load_dwordx4 v[136:139], v126, s[36:39], s10 offen
    s_add_u32 s10, s10, 3584
    buffer_load_dwordx4 v[140:143], v126, s[36:39], s10 offen
    s_add_u32 s10, s10, 3584
    buffer_load_dwordx4 v[144:147], v126, s[36:39], s10 offen
    s_add_u32 s10, s10, 3584
    buffer_load_dwordx4 v[148:151], v126, s[36:39], s10 offen
    s_add_u32 s10, s10, 3584
    buffer_load_dwordx4 v[152:155], v126, s[36:39], s10 offen
    s_add_u32 s10, s10, 3584
    buffer_load_dwordx4 v[156:159], v126, s[36:39], s10 offen
    s_branch L_wi0_j
L_wi0_d:
    s_sub_u32 s10, s72, 448
    s_and_b32 s15, s10, 1
    s_lshr_b32 s10, s10, 1
    s_mov_b32 s11, 0x24924925
    s_mul_hi_u32 s14, s10, s11
    s_mul_i32 s11, s14, 7
    s_sub_u32 s13, s10, s11
    s_mov_b64 s[36:37], s[100:101]
    s_mul_i32 s10, s14, 112*896
    s_lshl_b32 s11, s13, 7
    s_add_u32 s10, s10, s11
    s_lshl_b32 s11, s15, 6
    s_add_u32 s10, s10, s11
    v_mul_u32_u24 v126, 8*896, v125
    v_lshl_add_u32 v126, v124, 4, v126
    v_cndmask_b32 v126, v127, v126, vcc
    buffer_load_dwordx4 v[128:131], v126, s[36:39], s10 offen
    s_add_u32 s10, s10, 896
    buffer_load_dwordx4 v[132:135], v126, s[36:39], s10 offen
    s_add_u32 s10, s10, 896
    buffer_load_dwordx4 v[136:139], v126, s[36:39], s10 offen
    s_add_u32 s10, s10, 896
    buffer_load_dwordx4 v[140:143], v126, s[36:39], s10 offen
    s_add_u32 s10, s10, 896
    buffer_load_dwordx4 v[144:147], v126, s[36:39], s10 offen
    s_add_u32 s10, s10, 896
    buffer_load_dwordx4 v[148:151], v126, s[36:39], s10 offen
    s_add_u32 s10, s10, 896
    buffer_load_dwordx4 v[152:155], v126, s[36:39], s10 offen
    s_add_u32 s10, s10, 896
    buffer_load_dwordx4 v[156:159], v126, s[36:39], s10 offen
L_wi0_j:
    s_barrier
    s_cmp_ge_u32 s72, 672
    s_cbranch_scc1 L_wp0_done
    s_mov_b32 s10, 0x05040100
    s_mov_b32 s11, 0x07060302
    s_waitcnt vmcnt(6)
    v_perm_b32 v200, v132, v128, s10
    s_waitcnt vmcnt(4)
    v_perm_b32 v201, v140, v136, s10
    s_waitcnt vmcnt(2)
    v_perm_b32 v202, v148, v144, s10
    s_waitcnt vmcnt(0)
    v_perm_b32 v203, v156, v152, s10
    v_perm_b32 v204, v132, v128, s11
    v_perm_b32 v205, v140, v136, s11
    v_perm_b32 v206, v148, v144, s11
    v_perm_b32 v207, v156, v152, s11
    v_perm_b32 v208, v133, v129, s10
    v_perm_b32 v209, v141, v137, s10
    v_perm_b32 v210, v149, v145, s10
    v_perm_b32 v211, v157, v153, s10
    v_perm_b32 v212, v133, v129, s11
    v_perm_b32 v213, v141, v137, s11
    v_perm_b32 v214, v149, v145, s11
    v_perm_b32 v215, v157, v153, s11
    v_perm_b32 v216, v134, v130, s10
    v_perm_b32 v217, v142, v138, s10
    v_perm_b32 v218, v150, v146, s10
    v_perm_b32 v219, v158, v154, s10
    v_perm_b32 v220, v134, v130, s11
    v_perm_b32 v221, v142, v138, s11
    v_perm_b32 v222, v150, v146, s11
    v_perm_b32 v223, v158, v154, s11
    v_perm_b32 v224, v135, v131, s10
    v_perm_b32 v225, v143, v139, s10
    v_perm_b32 v226, v151, v147, s10
    v_perm_b32 v227, v159, v155, s10
    v_perm_b32 v228, v135, v131, s11
    v_perm_b32 v229, v143, v139, s11
    v_perm_b32 v230, v151, v147, s11
    v_perm_b32 v231, v159, v155, s11
    s_lshl_b32 s59, s3, 13
    s_add_u32 s59, s59, 8192
    v_add_u32 v20, s59, v1
    s_cmp_ge_u32 s72, 448
    s_cbranch_scc1 L_wp0_d
    s_lshr_b32 s10, s72, 1
    s_mov_b32 s11, 0x9249250
    s_mul_hi_u32 s12, s10, s11
    s_mul_i32 s11, s12, 28
    s_sub_u32 s10, s10, s11
    s_lshl_b32 s10, s10, 1
    s_and_b32 s11, s72, 1
    s_add_u32 s13, s10, s11
    s_and_b32 s14, s12, 3
    s_lshr_b32 s15, s12, 2
    v_lshrrev_b32 v16, 1, v125
    v_lshlrev_b32 v16, 10, v16
    v_lshrrev_b32 v17, 1, v124
    v_lshl_add_u32 v16, v17, 9, v16
    v_and_b32 v17, 1, v125
    v_lshl_add_u32 v16, v17, 8, v16
    v_and_b32 v17, 1, v124
    v_lshl_add_u32 v16, v17, 6, v16
    v_add_u32 v16, s59, v16
    ds_write_b128 v16, v[200:203] offset:0
    ds_write_b128 v16, v[204:207] offset:16
    ds_write_b128 v16, v[208:211] offset:32
    ds_write_b128 v16, v[212:215] offset:48
    ds_write_b128 v16, v[216:219] offset:128
    ds_write_b128 v16, v[220:223] offset:144
    ds_write_b128 v16, v[224:227] offset:160
    ds_write_b128 v16, v[228:231] offset:176
    ds_read_b128 v[128:131], v20 offset:0
    ds_read_b128 v[132:135], v20 offset:1024
    ds_read_b128 v[136:139], v20 offset:2048
    ds_read_b128 v[140:143], v20 offset:3072
    ds_read_b128 v[144:147], v20 offset:4096
    ds_read_b128 v[148:151], v20 offset:5120
    ds_read_b128 v[152:155], v20 offset:6144
    s_lshl_b32 s59, s13, 3
    s_add_u32 s59, s59, s12
    s_lshl_b32 s59, s59, 2
    s_add_u32 s59, s59, 12288
    s_lshl_b32 s10, s13, 1
    s_mov_b32 s60, 0x24924925
    s_mul_hi_u32 s11, s10, s60
    s_mul_i32 s60, s11, 7
    s_sub_u32 s12, s10, s60
    s_mul_i32 s11, s11, 203
    s_add_u32 s11, s11, s12
    s_mov_b32 s10, 0
    s_mov_b32 s62, 3
    s_cmp_ge_u32 s12, 3
    s_cselect_b32 s10, 84, s10
    s_cselect_b32 s62, 2, s62
    s_cmp_ge_u32 s12, 5
    s_cselect_b32 s10, 140, s10
    s_cselect_b32 s62, 2, s62
    s_add_u32 s11, s11, s10
    s_lshl_b32 s61, s11, 10
    s_lshl_b32 s62, s62, 10
    s_lshl_b32 s10, s13, 1
    s_add_u32 s10, s10, 1
    s_mov_b32 s60, 0x24924925
    s_mul_hi_u32 s11, s10, s60
    s_mul_i32 s60, s11, 7
    s_sub_u32 s12, s10, s60
    s_mul_i32 s11, s11, 203
    s_add_u32 s11, s11, s12
    s_mov_b32 s10, 0
    s_mov_b32 s64, 3
    s_cmp_ge_u32 s12, 3
    s_cselect_b32 s10, 84, s10
    s_cselect_b32 s64, 2, s64
    s_cmp_ge_u32 s12, 5
    s_cselect_b32 s10, 140, s10
    s_cselect_b32 s64, 2, s64
    s_add_u32 s11, s11, s10
    s_lshl_b32 s63, s11, 10
    s_lshl_b32 s64, s64, 10
    v_cmp_lt_u32 vcc, 31, v0
    v_mov_b32 v17, s61
    v_mov_b32 v18, s63
    v_cndmask_b32 v17, v17, v18, vcc
    v_mov_b32 v18, s62
    v_mov_b32 v19, s64
    v_cndmask_b32 v18, v18, v19, vcc
    s_mul_i32 s10, s14, 7
    v_mul_lo_u32 v19, s10, v18
    v_add_u32 v17, v17, v19
    v_bfe_u32 v19, v0, 4, 1
    v_lshl_add_u32 v17, v19, 9, v17
    v_and_b32 v19, 15, v0
    v_lshl_add_u32 v17, v19, 4, v17
    s_lshl_b32 s10, s15, 8
    s_add_u32 s10, s10, 8323072
    v_lshrrev_b32 v19, 5, v0
    v_and_b32 v21, 31, v0
    v_cmp_eq_u32 vcc, v19, v21
    v_mov_b32 v22, s56
    s_nop 0
    v_cndmask_b32 v24, 0, v22, vcc
    v_mov_b32 v25, v24
    v_mov_b32 v26, v24
    v_mov_b32 v27, v24
    s_waitcnt lgkmcnt(6)
    buffer_store_dwordx4 v[128:131], v17, s[44:47], s10 offen
    v_add_u32 v17, v17, v18
    v_mfma_f32_32x32x16_bf16 v[200:215], v[128:131], v[24:27], 0
    s_waitcnt lgkmcnt(5)
    buffer_store_dwordx4 v[132:135], v17, s[44:47], s10 offen
    v_add_u32 v17, v17, v18
    v_mfma_f32_32x32x16_bf16 v[200:215], v[132:135], v[24:27], v[200:215]
    s_waitcnt lgkmcnt(4)
    buffer_store_dwordx4 v[136:139], v17, s[44:47], s10 offen
    v_add_u32 v17, v17, v18
    v_mfma_f32_32x32x16_bf16 v[200:215], v[136:139], v[24:27], v[200:215]
    s_waitcnt lgkmcnt(3)
    buffer_store_dwordx4 v[140:143], v17, s[44:47], s10 offen
    v_add_u32 v17, v17, v18
    v_mfma_f32_32x32x16_bf16 v[200:215], v[140:143], v[24:27], v[200:215]
    s_waitcnt lgkmcnt(2)
    buffer_store_dwordx4 v[144:147], v17, s[44:47], s10 offen
    v_add_u32 v17, v17, v18
    v_mfma_f32_32x32x16_bf16 v[200:215], v[144:147], v[24:27], v[200:215]
    s_waitcnt lgkmcnt(1)
    buffer_store_dwordx4 v[148:151], v17, s[44:47], s10 offen
    v_add_u32 v17, v17, v18
    v_mfma_f32_32x32x16_bf16 v[200:215], v[148:151], v[24:27], v[200:215]
    s_waitcnt lgkmcnt(0)
    buffer_store_dwordx4 v[152:155], v17, s[44:47], s10 offen
    v_mfma_f32_32x32x16_bf16 v[200:215], v[152:155], v[24:27], v[200:215]
    s_mul_i32 s11, s62, 28
    s_add_u32 s11, s11, s61
    s_mul_i32 s12, s64, 28
    s_add_u32 s12, s12, s63
    v_cmp_eq_u32 vcc, 1, v21
    v_mov_b32 v17, s11
    v_mov_b32 v18, s12
    v_cndmask_b32 v17, v17, v18, vcc
    v_lshl_add_u32 v17, v19, 6, v17
    s_lshr_b32 s11, s14, 1
    s_lshl_b32 s11, s11, 9
    s_and_b32 s12, s14, 1
    s_lshl_b32 s12, s12, 3
    s_add_u32 s10, s10, s11
    s_add_u32 s10, s10, s12
    v_add_f32 v200, v200, v208
    v_add_f32 v201, v201, v209
    v_add_f32 v202, v202, v210
    v_add_f32 v203, v203, v211
    v_add_f32 v204, v204, v212
    v_add_f32 v205, v205, v213
    v_add_f32 v206, v206, v214
    v_add_f32 v207, v207, v215
    v_cvt_pk_bf16_f32 v208, v200, v200
    v_cvt_pk_bf16_f32 v209, v201, v201
    v_cvt_pk_bf16_f32 v210, v202, v202
    v_cvt_pk_bf16_f32 v211, v203, v203
    v_cvt_pk_bf16_f32 v212, v204, v204
    v_cvt_pk_bf16_f32 v213, v205, v205
    v_cvt_pk_bf16_f32 v214, v206, v206
    v_cvt_pk_bf16_f32 v215, v207, v207
    v_lshlrev_b32 v208, 16, v208
    v_lshlrev_b32 v209, 16, v209
    v_lshlrev_b32 v210, 16, v210
    v_lshlrev_b32 v211, 16, v211
    v_lshlrev_b32 v212, 16, v212
    v_lshlrev_b32 v213, 16, v213
    v_lshlrev_b32 v214, 16, v214
    v_lshlrev_b32 v215, 16, v215
    v_sub_f32 v200, v200, v208
    v_sub_f32 v201, v201, v209
    v_sub_f32 v202, v202, v210
    v_sub_f32 v203, v203, v211
    v_sub_f32 v204, v204, v212
    v_sub_f32 v205, v205, v213
    v_sub_f32 v206, v206, v214
    v_sub_f32 v207, v207, v215
    v_cvt_pk_bf16_f32 v216, v208, v200
    v_mov_b32 v217, v216
    v_cvt_pk_bf16_f32 v218, v209, v201
    v_mov_b32 v219, v218
    v_cvt_pk_bf16_f32 v220, v210, v202
    v_mov_b32 v221, v220
    v_cvt_pk_bf16_f32 v222, v211, v203
    v_mov_b32 v223, v222
    v_cvt_pk_bf16_f32 v224, v212, v204
    v_mov_b32 v225, v224
    v_cvt_pk_bf16_f32 v226, v213, v205
    v_mov_b32 v227, v226
    v_cvt_pk_bf16_f32 v228, v214, v206
    v_mov_b32 v229, v228
    v_cvt_pk_bf16_f32 v230, v215, v207
    v_mov_b32 v231, v230
    s_mov_b32 exec_lo, 3
    s_mov_b32 exec_hi, 3
    buffer_store_dwordx2 v[216:217], v17, s[44:47], s10 offen offset:0
    buffer_store_dwordx2 v[218:219], v17, s[44:47], s10 offen offset:16
    buffer_store_dwordx2 v[220:221], v17, s[44:47], s10 offen offset:32
    buffer_store_dwordx2 v[222:223], v17, s[44:47], s10 offen offset:48
    buffer_store_dwordx2 v[224:225], v17, s[44:47], s10 offen offset:128
    buffer_store_dwordx2 v[226:227], v17, s[44:47], s10 offen offset:144
    buffer_store_dwordx2 v[228:229], v17, s[44:47], s10 offen offset:160
    buffer_store_dwordx2 v[230:231], v17, s[44:47], s10 offen offset:176
    s_mov_b64 exec, -1
    s_nop 0
    s_branch L_wp0_fl
L_wp0_d:
    s_sub_u32 s10, s72, 448
    s_and_b32 s15, s10, 1
    s_lshr_b32 s10, s10, 1
    s_mov_b32 s11, 0x24924925
    s_mul_hi_u32 s14, s10, s11
    s_mul_i32 s11, s14, 7
    s_sub_u32 s13, s10, s11
    v_lshlrev_b32 v16, 9, v125
    v_lshrrev_b32 v17, 1, v124
    v_lshl_add_u32 v16, v17, 8, v16
    v_and_b32 v17, 1, v124
    v_lshl_add_u32 v16, v17, 6, v16
    v_add_u32 v16, s59, v16
    ds_write_b128 v16, v[200:203] offset:0
    ds_write_b128 v16, v[204:207] offset:16
    ds_write_b128 v16, v[208:211] offset:32
    ds_write_b128 v16, v[212:215] offset:48
    ds_write_b128 v16, v[216:219] offset:128
    ds_write_b128 v16, v[220:223] offset:144
    ds_write_b128 v16, v[224:227] offset:160
    ds_write_b128 v16, v[228:231] offset:176
    ds_read_b128 v[128:131], v20 offset:0
    ds_read_b128 v[132:135], v20 offset:1024
    ds_read_b128 v[136:139], v20 offset:2048
    ds_read_b128 v[140:143], v20 offset:3072
    ds_read_b128 v[144:147], v20 offset:4096
    ds_read_b128 v[148:151], v20 offset:5120
    ds_read_b128 v[152:155], v20 offset:6144
    s_lshl_b32 s59, s13, 5
    s_lshl_b32 s10, s14, 1
    s_add_u32 s59, s59, s10
    s_add_u32 s59, s59, s15
    s_lshl_b32 s59, s59, 2
    s_add_u32 s59, s59, 14336
    s_mul_i32 s10, s13, 112
    s_mul_i32 s11, s14, 7
    s_add_u32 s10, s10, s11
    s_lshl_b32 s10, s10, 1
    s_add_u32 s10, s10, s15
    s_lshl_b32 s10, s10, 10
    s_add_u32 s10, s10, 6684672
    s_waitcnt lgkmcnt(6)
    buffer_store_dwordx4 v[128:131], v1, s[44:47], s10 offen
    s_add_u32 s10, s10, 2048
    s_waitcnt lgkmcnt(5)
    buffer_store_dwordx4 v[132:135], v1, s[44:47], s10 offen
    s_add_u32 s10, s10, 2048
    s_waitcnt lgkmcnt(4)
    buffer_store_dwordx4 v[136:139], v1, s[44:47], s10 offen
    s_add_u32 s10, s10, 2048
    s_waitcnt lgkmcnt(3)
    buffer_store_dwordx4 v[140:143], v1, s[44:47], s10 offen
    s_add_u32 s10, s10, 2048
    s_waitcnt lgkmcnt(2)
    buffer_store_dwordx4 v[144:147], v1, s[44:47], s10 offen
    s_add_u32 s10, s10, 2048
    s_waitcnt lgkmcnt(1)
    buffer_store_dwordx4 v[148:151], v1, s[44:47], s10 offen
    s_add_u32 s10, s10, 2048
    s_waitcnt lgkmcnt(0)
    buffer_store_dwordx4 v[152:155], v1, s[44:47], s10 offen
    s_nop 1
L_wp0_fl:
L_wp0_done:
    s_endpgm
L_p_clr:
    s_lshl_b32 s10, s66, 7
    s_lshl_b32 s11, s49, 3
    s_add_u32 s10, s10, s11
    v_add_u32 v14, s10, v12
    v_mul_u32_u24 v14, 896, v14
    v_lshl_add_u32 v14, v13, 4, v14
    buffer_load_dwordx4 v[168:171], v14, s[16:19], 0 offen offset:0
    buffer_load_dwordx4 v[172:175], v14, s[16:19], 0 offen offset:128
    buffer_load_dwordx4 v[176:179], v14, s[16:19], 0 offen offset:256
    buffer_load_dwordx4 v[180:183], v14, s[16:19], 0 offen offset:384
    buffer_load_dwordx4 v[184:187], v14, s[16:19], 0 offen offset:512
    buffer_load_dwordx4 v[188:191], v14, s[16:19], 0 offen offset:640
    buffer_load_dwordx4 v[192:195], v14, s[16:19], 0 offen offset:768
    s_mul_i32 s12, s10, 896
    s_add_u32 s12, s12, 4849664
    s_add_u32 s15, s12, 4096
    v_mov_b32 v16, 0
    v_mov_b32 v17, 0
    v_mov_b32 v18, 0
    v_mov_b32 v19, 0
    s_lshl_b32 s10, s2, 11
    s_add_u32 s11, s10, 655360
    buffer_store_dwordx4 v[16:19], v1, s[44:47], s11 offen
    buffer_store_dwordx4 v[16:19], v1, s[44:47], s11 offen offset:1024
    s_cmp_ge_u32 s2, 64
    s_cbranch_scc1 L_p_pf
    buffer_store_dwordx4 v[16:19], v1, s[44:47], s10 offen
    buffer_store_dwordx4 v[16:19], v1, s[44:47], s10 offen offset:1024
L_p_pf:
    s_lshl_b32 s10, s58, 13
    v_lshlrev_b32 v6, 7, v0
    buffer_load_dword v20, v6, s[32:35], s10 offen
    s_barrier
    s_waitcnt vmcnt(0) lgkmcnt(0)
    buffer_store_dwordx4 v[168:171], v1, s[44:47], s12 offen offset:0
    buffer_store_dwordx4 v[172:175], v1, s[44:47], s12 offen offset:1024
    buffer_store_dwordx4 v[176:179], v1, s[44:47], s12 offen offset:2048
    buffer_store_dwordx4 v[180:183], v1, s[44:47], s12 offen offset:3072
    buffer_store_dwordx4 v[184:187], v1, s[44:47], s15 offen offset:0
    buffer_store_dwordx4 v[188:191], v1, s[44:47], s15 offen offset:1024
    buffer_store_dwordx4 v[192:195], v1, s[44:47], s15 offen offset:2048
    v_mov_b32 v16, 0
    v_mov_b32 v17, 0
    v_dot2c_f32_bf16 v16, s56, v168
    v_dot2c_f32_bf16 v17, v168, v168
    v_dot2c_f32_bf16 v16, s56, v169
    v_dot2c_f32_bf16 v17, v169, v169
    v_dot2c_f32_bf16 v16, s56, v170
    v_dot2c_f32_bf16 v17, v170, v170
    v_dot2c_f32_bf16 v16, s56, v171
    v_dot2c_f32_bf16 v17, v171, v171
    v_dot2c_f32_bf16 v16, s56, v172
    v_dot2c_f32_bf16 v17, v172, v172
    v_dot2c_f32_bf16 v16, s56, v173
    v_dot2c_f32_bf16 v17, v173, v173
    v_dot2c_f32_bf16 v16, s56, v174
    v_dot2c_f32_bf16 v17, v174, v174
    v_dot2c_f32_bf16 v16, s56, v175
    v_dot2c_f32_bf16 v17, v175, v175
    v_dot2c_f32_bf16 v16, s56, v176
    v_dot2c_f32_bf16 v17, v176, v176
    v_dot2c_f32_bf16 v16, s56, v177
    v_dot2c_f32_bf16 v17, v177, v177
    v_dot2c_f32_bf16 v16, s56, v178
    v_dot2c_f32_bf16 v17, v178, v178
    v_dot2c_f32_bf16 v16, s56, v179
    v_dot2c_f32_bf16 v17, v179, v179
    v_dot2c_f32_bf16 v16, s56, v180
    v_dot2c_f32_bf16 v17, v180, v180
    v_dot2c_f32_bf16 v16, s56, v181
    v_dot2c_f32_bf16 v17, v181, v181
    v_dot2c_f32_bf16 v16, s56, v182
    v_dot2c_f32_bf16 v17, v182, v182
    v_dot2c_f32_bf16 v16, s56, v183
    v_dot2c_f32_bf16 v17, v183, v183
    v_dot2c_f32_bf16 v16, s56, v184
    v_dot2c_f32_bf16 v17, v184, v184
    v_dot2c_f32_bf16 v16, s56, v185
    v_dot2c_f32_bf16 v17, v185, v185
    v_dot2c_f32_bf16 v16, s56, v186
    v_dot2c_f32_bf16 v17, v186, v186
    v_dot2c_f32_bf16 v16, s56, v187
    v_dot2c_f32_bf16 v17, v187, v187
    v_dot2c_f32_bf16 v16, s56, v188
    v_dot2c_f32_bf16 v17, v188, v188
    v_dot2c_f32_bf16 v16, s56, v189
    v_dot2c_f32_bf16 v17, v189, v189
    v_dot2c_f32_bf16 v16, s56, v190
    v_dot2c_f32_bf16 v17, v190, v190
    v_dot2c_f32_bf16 v16, s56, v191
    v_dot2c_f32_bf16 v17, v191, v191
    v_dot2c_f32_bf16 v16, s56, v192
    v_dot2c_f32_bf16 v17, v192, v192
    v_dot2c_f32_bf16 v16, s56, v193
    v_dot2c_f32_bf16 v17, v193, v193
    v_dot2c_f32_bf16 v16, s56, v194
    v_dot2c_f32_bf16 v17, v194, v194
    v_dot2c_f32_bf16 v16, s56, v195
    v_dot2c_f32_bf16 v17, v195, v195
    s_nop 1
    v_add_f32_dpp v16, v16, v16 row_ror:8 row_mask:0xf bank_mask:0xf
    v_mov_b32 v18, v16
    s_nop 1
    v_permlane16_swap_b32 v16, v18
    v_add_f32 v16, v16, v18
    v_mov_b32 v18, v16
    s_nop 1
    v_permlane32_swap_b32 v16, v18
    v_add_f32 v16, v16, v18
    v_add_f32_dpp v17, v17, v17 row_ror:8 row_mask:0xf bank_mask:0xf
    v_mov_b32 v18, v17
    s_nop 1
    v_permlane16_swap_b32 v17, v18
    v_add_f32 v17, v17, v18
    v_mov_b32 v18, v17
    s_nop 1
    v_permlane32_swap_b32 v17, v18
    v_add_f32 v17, v17, v18
    v_mul_f32 v16, 0x3b124925, v16
    v_mul_f32 v17, 0x3b124925, v17
    v_fma_f32 v17, -v16, v16, v17
    v_max_f32 v17, 0, v17
    v_add_f32 v17, 0x3727c5ac, v17
    v_rsq_f32 v17, v17
    s_lshl_b32 s10, s66, 14
    s_lshl_b32 s11, s49, 10
    s_add_u32 s10, s10, s11
    s_add_u32 s10, s10, 131072
    v_lshlrev_b32 v18, 3, v0
    v_mul_f32 v16, v16, v17
    buffer_store_dwordx2 v[16:17], v18, s[44:47], s10 offen
    buffer_store_dwordx2 v[16:17], v18, s[44:47], s10 offen offset:512
L_end0:
    s_endpgm
.globl main_kernel
.p2align 8
.type main_kernel,@function
main_kernel:
    s_cmp_ge_u32 s2, 256
    s_cbranch_scc1 L_end2
    s_load_dwordx2 s[44:45], s[0:1], 96
    s_load_dwordx8 s[4:11], s[0:1], 0
    s_load_dwordx4 s[12:15], s[0:1], 32
    s_load_dwordx4 s[96:99], s[0:1], 56
    s_load_dwordx4 s[60:63], s[0:1], 72
    v_lshrrev_b32 v1, 6, v0
    v_and_b32 v0, 63, v0
    v_readfirstlane_b32 s59, v1
    v_lshlrev_b32 v1, 4, v0
    s_and_b32 s3, s59, 3
    s_mov_b32 s43, s59
    s_and_b32 s64, s2, 7
    s_lshr_b32 s65, s2, 3
    s_and_b32 s49, s65, 15
    s_lshr_b32 s65, s65, 4
    s_lshl_b32 s66, s64, 1
    s_add_u32 s66, s66, s65
    s_lshl_b32 s48, s66, 2
    s_add_u32 s48, s48, s3
    s_cmp_ge_u32 s49, 7
    s_cselect_b32 s65, 1, 0
    s_mul_i32 s64, s65, 7
    s_sub_u32 s51, s49, s64
    s_lshl_b32 s50, s66, 1
    s_add_u32 s50, s50, s65
    s_lshl_b32 s50, s50, 1
    s_lshr_b32 s52, s3, 1
    s_add_u32 s52, s52, s50
    s_and_b32 s53, s3, 1
    s_lshl_b32 s64, s51, 1
    s_add_u32 s53, s53, s64
    s_mul_i32 s54, s52, 28672
    s_lshl_b32 s64, s53, 9
    s_add_u32 s54, s54, s64
    s_lshl_b32 s55, s3, 12
    s_mov_b32 s56, 0x3f803f80
    s_mov_b32 s57, 0xffff0000
    s_mul_i32 s58, s66, 14
    s_add_u32 s58, s58, s49
    s_mov_b32 s18, 0x1c0000
    s_mov_b32 s19, 0x00020000
    s_mov_b32 s22, 0x1c0000
    s_mov_b32 s23, 0x00020000
    s_mov_b32 s26, 0x1c0000
    s_mov_b32 s27, 0x00020000
    s_mov_b32 s30, 0xe00
    s_mov_b32 s31, 0x00020000
    s_mov_b32 s34, 0x1c0000
    s_mov_b32 s35, 0x00020000
    s_mov_b32 s38, 0x188000
    s_mov_b32 s39, 0x00020000
    s_mov_b32 s46, 0x13e0000
    s_mov_b32 s47, 0x00020000
    s_mov_b32 s70, 0x1c0000
    s_mov_b32 s71, 0x00020000
    v_and_b32 v12, 7, v0
    v_lshrrev_b32 v13, 3, v0
    v_mov_b32 v234, 0
    v_and_b32 v124, 3, v0
    v_lshrrev_b32 v125, 2, v0
    s_waitcnt lgkmcnt(0)
    s_mov_b32 s42, 1
    s_mov_b64 s[16:17], s[4:5]
    s_mov_b64 s[20:21], s[6:7]
    s_mov_b64 s[24:25], s[8:9]
    s_mov_b64 s[28:29], s[10:11]
    s_mov_b64 s[32:33], s[12:13]
    s_mov_b64 s[40:41], s[14:15]
    s_mov_b64 s[100:101], s[60:61]
    s_mov_b64 s[68:69], s[62:63]
    s_mov_b32 s38, s58
    s_mov_b32 s43, s42
    s_getreg_b32 s73, hwreg(HW_REG_XCC_ID)
    s_and_b32 s73, s73, 15
    v_mov_b32 v15, s42
    s_mul_i32 s36, s49, 207872
    s_add_u32 s36, s36, 8323072
    s_add_u32 s36, s36, s55
    s_min_u32 s63, s51, 6
    s_mul_i32 s58, s63, 112*2048
    s_mul_i32 s63, s3, 28*2048
    s_add_u32 s58, s58, s63
    s_add_u32 s58, s58, 6684672
    s_and_b32 s63, s3, 1
    s_lshl_b32 s63, s63, 10
    s_xor_b32 s15, s63, 1024
    s_add_u32 s59, s58, s15
    s_add_u32 s58, s58, s63
    v_mov_b32 v30, s42
    v_mov_b32 v31, s73
    s_lshl_b32 s10, s66, 7
    s_lshl_b32 s11, s49, 3
    s_add_u32 s10, s10, s11
    s_add_u32 s10, s10, 4096
    s_cmp_eq_u32 s3, 0
    s_cselect_b32 s10, s10, 0x7ff00000
    s_mov_b64 exec, 1
    buffer_store_dwordx2 v[30:31], v234, s[44:47], s10 offen sc1
    s_mov_b64 exec, -1
    s_cmp_lt_u32 s49, 14
    s_cbranch_scc1 L_m_busy
    s_add_u32 s39, s55, 114688
    s_mov_b32 m0, s39
    s_add_u32 s37, s36, 0
    buffer_load_dwordx4 v1, s[44:47], s37 offen offset:0 lds
    buffer_load_dwordx4 v1, s[44:47], s37 offen offset:1024 lds
    buffer_load_dwordx4 v1, s[44:47], s37 offen offset:2048 lds
    buffer_load_dwordx4 v1, s[44:47], s37 offen offset:3072 lds
    s_add_u32 s39, s55, 131072
    s_mov_b32 m0, s39
    s_add_u32 s37, s36, 16384
    buffer_load_dwordx4 v1, s[44:47], s37 offen offset:0 lds
    buffer_load_dwordx4 v1, s[44:47], s37 offen offset:1024 lds
    buffer_load_dwordx4 v1, s[44:47], s37 offen offset:2048 lds
    buffer_load_dwordx4 v1, s[44:47], s37 offen offset:3072 lds
    s_add_u32 s39, s55, 147456
    s_mov_b32 m0, s39
    s_add_u32 s37, s36, 32768
    buffer_load_dwordx4 v1, s[44:47], s37 offen offset:0 lds
    buffer_load_dwordx4 v1, s[44:47], s37 offen offset:1024 lds
    buffer_load_dwordx4 v1, s[44:47], s37 offen offset:2048 lds
    buffer_load_dwordx4 v1, s[44:47], s37 offen offset:3072 lds
    s_and_b32 s10, s66, 1
    s_lshl_b32 s10, s10, 1
    s_add_u32 s10, s10, s49
    s_sub_u32 s10, s10, 14
    s_lshl_b32 s10, s10, 2
    s_add_u32 s10, s10, s3
    s_mul_i32 s10, s10, 207872
    s_add_u32 s10, s10, 8323072
    v_lshlrev_b32 v6, 7, v0
    s_waitcnt vmcnt(0) lgkmcnt(0)
    s_nop 3
    s_branch L_m_post
L_m_busy:
    v_and_b32 v4, 31, v0
    s_lshr_b32 s6, s3, 1
    s_and_b32 s7, s3, 1
    s_lshl_b32 s8, s38, 1
    s_add_u32 s8, s8, s6
    s_lshl_b32 s9, s8, 12
    s_lshl_b32 s10, s7, 11
    s_add_u32 s10, s10, s9
    s_add_u32 s11, s10, 1179648
    buffer_load_dwordx4 v[16:19], v1, s[44:47], s11 offen
    buffer_load_dwordx4 v[20:23], v1, s[44:47], s11 offen offset:1024
    buffer_load_dwordx4 v[128:131], v1, s[32:35], s10 offen offset:0
    buffer_load_dwordx4 v[132:135], v1, s[32:35], s10 offen offset:4
    buffer_load_dwordx4 v[136:139], v1, s[32:35], s10 offen offset:8
    buffer_load_dwordx4 v[140:143], v1, s[32:35], s10 offen offset:12
    buffer_load_dwordx4 v[144:147], v1, s[32:35], s10 offen offset:16
    buffer_load_dwordx4 v[148:151], v1, s[32:35], s10 offen offset:1024
    buffer_load_dwordx4 v[152:155], v1, s[32:35], s10 offen offset:1028
    buffer_load_dwordx4 v[156:159], v1, s[32:35], s10 offen offset:1032
    buffer_load_dwordx4 v[160:163], v1, s[32:35], s10 offen offset:1036
    buffer_load_dwordx4 v[164:167], v1, s[32:35], s10 offen offset:1040
    v_add_u32 v9, v13, v12
    v_subrev_u32 v9, 8, v9
    v_max_i32 v10, 0, v9
    v_lshlrev_b32 v10, 1, v10
    buffer_load_ushort v11, v10, s[32:35], s9 offen
    s_lshl_b32 s10, s38, 2
    s_add_u32 s40, s40, s10
    s_addc_u32 s41, s41, 0
    s_load_dword s67, s[40:41], 0
    v_lshrrev_b32 v46, 2, v0
    v_mul_u32_u24 v46, 80, v46
    v_and_b32 v47, 3, v0
    v_lshl_add_u32 v46, v47, 4, v46
    s_mul_i32 s12, s6, 7680
    s_mul_i32 s11, s7, 2560
    s_add_u32 s12, s12, s11
    s_add_u32 s12, s12, 73728
    v_add_u32 v46, s12, v46
    v_lshrrev_b32 v6, 5, v0
    v_bfe_u32 v24, v0, 2, 1
    v_bfe_u32 v25, v0, 3, 2
    v_and_b32 v26, 3, v0
    v_lshl_add_u32 v26, v25, 2, v26
    v_lshl_add_u32 v26, v24, 4, v26
    v_add_u32 v26, 1, v26
    s_mov_b32 s12, 0xd95d9510
    v_and_b32 v24, 7, v26
    v_lshlrev_b32 v25, 2, v24
    v_lshrrev_b32 v25, v25, s12
    v_and_b32 v25, 15, v25
    v_lshrrev_b32 v26, 3, v26
    v_add3_u32 v26, v26, v25, v6
    v_mul_u32_u24 v24, 4608, v24
    v_lshl_add_u32 v26, v26, 4, v24
    s_mul_i32 s11, s6, 36864
    s_lshl_b32 s12, s7, 10
    s_add_u32 s11, s11, s12
    v_add_u32 v26, s11, v26
    v_sub_u32 v27, 31, v4
    v_mul_u32_u24 v27, 80, v27
    v_lshl_add_u32 v27, v6, 4, v27
    s_mul_i32 s11, s6, 7680
    s_mul_i32 s12, s7, 1280
    s_add_u32 s12, s12, s11
    s_add_u32 s12, s12, 73728
    v_add_u32 v27, s12, v27
    s_waitcnt vmcnt(12)
    ds_write_b128 v46, v[16:19]
    s_waitcnt vmcnt(11)
    ds_write_b128 v46, v[20:23] offset:1280
    s_mul_i32 s10, s6, 36864
    s_lshl_b32 s11, s7, 11
    s_add_u32 s11, s11, s10
    v_add_u32 v48, s11, v1
    s_waitcnt vmcnt(10)
    ds_write_b128 v48, v[128:131] offset:64
    s_waitcnt vmcnt(9)
    v_alignbit_b32 v52, v132, v128, 16
    v_alignbit_b32 v53, v133, v129, 16
    v_alignbit_b32 v54, v134, v130, 16
    v_alignbit_b32 v55, v135, v131, 16
    ds_write_b128 v48, v[52:55] offset:4688
    ds_write_b128 v48, v[132:135] offset:9360
    s_waitcnt vmcnt(8)
    v_alignbit_b32 v56, v136, v132, 16
    v_alignbit_b32 v57, v137, v133, 16
    v_alignbit_b32 v58, v138, v134, 16
    v_alignbit_b32 v59, v139, v135, 16
    ds_write_b128 v48, v[56:59] offset:14032
    ds_write_b128 v48, v[136:139] offset:18704
    s_waitcnt vmcnt(7)
    v_alignbit_b32 v60, v140, v136, 16
    v_alignbit_b32 v61, v141, v137, 16
    v_alignbit_b32 v62, v142, v138, 16
    v_alignbit_b32 v63, v143, v139, 16
    ds_write_b128 v48, v[60:63] offset:23184
    ds_write_b128 v48, v[140:143] offset:27856
    s_waitcnt vmcnt(6)
    v_alignbit_b32 v64, v144, v140, 16
    v_alignbit_b32 v65, v145, v141, 16
    v_alignbit_b32 v66, v146, v142, 16
    v_alignbit_b32 v67, v147, v143, 16
    ds_write_b128 v48, v[64:67] offset:32528
    s_waitcnt vmcnt(5)
    ds_write_b128 v48, v[148:151] offset:1088
    s_waitcnt vmcnt(4)
    v_alignbit_b32 v52, v152, v148, 16
    v_alignbit_b32 v53, v153, v149, 16
    v_alignbit_b32 v54, v154, v150, 16
    v_alignbit_b32 v55, v155, v151, 16
    ds_write_b128 v48, v[52:55] offset:5712
    ds_write_b128 v48, v[152:155] offset:10384
    s_waitcnt vmcnt(3)
    v_alignbit_b32 v56, v156, v152, 16
    v_alignbit_b32 v57, v157, v153, 16
    v_alignbit_b32 v58, v158, v154, 16
    v_alignbit_b32 v59, v159, v155, 16
    ds_write_b128 v48, v[56:59] offset:15056
    ds_write_b128 v48, v[156:159] offset:19728
    s_waitcnt vmcnt(2)
    v_alignbit_b32 v60, v160, v156, 16
    v_alignbit_b32 v61, v161, v157, 16
    v_alignbit_b32 v62, v162, v158, 16
    v_alignbit_b32 v63, v163, v159, 16
    ds_write_b128 v48, v[60:63] offset:24208
    ds_write_b128 v48, v[160:163] offset:28880
    s_waitcnt vmcnt(1)
    v_alignbit_b32 v64, v164, v160, 16
    v_alignbit_b32 v65, v165, v161, 16
    v_alignbit_b32 v66, v166, v162, 16
    v_alignbit_b32 v67, v167, v163, 16
    ds_write_b128 v48, v[64:67] offset:33552
    v_mov_b32 v68, 0
    v_mov_b32 v69, 0
    v_mov_b32 v70, 0
    v_mov_b32 v71, 0
    s_mov_b32 s12, 0xd95d9510
    v_lshlrev_b32 v48, 2, v13
    v_lshrrev_b32 v48, v48, s12
    v_and_b32 v48, 15, v48
    v_mul_u32_u24 v49, 4608, v13
    v_lshl_add_u32 v48, v48, 4, v49
    v_add_u32 v48, s10, v48
    v_min_u32 v49, 2, v12
    v_lshl_add_u32 v49, v49, 4, v48
    ds_write_b128 v49, v[68:71]
    s_mul_i32 s10, s6, 7680
    s_mul_i32 s11, s7, 1280
    s_add_u32 s10, s10, s11
    s_add_u32 s10, s10, 78848
    v_add_u32 v49, s10, v1
    ds_write_b128 v49, v[68:71]
    ds_write_b128 v49, v[68:71] offset:256
    v_cmp_le_i32 vcc, 0, v9
    v_lshl_add_u32 v49, v12, 1, v48
    s_waitcnt vmcnt(0)
    v_cndmask_b32 v11, 0, v11, vcc
    ds_write_b16 v49, v11 offset:48
    s_waitcnt lgkmcnt(0)
    s_barrier
    ds_read_b128 v[64:67], v26 offset:0
    ds_read_b128 v[68:71], v27 offset:0
    ds_read_b128 v[72:75], v27 offset:2560
    ds_read_b128 v[76:79], v26 offset:2048
    ds_read_b128 v[80:83], v26 offset:32
    ds_read_b128 v[84:87], v27 offset:32
    ds_read_b128 v[88:91], v27 offset:2592
    ds_read_b128 v[92:95], v26 offset:2080
    s_waitcnt lgkmcnt(6)
    v_mfma_f32_32x32x16_bf16 v[48:63], v[64:67], v[68:71], 0
    s_waitcnt lgkmcnt(5)
    v_mfma_f32_32x32x16_bf16 v[32:47], v[64:67], v[72:75], 0
    s_add_u32 s39, s55, 114688
    s_mov_b32 m0, s39
    s_add_u32 s37, s36, 0
    buffer_load_dwordx4 v1, s[44:47], s37 offen offset:0 lds
    s_waitcnt lgkmcnt(4)
    v_mfma_f32_32x32x16_bf16 v[48:63], v[76:79], v[72:75], v[48:63]
    buffer_load_dwordx4 v1, s[44:47], s37 offen offset:1024 lds
    ds_read_b128 v[64:67], v26 offset:64
    ds_read_b128 v[68:71], v27 offset:80
    ds_read_b128 v[72:75], v27 offset:2640
    ds_read_b128 v[76:79], v26 offset:2112
    s_waitcnt lgkmcnt(6)
    v_mfma_f32_32x32x16_bf16 v[48:63], v[80:83], v[84:87], v[48:63]
    s_waitcnt lgkmcnt(5)
    v_mfma_f32_32x32x16_bf16 v[32:47], v[80:83], v[88:91], v[32:47]
    buffer_load_dwordx4 v1, s[44:47], s37 offen offset:2048 lds
    s_waitcnt lgkmcnt(4)
    v_mfma_f32_32x32x16_bf16 v[48:63], v[92:95], v[88:91], v[48:63]
    ds_read_b128 v[80:83], v26 offset:96
    ds_read_b128 v[84:87], v27 offset:112
    ds_read_b128 v[88:91], v27 offset:2672
    ds_read_b128 v[92:95], v26 offset:2144
    s_waitcnt lgkmcnt(6)
    v_mfma_f32_32x32x16_bf16 v[48:63], v[64:67], v[68:71], v[48:63]
    s_waitcnt lgkmcnt(5)
    v_mfma_f32_32x32x16_bf16 v[32:47], v[64:67], v[72:75], v[32:47]
    buffer_load_dwordx4 v1, s[44:47], s37 offen offset:3072 lds
    s_waitcnt lgkmcnt(4)
    v_mfma_f32_32x32x16_bf16 v[48:63], v[76:79], v[72:75], v[48:63]
    s_add_u32 s39, s55, 131072
    s_mov_b32 m0, s39
    s_add_u32 s37, s36, 16384
    buffer_load_dwordx4 v1, s[44:47], s37 offen offset:0 lds
    ds_read_b128 v[64:67], v26 offset:128
    ds_read_b128 v[68:71], v27 offset:160
    ds_read_b128 v[72:75], v27 offset:2720
    ds_read_b128 v[76:79], v26 offset:2176
    s_waitcnt lgkmcnt(6)
    v_mfma_f32_32x32x16_bf16 v[48:63], v[80:83], v[84:87], v[48:63]
    s_waitcnt lgkmcnt(5)
    v_mfma_f32_32x32x16_bf16 v[32:47], v[80:83], v[88:91], v[32:47]
    buffer_load_dwordx4 v1, s[44:47], s37 offen offset:1024 lds
    s_waitcnt lgkmcnt(4)
    v_mfma_f32_32x32x16_bf16 v[48:63], v[92:95], v[88:91], v[48:63]
    ds_read_b128 v[80:83], v26 offset:160
    ds_read_b128 v[84:87], v27 offset:192
    ds_read_b128 v[88:91], v27 offset:2752
    ds_read_b128 v[92:95], v26 offset:2208
    s_waitcnt lgkmcnt(6)
    v_mfma_f32_32x32x16_bf16 v[48:63], v[64:67], v[68:71], v[48:63]
    s_waitcnt lgkmcnt(5)
    v_mfma_f32_32x32x16_bf16 v[32:47], v[64:67], v[72:75], v[32:47]
    buffer_load_dwordx4 v1, s[44:47], s37 offen offset:2048 lds
    s_waitcnt lgkmcnt(4)
    v_mfma_f32_32x32x16_bf16 v[48:63], v[76:79], v[72:75], v[48:63]
    buffer_load_dwordx4 v1, s[44:47], s37 offen offset:3072 lds
    ds_read_b128 v[64:67], v26 offset:192
    ds_read_b128 v[68:71], v27 offset:240
    ds_read_b128 v[72:75], v27 offset:2800
    ds_read_b128 v[76:79], v26 offset:2240
    s_waitcnt lgkmcnt(6)
    v_mfma_f32_32x32x16_bf16 v[48:63], v[80:83], v[84:87], v[48:63]
    s_waitcnt lgkmcnt(5)
    v_mfma_f32_32x32x16_bf16 v[32:47], v[80:83], v[88:91], v[32:47]
    s_add_u32 s39, s55, 147456
    s_mov_b32 m0, s39
    s_add_u32 s37, s36, 32768
    buffer_load_dwordx4 v1, s[44:47], s37 offen offset:0 lds
    s_waitcnt lgkmcnt(4)
    v_mfma_f32_32x32x16_bf16 v[48:63], v[92:95], v[88:91], v[48:63]
    ds_read_b128 v[80:83], v26 offset:224
    ds_read_b128 v[84:87], v27 offset:272
    ds_read_b128 v[88:91], v27 offset:2832
    ds_read_b128 v[92:95], v26 offset:2272
    s_waitcnt lgkmcnt(6)
    v_mfma_f32_32x32x16_bf16 v[48:63], v[64:67], v[68:71], v[48:63]
    s_waitcnt lgkmcnt(5)
    v_mfma_f32_32x32x16_bf16 v[32:47], v[64:67], v[72:75], v[32:47]
    buffer_load_dwordx4 v1, s[44:47], s37 offen offset:1024 lds
    s_waitcnt lgkmcnt(4)
    v_mfma_f32_32x32x16_bf16 v[48:63], v[76:79], v[72:75], v[48:63]
    buffer_load_dwordx4 v1, s[44:47], s37 offen offset:2048 lds
    ds_read_b128 v[64:67], v26 offset:256
    ds_read_b128 v[68:71], v27 offset:320
    ds_read_b128 v[72:75], v27 offset:2880
    ds_read_b128 v[76:79], v26 offset:2304
    s_waitcnt lgkmcnt(6)
    v_mfma_f32_32x32x16_bf16 v[48:63], v[80:83], v[84:87], v[48:63]
    s_waitcnt lgkmcnt(5)
    v_mfma_f32_32x32x16_bf16 v[32:47], v[80:83], v[88:91], v[32:47]
    buffer_load_dwordx4 v1, s[44:47], s37 offen offset:3072 lds
    s_waitcnt lgkmcnt(4)
    v_mfma_f32_32x32x16_bf16 v[48:63], v[92:95], v[88:91], v[48:63]
    ds_read_b128 v[80:83], v26 offset:288
    ds_read_b128 v[84:87], v27 offset:352
    ds_read_b128 v[88:91], v27 offset:2912
    ds_read_b128 v[92:95], v26 offset:2336
    s_waitcnt lgkmcnt(6)
    v_mfma_f32_32x32x16_bf16 v[48:63], v[64:67], v[68:71], v[48:63]
    s_waitcnt lgkmcnt(5)
    v_mfma_f32_32x32x16_bf16 v[32:47], v[64:67], v[72:75], v[32:47]
    s_add_u32 s63, s58, 0
    buffer_load_dwordx4 a[0:3], v1, s[44:47], s63 offen offset:0
    s_waitcnt lgkmcnt(4)
    v_mfma_f32_32x32x16_bf16 v[48:63], v[76:79], v[72:75], v[48:63]
    s_add_u32 s63, s59, 0
    buffer_load_dwordx4 a[4:7], v1, s[44:47], s63 offen offset:0
    ds_read_b128 v[64:67], v26 offset:320
    ds_read_b128 v[68:71], v27 offset:400
    ds_read_b128 v[72:75], v27 offset:2960
    ds_read_b128 v[76:79], v26 offset:2368
    s_waitcnt lgkmcnt(6)
    v_mfma_f32_32x32x16_bf16 v[48:63], v[80:83], v[84:87], v[48:63]
    s_waitcnt lgkmcnt(5)
    v_mfma_f32_32x32x16_bf16 v[32:47], v[80:83], v[88:91], v[32:47]
    s_add_u32 s63, s58, 0
    buffer_load_dwordx4 a[8:11], v1, s[44:47], s63 offen offset:2048
    s_waitcnt lgkmcnt(4)
    v_mfma_f32_32x32x16_bf16 v[48:63], v[92:95], v[88:91], v[48:63]
    ds_read_b128 v[80:83], v26 offset:352
    ds_read_b128 v[84:87], v27 offset:432
    ds_read_b128 v[88:91], v27 offset:2992
    ds_read_b128 v[92:95], v26 offset:2400
    s_waitcnt lgkmcnt(6)
    v_mfma_f32_32x32x16_bf16 v[48:63], v[64:67], v[68:71], v[48:63]
    s_waitcnt lgkmcnt(5)
    v_mfma_f32_32x32x16_bf16 v[32:47], v[64:67], v[72:75], v[32:47]
    s_add_u32 s63, s59, 0
    buffer_load_dwordx4 a[12:15], v1, s[44:47], s63 offen offset:2048
    s_waitcnt lgkmcnt(4)
    v_mfma_f32_32x32x16_bf16 v[48:63], v[76:79], v[72:75], v[48:63]
    s_add_u32 s63, s58, 4096
    buffer_load_dwordx4 a[16:19], v1, s[44:47], s63 offen offset:0
    ds_read_b128 v[64:67], v26 offset:384
    ds_read_b128 v[68:71], v27 offset:480
    ds_read_b128 v[72:75], v27 offset:3040
    ds_read_b128 v[76:79], v26 offset:2432
    s_waitcnt lgkmcnt(6)
    v_mfma_f32_32x32x16_bf16 v[48:63], v[80:83], v[84:87], v[48:63]
    s_waitcnt lgkmcnt(5)
    v_mfma_f32_32x32x16_bf16 v[32:47], v[80:83], v[88:91], v[32:47]
    s_add_u32 s63, s59, 4096
    buffer_load_dwordx4 a[20:23], v1, s[44:47], s63 offen offset:0
    s_waitcnt lgkmcnt(4)
    v_mfma_f32_32x32x16_bf16 v[48:63], v[92:95], v[88:91], v[48:63]
    ds_read_b128 v[80:83], v26 offset:416
    ds_read_b128 v[84:87], v27 offset:512
    ds_read_b128 v[88:91], v27 offset:3072
    ds_read_b128 v[92:95], v26 offset:2464
    s_waitcnt lgkmcnt(6)
    v_mfma_f32_32x32x16_bf16 v[48:63], v[64:67], v[68:71], v[48:63]
    s_waitcnt lgkmcnt(5)
    v_mfma_f32_32x32x16_bf16 v[32:47], v[64:67], v[72:75], v[32:47]
    s_add_u32 s63, s58, 12288
    buffer_load_dwordx4 a[56:59], v1, s[44:47], s63 offen offset:2048
    s_waitcnt lgkmcnt(4)
    v_mfma_f32_32x32x16_bf16 v[48:63], v[76:79], v[72:75], v[48:63]
    s_add_u32 s63, s59, 12288
    buffer_load_dwordx4 a[60:63], v1, s[44:47], s63 offen offset:2048
    ds_read_b128 v[64:67], v26 offset:448
    ds_read_b128 v[68:71], v27 offset:560
    ds_read_b128 v[72:75], v27 offset:3120
    ds_read_b128 v[76:79], v26 offset:2496
    s_waitcnt lgkmcnt(6)
    v_mfma_f32_32x32x16_bf16 v[48:63], v[80:83], v[84:87], v[48:63]
    s_waitcnt lgkmcnt(5)
    v_mfma_f32_32x32x16_bf16 v[32:47], v[80:83], v[88:91], v[32:47]
    s_add_u32 s63, s58, 16384
    buffer_load_dwordx4 a[64:67], v1, s[44:47], s63 offen offset:0
    s_waitcnt lgkmcnt(4)
    v_mfma_f32_32x32x16_bf16 v[48:63], v[92:95], v[88:91], v[48:63]
    ds_read_b128 v[80:83], v26 offset:480
    ds_read_b128 v[84:87], v27 offset:592
    ds_read_b128 v[88:91], v27 offset:3152
    ds_read_b128 v[92:95], v26 offset:2528
    s_waitcnt lgkmcnt(6)
    v_mfma_f32_32x32x16_bf16 v[48:63], v[64:67], v[68:71], v[48:63]
    s_waitcnt lgkmcnt(5)
    v_mfma_f32_32x32x16_bf16 v[32:47], v[64:67], v[72:75], v[32:47]
    s_add_u32 s63, s59, 16384
    buffer_load_dwordx4 a[68:71], v1, s[44:47], s63 offen offset:0
    s_waitcnt lgkmcnt(4)
    v_mfma_f32_32x32x16_bf16 v[48:63], v[76:79], v[72:75], v[48:63]
    s_add_u32 s63, s58, 16384
    buffer_load_dwordx4 a[72:75], v1, s[44:47], s63 offen offset:2048
    ds_read_b128 v[64:67], v26 offset:512
    ds_read_b128 v[68:71], v27 offset:640
    ds_read_b128 v[72:75], v27 offset:3200
    ds_read_b128 v[76:79], v26 offset:2560
    s_waitcnt lgkmcnt(6)
    v_mfma_f32_32x32x16_bf16 v[48:63], v[80:83], v[84:87], v[48:63]
    s_waitcnt lgkmcnt(5)
    v_mfma_f32_32x32x16_bf16 v[32:47], v[80:83], v[88:91], v[32:47]
    s_add_u32 s63, s59, 16384
    buffer_load_dwordx4 a[76:79], v1, s[44:47], s63 offen offset:2048
    s_waitcnt lgkmcnt(4)
    v_mfma_f32_32x32x16_bf16 v[48:63], v[92:95], v[88:91], v[48:63]
    ds_read_b128 v[80:83], v26 offset:544
    ds_read_b128 v[84:87], v27 offset:672
    ds_read_b128 v[88:91], v27 offset:3232
    ds_read_b128 v[92:95], v26 offset:2592
    s_waitcnt lgkmcnt(6)
    v_mfma_f32_32x32x16_bf16 v[48:63], v[64:67], v[68:71], v[48:63]
    s_waitcnt lgkmcnt(5)
    v_mfma_f32_32x32x16_bf16 v[32:47], v[64:67], v[72:75], v[32:47]
    s_add_u32 s63, s58, 28672
    buffer_load_dwordx4 a[112:115], v1, s[44:47], s63 offen offset:0
    s_waitcnt lgkmcnt(4)
    v_mfma_f32_32x32x16_bf16 v[48:63], v[76:79], v[72:75], v[48:63]
    s_add_u32 s63, s59, 28672
    buffer_load_dwordx4 a[116:119], v1, s[44:47], s63 offen offset:0
    ds_read_b128 v[64:67], v26 offset:576
    ds_read_b128 v[68:71], v27 offset:720
    ds_read_b128 v[72:75], v27 offset:3280
    ds_read_b128 v[76:79], v26 offset:2624
    s_waitcnt lgkmcnt(6)
    v_mfma_f32_32x32x16_bf16 v[48:63], v[80:83], v[84:87], v[48:63]
    s_waitcnt lgkmcnt(5)
    v_mfma_f32_32x32x16_bf16 v[32:47], v[80:83], v[88:91], v[32:47]
    s_add_u32 s63, s58, 28672
    buffer_load_dwordx4 a[120:123], v1, s[44:47], s63 offen offset:2048
    s_waitcnt lgkmcnt(4)
    v_mfma_f32_32x32x16_bf16 v[48:63], v[92:95], v[88:91], v[48:63]
    ds_read_b128 v[80:83], v26 offset:608
    ds_read_b128 v[84:87], v27 offset:752
    ds_read_b128 v[88:91], v27 offset:3312
    ds_read_b128 v[92:95], v26 offset:2656
    s_waitcnt lgkmcnt(6)
    v_mfma_f32_32x32x16_bf16 v[48:63], v[64:67], v[68:71], v[48:63]
    s_waitcnt lgkmcnt(5)
    v_mfma_f32_32x32x16_bf16 v[32:47], v[64:67], v[72:75], v[32:47]
    s_add_u32 s63, s59, 28672
    buffer_load_dwordx4 a[124:127], v1, s[44:47], s63 offen offset:2048
    s_waitcnt lgkmcnt(4)
    v_mfma_f32_32x32x16_bf16 v[48:63], v[76:79], v[72:75], v[48:63]
    s_add_u32 s63, s58, 32768
    buffer_load_dwordx4 a[128:131], v1, s[44:47], s63 offen offset:0
    ds_read_b128 v[64:67], v26 offset:640
    ds_read_b128 v[68:71], v27 offset:800
    ds_read_b128 v[72:75], v27 offset:3360
    ds_read_b128 v[76:79], v26 offset:2688
    s_waitcnt lgkmcnt(6)
    v_mfma_f32_32x32x16_bf16 v[48:63], v[80:83], v[84:87], v[48:63]
    s_waitcnt lgkmcnt(5)
    v_mfma_f32_32x32x16_bf16 v[32:47], v[80:83], v[88:91], v[32:47]
    s_add_u32 s63, s59, 32768
    buffer_load_dwordx4 a[132:135], v1, s[44:47], s63 offen offset:0
    s_waitcnt lgkmcnt(4)
    v_mfma_f32_32x32x16_bf16 v[48:63], v[92:95], v[88:91], v[48:63]
    ds_read_b128 v[80:83], v26 offset:672
    ds_read_b128 v[84:87], v27 offset:832
    ds_read_b128 v[88:91], v27 offset:3392
    ds_read_b128 v[92:95], v26 offset:2720
    s_waitcnt lgkmcnt(6)
    v_mfma_f32_32x32x16_bf16 v[48:63], v[64:67], v[68:71], v[48:63]
    s_waitcnt lgkmcnt(5)
    v_mfma_f32_32x32x16_bf16 v[32:47], v[64:67], v[72:75], v[32:47]
    s_add_u32 s63, s58, 40960
    buffer_load_dwordx4 a[168:171], v1, s[44:47], s63 offen offset:2048
    s_waitcnt lgkmcnt(4)
    v_mfma_f32_32x32x16_bf16 v[48:63], v[76:79], v[72:75], v[48:63]
    s_add_u32 s63, s59, 40960
    buffer_load_dwordx4 a[172:175], v1, s[44:47], s63 offen offset:2048
    ds_read_b128 v[64:67], v26 offset:704
    ds_read_b128 v[68:71], v27 offset:880
    ds_read_b128 v[72:75], v27 offset:3440
    ds_read_b128 v[76:79], v26 offset:2752
    s_waitcnt lgkmcnt(6)
    v_mfma_f32_32x32x16_bf16 v[48:63], v[80:83], v[84:87], v[48:63]
    s_waitcnt lgkmcnt(5)
    v_mfma_f32_32x32x16_bf16 v[32:47], v[80:83], v[88:91], v[32:47]
    s_add_u32 s63, s58, 45056
    buffer_load_dwordx4 a[176:179], v1, s[44:47], s63 offen offset:0
    s_waitcnt lgkmcnt(4)
    v_mfma_f32_32x32x16_bf16 v[48:63], v[92:95], v[88:91], v[48:63]
    ds_read_b128 v[80:83], v26 offset:736
    ds_read_b128 v[84:87], v27 offset:912
    ds_read_b128 v[88:91], v27 offset:3472
    ds_read_b128 v[92:95], v26 offset:2784
    s_waitcnt lgkmcnt(6)
    v_mfma_f32_32x32x16_bf16 v[48:63], v[64:67], v[68:71], v[48:63]
    s_waitcnt lgkmcnt(5)
    v_mfma_f32_32x32x16_bf16 v[32:47], v[64:67], v[72:75], v[32:47]
    s_add_u32 s63, s59, 45056
    buffer_load_dwordx4 a[180:183], v1, s[44:47], s63 offen offset:0
    s_waitcnt lgkmcnt(4)
    v_mfma_f32_32x32x16_bf16 v[48:63], v[76:79], v[72:75], v[48:63]
    s_add_u32 s63, s58, 45056
    buffer_load_dwordx4 a[184:187], v1, s[44:47], s63 offen offset:2048
    ds_read_b128 v[64:67], v26 offset:768
    ds_read_b128 v[68:71], v27 offset:960
    ds_read_b128 v[72:75], v27 offset:3520
    ds_read_b128 v[76:79], v26 offset:2816
    s_waitcnt lgkmcnt(6)
    v_mfma_f32_32x32x16_bf16 v[48:63], v[80:83], v[84:87], v[48:63]
    s_waitcnt lgkmcnt(5)
    v_mfma_f32_32x32x16_bf16 v[32:47], v[80:83], v[88:91], v[32:47]
    s_add_u32 s63, s59, 45056
    buffer_load_dwordx4 a[188:191], v1, s[44:47], s63 offen offset:2048
    s_waitcnt lgkmcnt(4)
    v_mfma_f32_32x32x16_bf16 v[48:63], v[92:95], v[88:91], v[48:63]
    ds_read_b128 v[80:83], v26 offset:800
    ds_read_b128 v[84:87], v27 offset:992
    ds_read_b128 v[88:91], v27 offset:3552
    ds_read_b128 v[92:95], v26 offset:2848
    s_waitcnt lgkmcnt(6)
    v_mfma_f32_32x32x16_bf16 v[48:63], v[64:67], v[68:71], v[48:63]
    s_waitcnt lgkmcnt(5)
    v_mfma_f32_32x32x16_bf16 v[32:47], v[64:67], v[72:75], v[32:47]
    s_add_u32 s63, s58, 4096
    buffer_load_dwordx4 a[24:27], v1, s[44:47], s63 offen offset:2048
    s_waitcnt lgkmcnt(4)
    v_mfma_f32_32x32x16_bf16 v[48:63], v[76:79], v[72:75], v[48:63]
    s_add_u32 s63, s59, 4096
    buffer_load_dwordx4 a[28:31], v1, s[44:47], s63 offen offset:2048
    ds_read_b128 v[64:67], v26 offset:832
    ds_read_b128 v[68:71], v27 offset:1040
    ds_read_b128 v[72:75], v27 offset:3600
    ds_read_b128 v[76:79], v26 offset:2880
    s_waitcnt lgkmcnt(6)
    v_mfma_f32_32x32x16_bf16 v[48:63], v[80:83], v[84:87], v[48:63]
    s_waitcnt lgkmcnt(5)
    v_mfma_f32_32x32x16_bf16 v[32:47], v[80:83], v[88:91], v[32:47]
    s_add_u32 s63, s58, 8192
    buffer_load_dwordx4 a[32:35], v1, s[44:47], s63 offen offset:0
    s_waitcnt lgkmcnt(4)
    v_mfma_f32_32x32x16_bf16 v[48:63], v[92:95], v[88:91], v[48:63]
    ds_read_b128 v[80:83], v26 offset:864
    ds_read_b128 v[84:87], v27 offset:1072
    ds_read_b128 v[88:91], v27 offset:3632
    ds_read_b128 v[92:95], v26 offset:2912
    s_waitcnt lgkmcnt(6)
    v_mfma_f32_32x32x16_bf16 v[48:63], v[64:67], v[68:71], v[48:63]
    s_waitcnt lgkmcnt(5)
    v_mfma_f32_32x32x16_bf16 v[32:47], v[64:67], v[72:75], v[32:47]
    s_add_u32 s63, s59, 8192
    buffer_load_dwordx4 a[36:39], v1, s[44:47], s63 offen offset:0
    s_waitcnt lgkmcnt(4)
    v_mfma_f32_32x32x16_bf16 v[48:63], v[76:79], v[72:75], v[48:63]
    s_add_u32 s63, s58, 20480
    buffer_load_dwordx4 a[80:83], v1, s[44:47], s63 offen offset:0
    ds_read_b128 v[64:67], v26 offset:896
    ds_read_b128 v[68:71], v27 offset:1120
    ds_read_b128 v[72:75], v27 offset:3680
    ds_read_b128 v[76:79], v26 offset:2944
    s_waitcnt lgkmcnt(6)
    v_mfma_f32_32x32x16_bf16 v[48:63], v[80:83], v[84:87], v[48:63]
    s_waitcnt lgkmcnt(5)
    v_mfma_f32_32x32x16_bf16 v[32:47], v[80:83], v[88:91], v[32:47]
    s_add_u32 s63, s59, 20480
    buffer_load_dwordx4 a[84:87], v1, s[44:47], s63 offen offset:0
    s_waitcnt lgkmcnt(4)
    v_mfma_f32_32x32x16_bf16 v[48:63], v[92:95], v[88:91], v[48:63]
    ds_read_b128 v[80:83], v26 offset:928
    ds_read_b128 v[84:87], v27 offset:1152
    ds_read_b128 v[88:91], v27 offset:3712
    ds_read_b128 v[92:95], v26 offset:2976
    s_waitcnt lgkmcnt(6)
    v_mfma_f32_32x32x16_bf16 v[48:63], v[64:67], v[68:71], v[48:63]
    s_waitcnt lgkmcnt(5)
    v_mfma_f32_32x32x16_bf16 v[32:47], v[64:67], v[72:75], v[32:47]
    s_add_u32 s63, s58, 20480
    buffer_load_dwordx4 a[88:91], v1, s[44:47], s63 offen offset:2048
    s_waitcnt lgkmcnt(4)
    v_mfma_f32_32x32x16_bf16 v[48:63], v[76:79], v[72:75], v[48:63]
    s_add_u32 s63, s59, 20480
    buffer_load_dwordx4 a[92:95], v1, s[44:47], s63 offen offset:2048
    s_xor_b32 s10, s3, 1
    s_lshl_b32 s10, s10, 12
    s_add_u32 s10, s10, 89088
    v_add_u32 v24, s10, v1
    s_add_u32 s10, s55, 89088
    v_add_u32 v25, s10, v1
    s_lshl_b32 s10, s7, 5
    s_sub_u32 s10, 63, s10
    v_sub_u32 v28, s10, v4
    v_mul_u32_u24 v28, 80, v28
    v_xor_b32 v29, 1, v6
    v_lshl_add_u32 v28, v29, 5, v28
    s_mul_i32 s10, s6, 7680
    s_add_u32 s10, s10, 73728
    v_add_u32 v28, s10, v28
    ds_read_b128 v[96:99], v28
    ds_read_b128 v[100:103], v28 offset:16
    v_lshrrev_b32 v28, 1, v4
    v_mul_u32_u24 v28, 57344, v28
    v_and_b32 v29, 1, v4
    v_lshl_add_u32 v28, v29, 4, v28
    v_lshl_add_u32 v28, v6, 5, v28
    v_cmp_eq_u32 s[60:61], 1, v29
    s_mul_i32 s11, s7, 16*57344
    s_lshl_b32 s12, s8, 7
    s_add_u32 s11, s11, s12
    s_add_u32 s11, s11, 3014656
    s_lshl_b32 s10, s67, 16
    s_and_b32 s12, s67, 0xffff0000
    s_cmp_eq_u32 s6, 0
    s_cselect_b32 s10, s10, s12
    ds_read_b128 v[64:67], v26 offset:960
    ds_read_b128 v[68:71], v27 offset:1200
    ds_read_b128 v[72:75], v27 offset:3760
    ds_read_b128 v[76:79], v26 offset:3008
    s_waitcnt lgkmcnt(8)
    v_mfma_f32_32x32x16_bf16 v[48:63], v[80:83], v[84:87], v[48:63]
    s_waitcnt lgkmcnt(7)
    v_mfma_f32_32x32x16_bf16 v[32:47], v[80:83], v[88:91], v[32:47]
    s_add_u32 s63, s58, 32768
    buffer_load_dwordx4 a[136:139], v1, s[44:47], s63 offen offset:2048
    s_waitcnt lgkmcnt(6)
    v_mfma_f32_32x32x16_bf16 v[48:63], v[92:95], v[88:91], v[48:63]
    ds_read_b128 v[80:83], v26 offset:992
    ds_read_b128 v[84:87], v27 offset:1232
    ds_read_b128 v[88:91], v27 offset:3792
    ds_read_b128 v[92:95], v26 offset:3040
    s_waitcnt lgkmcnt(6)
    v_mfma_f32_32x32x16_bf16 v[48:63], v[64:67], v[68:71], v[48:63]
    s_waitcnt lgkmcnt(5)
    v_mfma_f32_32x32x16_bf16 v[32:47], v[64:67], v[72:75], v[32:47]
    s_waitcnt lgkmcnt(4)
    v_mfma_f32_32x32x16_bf16 v[48:63], v[76:79], v[72:75], v[48:63]
    s_waitcnt lgkmcnt(2)
    v_mfma_f32_32x32x16_bf16 v[48:63], v[80:83], v[84:87], v[48:63]
    s_waitcnt lgkmcnt(1)
    v_mfma_f32_32x32x16_bf16 v[32:47], v[80:83], v[88:91], v[32:47]
    s_waitcnt lgkmcnt(0)
    v_mfma_f32_32x32x16_bf16 v[48:63], v[92:95], v[88:91], v[48:63]
    s_cmp_eq_u32 s7, 0
    s_cbranch_scc1 L_cv_p0
    s_nop 7
    ds_write_b128 v24, v[32:35] offset:0
    ds_write_b128 v24, v[36:39] offset:1024
    ds_write_b128 v24, v[40:43] offset:2048
    ds_write_b128 v24, v[44:47] offset:3072
    v_mov_b32 v32, v48
    v_mov_b32 v33, v49
    v_mov_b32 v34, v50
    v_mov_b32 v35, v51
    v_mov_b32 v36, v52
    v_mov_b32 v37, v53
    v_mov_b32 v38, v54
    v_mov_b32 v39, v55
    v_mov_b32 v40, v56
    v_mov_b32 v41, v57
    v_mov_b32 v42, v58
    v_mov_b32 v43, v59
    v_mov_b32 v44, v60
    v_mov_b32 v45, v61
    v_mov_b32 v46, v62
    v_mov_b32 v47, v63
    s_waitcnt lgkmcnt(0)
    s_nop 3
    s_branch L_cv_j
L_cv_p0:
    s_nop 9
    ds_write_b128 v24, v[48:51] offset:0
    ds_write_b128 v24, v[52:55] offset:1024
    ds_write_b128 v24, v[56:59] offset:2048
    ds_write_b128 v24, v[60:63] offset:3072
    s_waitcnt lgkmcnt(0)
L_cv_j:
    s_barrier
    ds_read_b128 v[64:67], v25 offset:0
    ds_read_b128 v[68:71], v25 offset:1024
    ds_read_b128 v[72:75], v25 offset:2048
    ds_read_b128 v[76:79], v25 offset:3072
    v_and_b32 v30, s57, v103
    v_fmac_f32 v32, s10, v30
    v_lshlrev_b32 v30, 16, v103
    v_fmac_f32 v33, s10, v30
    v_and_b32 v30, s57, v102
    v_fmac_f32 v34, s10, v30
    v_lshlrev_b32 v30, 16, v102
    v_fmac_f32 v35, s10, v30
    v_and_b32 v30, s57, v101
    v_fmac_f32 v36, s10, v30
    v_lshlrev_b32 v30, 16, v101
    v_fmac_f32 v37, s10, v30
    v_and_b32 v30, s57, v100
    v_fmac_f32 v38, s10, v30
    v_lshlrev_b32 v30, 16, v100
    v_fmac_f32 v39, s10, v30
    v_and_b32 v30, s57, v99
    v_fmac_f32 v40, s10, v30
    v_lshlrev_b32 v30, 16, v99
    v_fmac_f32 v41, s10, v30
    v_and_b32 v30, s57, v98
    v_fmac_f32 v42, s10, v30
    v_lshlrev_b32 v30, 16, v98
    v_fmac_f32 v43, s10, v30
    v_and_b32 v30, s57, v97
    v_fmac_f32 v44, s10, v30
    v_lshlrev_b32 v30, 16, v97
    v_fmac_f32 v45, s10, v30
    v_and_b32 v30, s57, v96
    v_fmac_f32 v46, s10, v30
    v_lshlrev_b32 v30, 16, v96
    v_fmac_f32 v47, s10, v30
    s_waitcnt lgkmcnt(3)
    v_add_f32 v32, v32, v64
    v_add_f32 v33, v33, v65
    v_add_f32 v34, v34, v66
    v_add_f32 v35, v35, v67
    s_waitcnt lgkmcnt(2)
    v_add_f32 v36, v36, v68
    v_add_f32 v37, v37, v69
    v_add_f32 v38, v38, v70
    v_add_f32 v39, v39, v71
    s_waitcnt lgkmcnt(1)
    v_add_f32 v40, v40, v72
    v_add_f32 v41, v41, v73
    v_add_f32 v42, v42, v74
    v_add_f32 v43, v43, v75
    s_waitcnt lgkmcnt(0)
    v_add_f32 v44, v44, v76
    v_add_f32 v45, v45, v77
    v_add_f32 v46, v46, v78
    v_add_f32 v47, v47, v79
    v_cvt_pk_bf16_f32 v80, v32, v33
    v_cvt_pk_bf16_f32 v81, v34, v35
    v_cvt_pk_bf16_f32 v82, v36, v37
    v_cvt_pk_bf16_f32 v83, v38, v39
    v_cvt_pk_bf16_f32 v84, v40, v41
    v_cvt_pk_bf16_f32 v85, v42, v43
    v_cvt_pk_bf16_f32 v86, v44, v45
    v_cvt_pk_bf16_f32 v87, v46, v47
    v_cndmask_b32 v64, v84, v80, s[60:61]
    v_cndmask_b32 v65, v85, v81, s[60:61]
    v_cndmask_b32 v66, v86, v82, s[60:61]
    v_cndmask_b32 v67, v87, v83, s[60:61]
    v_mov_b32_dpp v68, v64 quad_perm:[1,0,3,2] row_mask:0xf bank_mask:0xf
    v_mov_b32_dpp v69, v65 quad_perm:[1,0,3,2] row_mask:0xf bank_mask:0xf
    v_mov_b32_dpp v70, v66 quad_perm:[1,0,3,2] row_mask:0xf bank_mask:0xf
    v_mov_b32_dpp v71, v67 quad_perm:[1,0,3,2] row_mask:0xf bank_mask:0xf
    v_cndmask_b32 v72, v80, v68, s[60:61]
    v_cndmask_b32 v76, v68, v84, s[60:61]
    v_cndmask_b32 v73, v81, v69, s[60:61]
    v_cndmask_b32 v77, v69, v85, s[60:61]
    v_cndmask_b32 v74, v82, v70, s[60:61]
    v_cndmask_b32 v78, v70, v86, s[60:61]
    v_cndmask_b32 v75, v83, v71, s[60:61]
    v_cndmask_b32 v79, v71, v87, s[60:61]
    buffer_store_dwordx4 v[72:75], v28, s[44:47], s11 offen sc1
    buffer_store_dwordx4 v[76:79], v28, s[44:47], s11 offen offset:64 sc1
    s_waitcnt vmcnt(0)
    s_barrier
    s_cmp_lg_u32 s3, 0
    s_cbranch_scc1 L_m_post
    s_lshl_b32 s10, s38, 7
    s_add_u32 s10, s10, 98304
    s_mov_b64 exec, 1
    buffer_store_dword v15, v234, s[44:47], s10 offen sc1
    s_mov_b64 exec, -1
    s_nop 0
L_m_post:
    s_lshl_b32 s10, s66, 7
    s_lshl_b32 s11, s49, 3
    s_add_u32 s10, s10, s11
    s_mul_i32 s41, s10, 896
    s_lshl_b32 s40, s10, 7
    s_add_u32 s40, s40, 131072
    s_and_b32 s67, s3, 1
    v_lshrrev_b32 v14, 2, v13
    v_lshlrev_b32 v11, 3, v12
    v_lshl_add_u32 v11, v14, 6, v11
    s_sub_u32 s8, s36, s55
    s_mul_i32 s13, s48, 112*1024
    s_mul_i32 s14, s49, 7*1024
    s_add_u32 s13, s13, s14
    s_add_u32 s13, s13, 11665408
    s_add_u32 s14, s13, 4096
    v_min_u32 v5, 15, v0
    v_lshlrev_b32 v5, 3, v5
    s_lshl_b32 s11, s66, 7
    s_add_u32 s12, s11, 4096
    buffer_load_dwordx2 v[30:31], v5, s[44:47], s12 offen sc1
    s_cmp_ge_u32 s3, 2
    s_cbranch_scc1 L_k2_l
    s_add_u32 s9, s36, 49152
    s_add_u32 s10, s55, 0
    s_mov_b32 m0, s10
    s_nop 0
    buffer_load_dwordx4 v1, s[44:47], s9 offen offset:0 lds
    buffer_load_dwordx4 v1, s[44:47], s9 offen offset:1024 lds
    buffer_load_dwordx4 v1, s[44:47], s9 offen offset:2048 lds
    buffer_load_dwordx4 v1, s[44:47], s9 offen offset:3072 lds
    s_add_u32 s9, s9, 8192
    s_add_u32 s10, s55, 8192
    s_mov_b32 m0, s10
    s_nop 0
    buffer_load_dwordx4 v1, s[44:47], s9 offen offset:0 lds
    buffer_load_dwordx4 v1, s[44:47], s9 offen offset:1024 lds
    buffer_load_dwordx4 v1, s[44:47], s9 offen offset:2048 lds
    buffer_load_dwordx4 v1, s[44:47], s9 offen offset:3072 lds
    s_add_u32 s9, s9, 8192
    s_add_u32 s10, s55, 16384
    s_mov_b32 m0, s10
    s_nop 0
    buffer_load_dwordx4 v1, s[44:47], s9 offen offset:0 lds
    buffer_load_dwordx4 v1, s[44:47], s9 offen offset:1024 lds
    buffer_load_dwordx4 v1, s[44:47], s9 offen offset:2048 lds
    buffer_load_dwordx4 v1, s[44:47], s9 offen offset:3072 lds
    s_add_u32 s9, s9, 8192
    s_add_u32 s10, s55, 24576
    s_mov_b32 m0, s10
    s_nop 0
    buffer_load_dwordx4 v1, s[44:47], s9 offen offset:0 lds
    buffer_load_dwordx4 v1, s[44:47], s9 offen offset:1024 lds
    buffer_load_dwordx4 v1, s[44:47], s9 offen offset:2048 lds
    buffer_load_dwordx4 v1, s[44:47], s9 offen offset:3072 lds
    s_add_u32 s9, s9, 8192
    s_add_u32 s10, s55, 32768
    s_mov_b32 m0, s10
    s_nop 0
    buffer_load_dwordx4 v1, s[44:47], s9 offen offset:0 lds
    buffer_load_dwordx4 v1, s[44:47], s9 offen offset:1024 lds
    buffer_load_dwordx4 v1, s[44:47], s9 offen offset:2048 lds
    buffer_load_dwordx4 v1, s[44:47], s9 offen offset:3072 lds
    s_add_u32 s9, s9, 8192
    s_add_u32 s10, s55, 40960
    s_mov_b32 m0, s10
    s_nop 0
    buffer_load_dwordx4 v1, s[44:47], s9 offen offset:0 lds
    buffer_load_dwordx4 v1, s[44:47], s9 offen offset:1024 lds
    buffer_load_dwordx4 v1, s[44:47], s9 offen offset:2048 lds
    buffer_load_dwordx4 v1, s[44:47], s9 offen offset:3072 lds
    s_waitcnt vmcnt(0) lgkmcnt(0)
    s_nop 0
    s_branch L_k2_j
L_k2_l:
    s_lshl_b32 s9, s67, 10
    s_add_u32 s9, s9, s41
    s_add_u32 s10, s9, 4849664
    s_add_u32 s11, s9, 4853760
    s_add_u32 s15, s41, 4853760
    buffer_load_dwordx4 v[240:243], v1, s[44:47], s10 offen sc1
    buffer_load_dwordx4 v[244:247], v1, s[44:47], s10 offen offset:2048 sc1
    buffer_load_dwordx4 v[248:251], v1, s[44:47], s11 offen sc1
    buffer_load_dwordx4 v[252:255], v1, s[44:47], s15 offen offset:2048 sc1
    v_lshlrev_b32 v14, 3, v12
    buffer_load_dwordx2 v[232:233], v14, s[44:47], s40 offen offset:896 sc1
    buffer_load_dword v29, v1, s[44:47], s40 offen sc1
    s_lshl_b32 s10, s67, 12
    s_add_u32 s10, s10, 98304
    v_add_u32 v16, s10, v1
    v_lshrrev_b32 v17, 4, v0
    v_bfe_u32 v18, v0, 1, 1
    v_lshl_add_u32 v17, v17, 1, v18
    v_lshlrev_b32 v17, 7, v17
    v_bfe_u32 v18, v0, 2, 2
    v_lshl_add_u32 v17, v18, 4, v17
    v_and_b32 v18, 1, v0
    v_lshl_add_u32 v17, v18, 3, v17
    v_add_u32 v17, s10, v17
    s_waitcnt vmcnt(5)
    v_lshlrev_b32 v128, 16, v240
    v_and_b32 v129, s57, v240
    v_lshlrev_b32 v130, 16, v241
    v_and_b32 v131, s57, v241
    v_lshlrev_b32 v132, 16, v242
    v_and_b32 v133, s57, v242
    v_lshlrev_b32 v134, 16, v243
    v_and_b32 v135, s57, v243
    s_waitcnt vmcnt(1)
    v_fma_f32 v160, v128, v233, -v232
    v_fma_f32 v161, v129, v233, -v232
    v_fma_f32 v162, v130, v233, -v232
    v_fma_f32 v163, v131, v233, -v232
    v_fma_f32 v164, v132, v233, -v232
    v_fma_f32 v165, v133, v233, -v232
    v_fma_f32 v166, v134, v233, -v232
    v_fma_f32 v167, v135, v233, -v232
    v_lshlrev_b32 v136, 16, v244
    v_and_b32 v137, s57, v244
    v_lshlrev_b32 v138, 16, v245
    v_and_b32 v139, s57, v245
    v_lshlrev_b32 v140, 16, v246
    v_and_b32 v141, s57, v246
    v_lshlrev_b32 v142, 16, v247
    v_and_b32 v143, s57, v247
    v_fma_f32 v168, v136, v233, -v232
    v_fma_f32 v169, v137, v233, -v232
    v_fma_f32 v170, v138, v233, -v232
    v_fma_f32 v171, v139, v233, -v232
    v_fma_f32 v172, v140, v233, -v232
    v_fma_f32 v173, v141, v233, -v232
    v_fma_f32 v174, v142, v233, -v232
    v_fma_f32 v175, v143, v233, -v232
    v_lshlrev_b32 v144, 16, v248
    v_and_b32 v145, s57, v248
    v_lshlrev_b32 v146, 16, v249
    v_and_b32 v147, s57, v249
    v_lshlrev_b32 v148, 16, v250
    v_and_b32 v149, s57, v250
    v_lshlrev_b32 v150, 16, v251
    v_and_b32 v151, s57, v251
    v_fma_f32 v176, v144, v233, -v232
    v_fma_f32 v177, v145, v233, -v232
    v_fma_f32 v178, v146, v233, -v232
    v_fma_f32 v179, v147, v233, -v232
    v_fma_f32 v180, v148, v233, -v232
    v_fma_f32 v181, v149, v233, -v232
    v_fma_f32 v182, v150, v233, -v232
    v_fma_f32 v183, v151, v233, -v232
    v_lshlrev_b32 v152, 16, v252
    v_and_b32 v153, s57, v252
    v_lshlrev_b32 v154, 16, v253
    v_and_b32 v155, s57, v253
    v_lshlrev_b32 v156, 16, v254
    v_and_b32 v157, s57, v254
    v_lshlrev_b32 v158, 16, v255
    v_and_b32 v159, s57, v255
    v_fma_f32 v184, v152, v233, -v232
    v_fma_f32 v185, v153, v233, -v232
    v_fma_f32 v186, v154, v233, -v232
    v_fma_f32 v187, v155, v233, -v232
    v_fma_f32 v188, v156, v233, -v232
    v_fma_f32 v189, v157, v233, -v232
    v_fma_f32 v190, v158, v233, -v232
    v_fma_f32 v191, v159, v233, -v232
    v_lshlrev_b32 v24, 7, v0
    s_lshl_b32 s10, s66, 1
    s_lshr_b32 s11, s49, 3
    s_add_u32 s10, s10, s11
    s_mul_i32 s10, s10, 57344
    s_and_b32 s11, s49, 7
    s_lshl_b32 s11, s11, 4
    s_add_u32 s10, s10, s11
    s_add_u32 s10, s10, 3014656
    s_lshl_b32 s11, s67, 13
    s_add_u32 s60, s10, s11
    s_add_u32 s61, s60, 16384
    s_add_u32 s37, s60, 32768
    s_add_u32 s63, s10, 49152
    s_lshl_b32 s39, s67, 12
    s_add_u32 s39, s39, 98304
    v_and_b32 v19, 31, v0
    v_lshlrev_b32 v19, 7, v19
    v_lshrrev_b32 v25, 5, v0
    v_lshl_add_u32 v26, v25, 13, v19
    s_lshl_b32 s10, s67, 12
    s_sub_u32 s10, 8192, s10
    v_mul_lo_u32 v25, v25, s10
    v_add_u32 v27, v25, v19
    s_add_u32 s36, s39, 16384
    buffer_load_dword v20, v26, s[44:47], s39 offen sc1
    buffer_load_dword v21, v27, s[44:47], s36 offen sc1
    s_mov_b32 s62, 0
L1_chk:
    s_waitcnt vmcnt(1)
    v_xor_b32 v28, s42, v20
    s_waitcnt vmcnt(0)
    v_xor_b32 v29, s42, v21
    v_or_b32 v28, v28, v29
    v_cmp_ne_u32 vcc, 0, v28
    s_add_u32 s62, s62, 1
    s_cmp_lt_u32 s62, 0x20000
    s_cselect_b64 s[64:65], vcc, 0
    s_cmp_eq_u64 s[64:65], 0
    s_cbranch_scc1 L1_ok
    s_sleep 3
    buffer_load_dword v20, v26, s[44:47], s39 offen sc1
    buffer_load_dword v21, v27, s[44:47], s36 offen sc1
    s_waitcnt vmcnt(0) lgkmcnt(0)
    s_branch L1_chk
L1_ok:
    buffer_load_dwordx4 v[32:35], v24, s[44:47], s60 offen sc1
    buffer_load_dwordx4 v[36:39], v24, s[44:47], s61 offen sc1
    buffer_load_dwordx4 v[40:43], v24, s[44:47], s37 offen sc1
    buffer_load_dwordx4 v[44:47], v24, s[44:47], s63 offen sc1
    s_waitcnt vmcnt(3)
    ds_write_b128 v16, v[32:35] offset:0
    s_waitcnt vmcnt(2)
    ds_write_b128 v16, v[36:39] offset:1024
    s_waitcnt vmcnt(1)
    ds_write_b128 v16, v[40:43] offset:2048
    s_waitcnt vmcnt(0)
    ds_write_b128 v16, v[44:47] offset:3072
    ds_read_b64_tr_b16 v[68:69], v17 offset:0
    ds_read_b64_tr_b16 v[70:71], v17 offset:64
    ds_read_b64_tr_b16 v[76:77], v17 offset:1024
    ds_read_b64_tr_b16 v[78:79], v17 offset:1088
    ds_read_b64_tr_b16 v[84:85], v17 offset:2048
    ds_read_b64_tr_b16 v[86:87], v17 offset:2112
    ds_read_b64_tr_b16 v[92:93], v17 offset:3072
    ds_read_b64_tr_b16 v[94:95], v17 offset:3136
    s_waitcnt lgkmcnt(7)
    v_lshlrev_b32 v48, 16, v68
    v_and_b32 v49, s57, v68
    v_lshlrev_b32 v50, 16, v69
    v_and_b32 v51, s57, v69
    s_waitcnt lgkmcnt(6)
    v_lshlrev_b32 v52, 16, v70
    v_and_b32 v53, s57, v70
    v_lshlrev_b32 v54, 16, v71
    v_and_b32 v55, s57, v71
    v_fmac_f32 v128, v160, v48
    v_fmac_f32 v129, v161, v49
    v_fmac_f32 v130, v162, v50
    v_fmac_f32 v131, v163, v51
    v_fmac_f32 v132, v164, v52
    v_fmac_f32 v133, v165, v53
    v_fmac_f32 v134, v166, v54
    v_fmac_f32 v135, v167, v55
    v_cvt_pk_bf16_f32 v64, v128, v129
    v_cvt_pk_bf16_f32 v65, v130, v131
    v_cvt_pk_bf16_f32 v66, v132, v133
    v_cvt_pk_bf16_f32 v67, v134, v135
    s_waitcnt lgkmcnt(5)
    v_lshlrev_b32 v48, 16, v76
    v_and_b32 v49, s57, v76
    v_lshlrev_b32 v50, 16, v77
    v_and_b32 v51, s57, v77
    s_waitcnt lgkmcnt(4)
    v_lshlrev_b32 v52, 16, v78
    v_and_b32 v53, s57, v78
    v_lshlrev_b32 v54, 16, v79
    v_and_b32 v55, s57, v79
    v_fmac_f32 v136, v168, v48
    v_fmac_f32 v137, v169, v49
    v_fmac_f32 v138, v170, v50
    v_fmac_f32 v139, v171, v51
    v_fmac_f32 v140, v172, v52
    v_fmac_f32 v141, v173, v53
    v_fmac_f32 v142, v174, v54
    v_fmac_f32 v143, v175, v55
    v_cvt_pk_bf16_f32 v72, v136, v137
    v_cvt_pk_bf16_f32 v73, v138, v139
    v_cvt_pk_bf16_f32 v74, v140, v141
    v_cvt_pk_bf16_f32 v75, v142, v143
    s_waitcnt lgkmcnt(3)
    v_lshlrev_b32 v48, 16, v84
    v_and_b32 v49, s57, v84
    v_lshlrev_b32 v50, 16, v85
    v_and_b32 v51, s57, v85
    s_waitcnt lgkmcnt(2)
    v_lshlrev_b32 v52, 16, v86
    v_and_b32 v53, s57, v86
    v_lshlrev_b32 v54, 16, v87
    v_and_b32 v55, s57, v87
    v_fmac_f32 v144, v176, v48
    v_fmac_f32 v145, v177, v49
    v_fmac_f32 v146, v178, v50
    v_fmac_f32 v147, v179, v51
    v_fmac_f32 v148, v180, v52
    v_fmac_f32 v149, v181, v53
    v_fmac_f32 v150, v182, v54
    v_fmac_f32 v151, v183, v55
    v_cvt_pk_bf16_f32 v80, v144, v145
    v_cvt_pk_bf16_f32 v81, v146, v147
    v_cvt_pk_bf16_f32 v82, v148, v149
    v_cvt_pk_bf16_f32 v83, v150, v151
    s_waitcnt lgkmcnt(1)
    v_lshlrev_b32 v48, 16, v92
    v_and_b32 v49, s57, v92
    v_lshlrev_b32 v50, 16, v93
    v_and_b32 v51, s57, v93
    s_waitcnt lgkmcnt(0)
    v_lshlrev_b32 v52, 16, v94
    v_and_b32 v53, s57, v94
    v_lshlrev_b32 v54, 16, v95
    v_and_b32 v55, s57, v95
    v_fmac_f32 v152, v184, v48
    v_fmac_f32 v153, v185, v49
    v_fmac_f32 v154, v186, v50
    v_fmac_f32 v155, v187, v51
    v_fmac_f32 v156, v188, v52
    v_fmac_f32 v157, v189, v53
    v_fmac_f32 v158, v190, v54
    v_fmac_f32 v159, v191, v55
    v_cvt_pk_bf16_f32 v88, v152, v153
    v_cvt_pk_bf16_f32 v89, v154, v155
    v_cvt_pk_bf16_f32 v90, v156, v157
    v_cvt_pk_bf16_f32 v91, v158, v159
    s_nop 4
L_k2_j:
    s_mov_b32 s62, 0
L2_chk:
    v_cmp_ne_u32 vcc, s42, v30
    s_add_u32 s62, s62, 1
    s_cmp_lt_u32 s62, 0x20000
    s_cselect_b64 s[64:65], vcc, 0
    s_cmp_eq_u64 s[64:65], 0
    s_cbranch_scc1 L2_ok
    s_sleep 1
    buffer_load_dwordx2 v[30:31], v5, s[44:47], s12 offen sc1
    s_waitcnt vmcnt(0) lgkmcnt(0)
    s_branch L2_chk
L2_ok:
    v_cmp_ne_u32 s[72:73], s73, v31
    s_nop 0
    s_cmp_lg_u64 s[72:73], 0
    s_cbranch_scc1 L_slow
    s_cmp_lt_u32 s3, 2
    s_cbranch_scc1 L_F_rj
    s_lshl_b32 s9, s67, 10
    s_add_u32 s9, s9, 0
    s_add_u32 s9, s9, s41
    s_add_u32 s10, s9, 4849664
    buffer_store_dwordx4 v[64:67], v1, s[44:47], s10 offen
    s_lshl_b32 s9, s67, 10
    s_add_u32 s9, s9, 2048
    s_add_u32 s9, s9, s41
    s_add_u32 s10, s9, 4849664
    buffer_store_dwordx4 v[72:75], v1, s[44:47], s10 offen
    s_lshl_b32 s9, s67, 10
    s_add_u32 s9, s9, 4096
    s_add_u32 s9, s9, s41
    s_add_u32 s10, s9, 4849664
    buffer_store_dwordx4 v[80:83], v1, s[44:47], s10 offen
    s_add_u32 s9, s41, 6144
    s_cmp_eq_u32 s3, 3
    s_cselect_b32 s9, 0x7f000000, s9
    s_add_u32 s10, s9, 4849664
    buffer_store_dwordx4 v[88:91], v1, s[44:47], s10 offen
    v_mov_b32 v112, 0
    v_mov_b32 v113, 0
    v_dot2c_f32_bf16 v112, s56, v64
    v_dot2c_f32_bf16 v113, v64, v64
    v_dot2c_f32_bf16 v112, s56, v65
    v_dot2c_f32_bf16 v113, v65, v65
    v_dot2c_f32_bf16 v112, s56, v66
    v_dot2c_f32_bf16 v113, v66, v66
    v_dot2c_f32_bf16 v112, s56, v67
    v_dot2c_f32_bf16 v113, v67, v67
    v_mov_b32 v114, 0
    v_mov_b32 v115, 0
    v_dot2c_f32_bf16 v114, s56, v72
    v_dot2c_f32_bf16 v115, v72, v72
    v_dot2c_f32_bf16 v114, s56, v73
    v_dot2c_f32_bf16 v115, v73, v73
    v_dot2c_f32_bf16 v114, s56, v74
    v_dot2c_f32_bf16 v115, v74, v74
    v_dot2c_f32_bf16 v114, s56, v75
    v_dot2c_f32_bf16 v115, v75, v75
    v_mov_b32 v116, 0
    v_mov_b32 v117, 0
    v_dot2c_f32_bf16 v116, s56, v80
    v_dot2c_f32_bf16 v117, v80, v80
    v_dot2c_f32_bf16 v116, s56, v81
    v_dot2c_f32_bf16 v117, v81, v81
    v_dot2c_f32_bf16 v116, s56, v82
    v_dot2c_f32_bf16 v117, v82, v82
    v_dot2c_f32_bf16 v116, s56, v83
    v_dot2c_f32_bf16 v117, v83, v83
    v_mov_b32 v118, 0
    v_mov_b32 v119, 0
    v_dot2c_f32_bf16 v118, s56, v88
    v_dot2c_f32_bf16 v119, v88, v88
    v_dot2c_f32_bf16 v118, s56, v89
    v_dot2c_f32_bf16 v119, v89, v89
    v_dot2c_f32_bf16 v118, s56, v90
    v_dot2c_f32_bf16 v119, v90, v90
    v_dot2c_f32_bf16 v118, s56, v91
    v_dot2c_f32_bf16 v119, v91, v91
    v_add_f32_dpp v112, v112, v112 row_ror:8 row_mask:0xf bank_mask:0xf
    v_add_f32_dpp v113, v113, v113 row_ror:8 row_mask:0xf bank_mask:0xf
    v_add_f32_dpp v114, v114, v114 row_ror:8 row_mask:0xf bank_mask:0xf
    v_add_f32_dpp v115, v115, v115 row_ror:8 row_mask:0xf bank_mask:0xf
    v_add_f32_dpp v116, v116, v116 row_ror:8 row_mask:0xf bank_mask:0xf
    v_add_f32_dpp v117, v117, v117 row_ror:8 row_mask:0xf bank_mask:0xf
    v_add_f32_dpp v118, v118, v118 row_ror:8 row_mask:0xf bank_mask:0xf
    v_add_f32_dpp v119, v119, v119 row_ror:8 row_mask:0xf bank_mask:0xf
    v_mov_b32 v120, v112
    v_mov_b32 v121, v113
    v_mov_b32 v122, v114
    v_mov_b32 v123, v115
    v_mov_b32 v124, v116
    v_mov_b32 v125, v117
    v_mov_b32 v126, v118
    v_mov_b32 v127, v119
    v_permlane16_swap_b32 v112, v120
    v_permlane16_swap_b32 v113, v121
    v_permlane16_swap_b32 v114, v122
    v_permlane16_swap_b32 v115, v123
    v_permlane16_swap_b32 v116, v124
    v_permlane16_swap_b32 v117, v125
    v_permlane16_swap_b32 v118, v126
    v_permlane16_swap_b32 v119, v127
    v_add_f32 v112, v112, v120
    v_add_f32 v113, v113, v121
    v_add_f32 v114, v114, v122
    v_add_f32 v115, v115, v123
    v_add_f32 v116, v116, v124
    v_add_f32 v117, v117, v125
    v_add_f32 v118, v118, v126
    v_add_f32 v119, v119, v127
    s_lshl_b32 s9, s67, 7
    s_add_u32 s9, s9, 0
    s_add_u32 s9, s9, s40
    buffer_store_dwordx2 v[112:113], v11, s[44:47], s9 offen
    s_lshl_b32 s9, s67, 7
    s_add_u32 s9, s9, 256
    s_add_u32 s9, s9, s40
    buffer_store_dwordx2 v[114:115], v11, s[44:47], s9 offen
    s_lshl_b32 s9, s67, 7
    s_add_u32 s9, s9, 512
    s_add_u32 s9, s9, s40
    buffer_store_dwordx2 v[116:117], v11, s[44:47], s9 offen
    s_add_u32 s9, s40, 768
    s_cmp_eq_u32 s3, 3
    s_cselect_b32 s9, 0x7f000000, s9
    buffer_store_dwordx2 v[118:119], v11, s[44:47], s9 offen
    s_lshl_b32 s10, s66, 8
    s_lshr_b32 s11, s49, 2
    s_lshl_b32 s11, s11, 6
    s_add_u32 s10, s10, s11
    s_and_b32 s11, s49, 3
    s_lshl_b32 s11, s11, 3
    s_add_u32 s10, s10, s11
    s_lshl_b32 s11, s67, 2
    s_add_u32 s10, s10, s11
    s_add_u32 s10, s10, 20480
    s_waitcnt vmcnt(0)
    s_mov_b64 exec, 1
    buffer_store_dword v15, v234, s[44:47], s10 offen
    s_mov_b64 exec, -1
    s_lshl_b32 s9, s67, 10
    s_add_u32 s9, s9, 0
    s_add_u32 s9, s9, s41
    s_add_u32 s10, s9, 19005440
    buffer_store_dwordx4 v[68:71], v1, s[44:47], s10 offen sc1
    s_lshl_b32 s9, s67, 10
    s_add_u32 s9, s9, 2048
    s_add_u32 s9, s9, s41
    s_add_u32 s10, s9, 19005440
    buffer_store_dwordx4 v[76:79], v1, s[44:47], s10 offen sc1
    s_lshl_b32 s9, s67, 10
    s_add_u32 s9, s9, 4096
    s_add_u32 s9, s9, s41
    s_add_u32 s10, s9, 19005440
    buffer_store_dwordx4 v[84:87], v1, s[44:47], s10 offen sc1
    s_add_u32 s9, s41, 6144
    s_cmp_eq_u32 s3, 3
    s_cselect_b32 s9, 0x7f000000, s9
    s_add_u32 s10, s9, 19005440
    buffer_store_dwordx4 v[92:95], v1, s[44:47], s10 offen sc1
    s_nop 1
L_F_rj:
    s_add_u32 s8, s8, s55
    v_add_u32 v2, 0x10000, v1
    v_add_u32 v3, 0x20000, v1
    v_and_b32 v8, 31, v0
    v_lshlrev_b32 v8, 3, v8
    v_bfe_u32 v6, v0, 3, 2
    v_and_b32 v7, 7, v0
    v_lshrrev_b32 v4, 5, v0
    v_mul_u32_u24 v12, 7168, v6
    v_lshl_add_u32 v12, v4, 7, v12
    v_lshl_add_u32 v12, v7, 4, v12
    v_lshlrev_b32 v9, 10, v6
    v_lshl_add_u32 v9, v7, 3, v9
    v_mul_u32_u24 v4, 448, v4
    v_add_u32 v9, v9, v4
    v_min_u32 v6, 7, v0
    v_lshrrev_b32 v7, 2, v6
    v_and_b32 v6, 3, v6
    v_lshlrev_b32 v14, 6, v7
    v_lshl_add_u32 v14, v6, 2, v14
    s_lshl_b32 s40, s50, 6
    s_lshl_b32 s41, s3, 4
    s_add_u32 s40, s40, s41
    v_add_u32 v14, s40, v14
    s_mul_i32 s7, s48, 28672
    s_add_u32 s7, s7, 4849664
    s_lshl_b32 s60, s48, 12
    s_add_u32 s60, s60, 131072
    s_barrier
    v_min_u32 v7, 7, v0
    v_lshlrev_b32 v7, 2, v7
    s_lshl_b32 s38, s48, 6
    s_add_u32 s38, s38, 20480
    buffer_load_dword v6, v7, s[44:47], s38 offen sc1
    s_mov_b32 s62, 0
L3_chk:
    s_waitcnt vmcnt(0)
    v_cmp_ne_u32 vcc, s42, v6
    s_add_u32 s62, s62, 1
    s_cmp_lt_u32 s62, 0x20000
    s_cselect_b64 s[64:65], vcc, 0
    s_cmp_eq_u64 s[64:65], 0
    s_cbranch_scc1 L3_ok
    s_sleep 1
    buffer_load_dword v6, v7, s[44:47], s38 offen sc1
    s_waitcnt vmcnt(0) lgkmcnt(0)
    s_branch L3_chk
L3_ok:
    buffer_load_dwordx4 v[16:19], v12, s[44:47], s7 offen offset:0 sc1
    buffer_load_dwordx4 v[20:23], v12, s[44:47], s7 offen offset:256 sc1
    buffer_load_dwordx4 v[24:27], v12, s[44:47], s7 offen offset:512 sc1
    buffer_load_dwordx4 v[28:31], v12, s[44:47], s7 offen offset:768 sc1
    buffer_load_dwordx4 v[32:35], v12, s[44:47], s7 offen offset:1024 sc1
    buffer_load_dwordx4 v[36:39], v12, s[44:47], s7 offen offset:1280 sc1
    buffer_load_dwordx4 v[40:43], v12, s[44:47], s7 offen offset:1536 sc1
    buffer_load_dwordx4 v[44:47], v12, s[44:47], s7 offen offset:1792 sc1
    buffer_load_dwordx4 v[48:51], v12, s[44:47], s7 offen offset:2048 sc1
    ds_read_b128 a[224:227], v2 offset:49152
    ds_read_b128 a[228:231], v2 offset:50176
    ds_read_b128 a[232:235], v2 offset:51200
    ds_read_b128 a[236:239], v2 offset:52224
    s_waitcnt vmcnt(8) lgkmcnt(3)
    v_mfma_f32_32x32x16_bf16 v[132:147], a[224:227], v[16:19], 0
    ds_read_b128 a[240:243], v2 offset:53248
    buffer_load_dwordx4 v[52:55], v12, s[44:47], s7 offen offset:2304 sc1
    s_waitcnt lgkmcnt(3)
    v_mfma_f32_32x32x16_bf16 v[148:163], a[228:231], v[16:19], 0
    ds_read_b128 a[244:247], v2 offset:54272
    s_waitcnt lgkmcnt(3)
    v_mfma_f32_32x32x16_bf16 v[164:179], a[232:235], v[16:19], 0
    ds_read_b128 a[248:251], v2 offset:55296
    buffer_load_dwordx4 v[56:59], v12, s[44:47], s7 offen offset:2560 sc1
    s_waitcnt vmcnt(9) lgkmcnt(3)
    v_mfma_f32_32x32x16_bf16 v[132:147], a[236:239], v[20:23], v[132:147]
    ds_read_b128 a[252:255], v2 offset:56320
    s_waitcnt lgkmcnt(3)
    v_mfma_f32_32x32x16_bf16 v[148:163], a[240:243], v[20:23], v[148:163]
    ds_read_b128 a[224:227], v2 offset:57344
    buffer_load_dwordx4 v[60:63], v12, s[44:47], s7 offen offset:2816 sc1
    s_waitcnt lgkmcnt(3)
    v_mfma_f32_32x32x16_bf16 v[164:179], a[244:247], v[20:23], v[164:179]
    ds_read_b128 a[228:231], v2 offset:58368
    s_waitcnt vmcnt(9) lgkmcnt(3)
    v_mfma_f32_32x32x16_bf16 v[132:147], a[248:251], v[24:27], v[132:147]
    ds_read_b128 a[232:235], v2 offset:59392
    buffer_load_dwordx4 v[64:67], v12, s[44:47], s7 offen offset:3072 sc1
    s_waitcnt lgkmcnt(3)
    v_mfma_f32_32x32x16_bf16 v[148:163], a[252:255], v[24:27], v[148:163]
    ds_read_b128 a[236:239], v2 offset:60416
    s_waitcnt lgkmcnt(3)
    v_mfma_f32_32x32x16_bf16 v[164:179], a[224:227], v[24:27], v[164:179]
    ds_read_b128 a[240:243], v2 offset:61440
    buffer_load_dwordx4 v[68:71], v12, s[44:47], s7 offen offset:3328 sc1
    s_waitcnt vmcnt(10) lgkmcnt(3)
    v_mfma_f32_32x32x16_bf16 v[132:147], a[228:231], v[28:31], v[132:147]
    ds_read_b128 a[244:247], v2 offset:62464
    s_waitcnt lgkmcnt(3)
    v_mfma_f32_32x32x16_bf16 v[148:163], a[232:235], v[28:31], v[148:163]
    ds_read_b128 a[248:251], v2 offset:63488
    buffer_load_dwordx4 v[72:75], v12, s[44:47], s7 offen offset:3584 sc1
    s_waitcnt lgkmcnt(3)
    v_mfma_f32_32x32x16_bf16 v[164:179], a[236:239], v[28:31], v[164:179]
    ds_read_b128 a[252:255], v2 offset:64512
    s_waitcnt vmcnt(10) lgkmcnt(3)
    v_mfma_f32_32x32x16_bf16 v[132:147], a[240:243], v[32:35], v[132:147]
    ds_read_b128 a[224:227], v3 offset:0
    buffer_load_dwordx4 v[76:79], v12, s[44:47], s7 offen offset:3840 sc1
    s_waitcnt lgkmcnt(3)
    v_mfma_f32_32x32x16_bf16 v[148:163], a[244:247], v[32:35], v[148:163]
    ds_read_b128 a[228:231], v3 offset:1024
    s_waitcnt lgkmcnt(3)
    v_mfma_f32_32x32x16_bf16 v[164:179], a[248:251], v[32:35], v[164:179]
    ds_read_b128 a[232:235], v3 offset:2048
    s_add_u32 s7, s7, 4096
    buffer_load_dwordx4 v[80:83], v12, s[44:47], s7 offen offset:0 sc1
    s_waitcnt vmcnt(11) lgkmcnt(3)
    v_mfma_f32_32x32x16_bf16 v[132:147], a[252:255], v[36:39], v[132:147]
    ds_read_b128 a[236:239], v3 offset:3072
    s_waitcnt lgkmcnt(3)
    v_mfma_f32_32x32x16_bf16 v[148:163], a[224:227], v[36:39], v[148:163]
    ds_read_b128 a[240:243], v3 offset:4096
    buffer_load_dwordx4 v[84:87], v12, s[44:47], s7 offen offset:256 sc1
    s_waitcnt lgkmcnt(3)
    v_mfma_f32_32x32x16_bf16 v[164:179], a[228:231], v[36:39], v[164:179]
    ds_read_b128 a[244:247], v3 offset:5120
    s_waitcnt vmcnt(11) lgkmcnt(3)
    v_mfma_f32_32x32x16_bf16 v[132:147], a[232:235], v[40:43], v[132:147]
    ds_read_b128 a[248:251], v3 offset:6144
    buffer_load_dwordx4 v[88:91], v12, s[44:47], s7 offen offset:512 sc1
    s_waitcnt lgkmcnt(3)
    v_mfma_f32_32x32x16_bf16 v[148:163], a[236:239], v[40:43], v[148:163]
    ds_read_b128 a[252:255], v3 offset:7168
    s_waitcnt lgkmcnt(3)
    v_mfma_f32_32x32x16_bf16 v[164:179], a[240:243], v[40:43], v[164:179]
    ds_read_b128 a[224:227], v3 offset:8192
    buffer_load_dwordx4 v[92:95], v12, s[44:47], s7 offen offset:768 sc1
    s_waitcnt vmcnt(12) lgkmcnt(3)
    v_mfma_f32_32x32x16_bf16 v[132:147], a[244:247], v[44:47], v[132:147]
    ds_read_b128 a[228:231], v3 offset:9216
    s_waitcnt lgkmcnt(3)
    v_mfma_f32_32x32x16_bf16 v[148:163], a[248:251], v[44:47], v[148:163]
    ds_read_b128 a[232:235], v3 offset:10240
    buffer_load_dwordx2 v[244:245], v9, s[44:47], s60 offen offset:0 sc1
    buffer_load_dwordx2 v[246:247], v9, s[44:47], s60 offen offset:64 sc1
    buffer_load_dwordx2 v[248:249], v9, s[44:47], s60 offen offset:128 sc1
    buffer_load_dwordx2 v[250:251], v9, s[44:47], s60 offen offset:192 sc1
    buffer_load_dwordx2 v[252:253], v9, s[44:47], s60 offen offset:256 sc1
    buffer_load_dwordx2 v[254:255], v9, s[44:47], s60 offen offset:320 sc1
    buffer_load_dwordx2 v[10:11], v9, s[44:47], s60 offen offset:384 sc1
    s_waitcnt lgkmcnt(3)
    v_mfma_f32_32x32x16_bf16 v[164:179], a[252:255], v[44:47], v[164:179]
    ds_read_b128 a[236:239], v3 offset:11264
    s_waitcnt vmcnt(18) lgkmcnt(3)
    v_mfma_f32_32x32x16_bf16 v[132:147], a[224:227], v[48:51], v[132:147]
    ds_read_b128 a[240:243], v3 offset:12288
    buffer_load_dwordx4 v[96:99], v12, s[44:47], s7 offen offset:1024 sc1
    s_waitcnt lgkmcnt(3)
    v_mfma_f32_32x32x16_bf16 v[148:163], a[228:231], v[48:51], v[148:163]
    ds_read_b128 a[244:247], v3 offset:13312
    s_waitcnt lgkmcnt(3)
    v_mfma_f32_32x32x16_bf16 v[164:179], a[232:235], v[48:51], v[164:179]
    ds_read_b128 a[248:251], v3 offset:14336
    buffer_load_dwordx4 v[100:103], v12, s[44:47], s7 offen offset:1280 sc1
    s_waitcnt vmcnt(19) lgkmcnt(3)
    v_mfma_f32_32x32x16_bf16 v[132:147], a[236:239], v[52:55], v[132:147]
    ds_read_b128 a[252:255], v3 offset:15360
    s_waitcnt lgkmcnt(3)
    v_mfma_f32_32x32x16_bf16 v[148:163], a[240:243], v[52:55], v[148:163]
    ds_read_b128 a[224:227], v3 offset:16384
    buffer_load_dwordx4 v[104:107], v12, s[44:47], s7 offen offset:1536 sc1
    s_waitcnt lgkmcnt(3)
    v_mfma_f32_32x32x16_bf16 v[164:179], a[244:247], v[52:55], v[164:179]
    ds_read_b128 a[228:231], v3 offset:17408
    s_waitcnt vmcnt(19) lgkmcnt(3)
    v_mfma_f32_32x32x16_bf16 v[132:147], a[248:251], v[56:59], v[132:147]
    ds_read_b128 a[232:235], v3 offset:18432
    buffer_load_dwordx4 v[108:111], v12, s[44:47], s7 offen offset:1792 sc1
    s_waitcnt lgkmcnt(3)
    v_mfma_f32_32x32x16_bf16 v[148:163], a[252:255], v[56:59], v[148:163]
    ds_read_b128 a[236:239], v3 offset:19456
    s_waitcnt lgkmcnt(3)
    v_mfma_f32_32x32x16_bf16 v[164:179], a[224:227], v[56:59], v[164:179]
    ds_read_b128 a[240:243], v3 offset:20480
    buffer_load_dwordx4 v[112:115], v12, s[44:47], s7 offen offset:2048 sc1
    s_waitcnt vmcnt(20) lgkmcnt(3)
    v_mfma_f32_32x32x16_bf16 v[132:147], a[228:231], v[60:63], v[132:147]
    ds_read_b128 a[244:247], v3 offset:21504
    s_waitcnt lgkmcnt(3)
    v_mfma_f32_32x32x16_bf16 v[148:163], a[232:235], v[60:63], v[148:163]
    ds_read_b128 a[248:251], v3 offset:22528
    buffer_load_dwordx4 v[116:119], v12, s[44:47], s7 offen offset:2304 sc1
    s_waitcnt lgkmcnt(3)
    v_mfma_f32_32x32x16_bf16 v[164:179], a[236:239], v[60:63], v[164:179]
    ds_read_b128 a[252:255], v3 offset:23552
    s_waitcnt vmcnt(20) lgkmcnt(3)
    v_mfma_f32_32x32x16_bf16 v[132:147], a[240:243], v[64:67], v[132:147]
    ds_read_b128 a[224:227], v3 offset:24576
    buffer_load_dwordx4 v[120:123], v12, s[44:47], s7 offen offset:2560 sc1
    s_waitcnt lgkmcnt(3)
    v_mfma_f32_32x32x16_bf16 v[148:163], a[244:247], v[64:67], v[148:163]
    ds_read_b128 a[228:231], v3 offset:25600
    s_waitcnt lgkmcnt(3)
    v_mfma_f32_32x32x16_bf16 v[164:179], a[248:251], v[64:67], v[164:179]
    ds_read_b128 a[232:235], v3 offset:26624
    buffer_load_dwordx4 v[124:127], v12, s[44:47], s7 offen offset:2816 sc1
    s_waitcnt vmcnt(21) lgkmcnt(3)
    v_mfma_f32_32x32x16_bf16 v[132:147], a[252:255], v[68:71], v[132:147]
    ds_read_b128 a[236:239], v3 offset:27648
    s_waitcnt lgkmcnt(3)
    v_mfma_f32_32x32x16_bf16 v[148:163], a[224:227], v[68:71], v[148:163]
    ds_read_b128 a[240:243], v3 offset:28672
    s_add_u32 s10, s55, 49152
    s_mov_b32 m0, s10
    s_add_u32 s11, s8, 98304
    buffer_load_dwordx4 v1, s[44:47], s11 offen offset:0 lds
    s_waitcnt lgkmcnt(3)
    v_mfma_f32_32x32x16_bf16 v[164:179], a[228:231], v[68:71], v[164:179]
    ds_read_b128 a[244:247], v3 offset:29696
    s_waitcnt vmcnt(21) lgkmcnt(3)
    v_mfma_f32_32x32x16_bf16 v[132:147], a[232:235], v[72:75], v[132:147]
    ds_read_b128 a[248:251], v3 offset:30720
    buffer_load_dwordx4 v1, s[44:47], s11 offen offset:1024 lds
    s_waitcnt lgkmcnt(3)
    v_mfma_f32_32x32x16_bf16 v[148:163], a[236:239], v[72:75], v[148:163]
    ds_read_b128 a[252:255], v3 offset:31744
    s_waitcnt lgkmcnt(3)
    v_mfma_f32_32x32x16_bf16 v[164:179], a[240:243], v[72:75], v[164:179]
    ds_read_b128 a[224:227], v1 offset:0
    buffer_load_dwordx4 v1, s[44:47], s11 offen offset:2048 lds
    s_waitcnt vmcnt(22) lgkmcnt(3)
    v_mfma_f32_32x32x16_bf16 v[132:147], a[244:247], v[76:79], v[132:147]
    ds_read_b128 a[228:231], v1 offset:1024
    s_waitcnt lgkmcnt(3)
    v_mfma_f32_32x32x16_bf16 v[148:163], a[248:251], v[76:79], v[148:163]
    ds_read_b128 a[232:235], v1 offset:2048
    buffer_load_dwordx4 v1, s[44:47], s11 offen offset:3072 lds
    s_waitcnt lgkmcnt(3)
    v_mfma_f32_32x32x16_bf16 v[164:179], a[252:255], v[76:79], v[164:179]
    ds_read_b128 a[236:239], v1 offset:3072
    s_waitcnt vmcnt(22) lgkmcnt(3)
    v_mfma_f32_32x32x16_bf16 v[132:147], a[224:227], v[80:83], v[132:147]
    ds_read_b128 a[240:243], v1 offset:4096
    s_add_u32 s10, s55, 65536
    s_mov_b32 m0, s10
    s_add_u32 s11, s8, 114688
    buffer_load_dwordx4 v1, s[44:47], s11 offen offset:0 lds
    s_waitcnt lgkmcnt(3)
    v_mfma_f32_32x32x16_bf16 v[148:163], a[228:231], v[80:83], v[148:163]
    s_barrier
    ds_read_b128 a[244:247], v1 offset:5120
    s_waitcnt lgkmcnt(3)
    v_mfma_f32_32x32x16_bf16 v[164:179], a[232:235], v[80:83], v[164:179]
    ds_read_b128 a[248:251], v1 offset:6144
    buffer_load_dwordx4 v1, s[44:47], s11 offen offset:1024 lds
    s_waitcnt vmcnt(23) lgkmcnt(3)
    v_mfma_f32_32x32x16_bf16 v[132:147], a[236:239], v[84:87], v[132:147]
    ds_read_b128 a[252:255], v1 offset:7168
    s_waitcnt lgkmcnt(3)
    v_mfma_f32_32x32x16_bf16 v[148:163], a[240:243], v[84:87], v[148:163]
    ds_read_b128 a[224:227], v1 offset:8192
    buffer_load_dwordx4 v1, s[44:47], s11 offen offset:2048 lds
    s_waitcnt lgkmcnt(3)
    v_mfma_f32_32x32x16_bf16 v[164:179], a[244:247], v[84:87], v[164:179]
    ds_read_b128 a[228:231], v1 offset:9216
    s_waitcnt vmcnt(23) lgkmcnt(3)
    v_mfma_f32_32x32x16_bf16 v[132:147], a[248:251], v[88:91], v[132:147]
    ds_read_b128 a[232:235], v1 offset:10240
    buffer_load_dwordx4 v1, s[44:47], s11 offen offset:3072 lds
    s_waitcnt lgkmcnt(3)
    v_mfma_f32_32x32x16_bf16 v[148:163], a[252:255], v[88:91], v[148:163]
    ds_read_b128 a[236:239], v1 offset:11264
    s_waitcnt lgkmcnt(3)
    v_mfma_f32_32x32x16_bf16 v[164:179], a[224:227], v[88:91], v[164:179]
    ds_read_b128 a[240:243], v1 offset:12288
    s_add_u32 s10, s55, 81920
    s_mov_b32 m0, s10
    s_add_u32 s11, s8, 131072
    buffer_load_dwordx4 v1, s[44:47], s11 offen offset:0 lds
    s_waitcnt vmcnt(24) lgkmcnt(3)
    v_mfma_f32_32x32x16_bf16 v[132:147], a[228:231], v[92:95], v[132:147]
    ds_read_b128 a[244:247], v1 offset:13312
    s_waitcnt vmcnt(22)
    v_add_f32 v244, v244, v246
    v_add_f32 v245, v245, v247
    s_waitcnt vmcnt(21)
    v_add_f32 v244, v244, v248
    s_waitcnt lgkmcnt(3)
    v_mfma_f32_32x32x16_bf16 v[148:163], a[232:235], v[92:95], v[148:163]
    ds_read_b128 a[248:251], v1 offset:14336
    buffer_load_dwordx4 v1, s[44:47], s11 offen offset:1024 lds
    v_add_f32 v245, v245, v249
    s_waitcnt vmcnt(21)
    v_add_f32 v244, v244, v250
    v_add_f32 v245, v245, v251
    s_waitcnt lgkmcnt(3)
    v_mfma_f32_32x32x16_bf16 v[164:179], a[236:239], v[92:95], v[164:179]
    ds_read_b128 a[252:255], v1 offset:15360
    s_waitcnt vmcnt(20)
    v_add_f32 v244, v244, v252
    v_add_f32 v245, v245, v253
    s_waitcnt vmcnt(19)
    v_add_f32 v244, v244, v254
    s_waitcnt vmcnt(17) lgkmcnt(3)
    v_mfma_f32_32x32x16_bf16 v[132:147], a[240:243], v[96:99], v[132:147]
    ds_read_b128 a[224:227], v1 offset:16384
    buffer_load_dwordx4 v1, s[44:47], s11 offen offset:2048 lds
    v_add_f32 v245, v245, v255
    v_add_f32 v4, v244, v10
    v_add_f32 v5, v245, v11
    s_waitcnt lgkmcnt(3)
    v_mfma_f32_32x32x16_bf16 v[148:163], a[244:247], v[96:99], v[148:163]
    ds_read_b128 a[228:231], v1 offset:17408
    v_mov_b32 v6, v4
    s_nop 1
    v_permlane32_swap_b32 v4, v6
    v_add_f32 v4, v4, v6
    s_waitcnt lgkmcnt(3)
    v_mfma_f32_32x32x16_bf16 v[164:179], a[248:251], v[96:99], v[164:179]
    ds_read_b128 a[232:235], v1 offset:18432
    buffer_load_dwordx4 v1, s[44:47], s11 offen offset:3072 lds
    v_mov_b32 v6, v5
    s_nop 1
    v_permlane32_swap_b32 v5, v6
    v_add_f32 v5, v5, v6
    s_waitcnt vmcnt(18) lgkmcnt(3)
    v_mfma_f32_32x32x16_bf16 v[132:147], a[252:255], v[100:103], v[132:147]
    ds_read_b128 a[236:239], v1 offset:19456
    v_mul_f32 v4, 0xbb124925, v4
    v_mul_f32 v5, 0x3b124925, v5
    v_fma_f32 v5, -v4, v4, v5
    s_waitcnt lgkmcnt(3)
    v_mfma_f32_32x32x16_bf16 v[148:163], a[224:227], v[100:103], v[148:163]
    ds_read_b128 a[240:243], v1 offset:20480
    s_add_u32 s10, s55, 98304
    s_mov_b32 m0, s10
    s_add_u32 s11, s8, 147456
    buffer_load_dwordx4 v1, s[44:47], s11 offen offset:0 lds
    v_max_f32 v5, 0, v5
    v_add_f32 v5, 0x3727c5ac, v5
    v_rcp_f32 v5, v5
    s_waitcnt lgkmcnt(3)
    v_mfma_f32_32x32x16_bf16 v[164:179], a[228:231], v[100:103], v[164:179]
    ds_read_b128 a[244:247], v1 offset:21504
    v_cvt_pk_bf16_f32 v128, v4, v4
    v_lshlrev_b32 v6, 16, v128
    v_sub_f32 v6, v4, v6
    s_waitcnt vmcnt(18) lgkmcnt(3)
    v_mfma_f32_32x32x16_bf16 v[132:147], a[232:235], v[104:107], v[132:147]
    ds_read_b128 a[248:251], v1 offset:22528
    buffer_load_dwordx4 v1, s[44:47], s11 offen offset:1024 lds
    v_cvt_pk_bf16_f32 v129, v6, v6
    v_mov_b32 v130, v128
    v_mov_b32 v131, v129
    s_waitcnt lgkmcnt(3)
    v_mfma_f32_32x32x16_bf16 v[148:163], a[236:239], v[104:107], v[148:163]
    ds_read_b128 a[252:255], v1 offset:23552
    v_lshrrev_b32 v6, 1, v8
    s_lshl_b32 s15, s48, 7
    s_add_u32 s15, s15, 65536
    s_waitcnt lgkmcnt(3)
    v_mfma_f32_32x32x16_bf16 v[164:179], a[240:243], v[104:107], v[164:179]
    ds_read_b128 a[224:227], v1 offset:24576
    buffer_load_dwordx4 v1, s[44:47], s11 offen offset:2048 lds
    buffer_store_dword v5, v6, s[44:47], s15 offen sc1
    s_waitcnt vmcnt(20) lgkmcnt(3)
    v_mfma_f32_32x32x16_bf16 v[132:147], a[244:247], v[108:111], v[132:147]
    ds_read_b128 a[228:231], v1 offset:25600
    s_waitcnt lgkmcnt(3)
    v_mfma_f32_32x32x16_bf16 v[148:163], a[248:251], v[108:111], v[148:163]
    ds_read_b128 a[232:235], v1 offset:26624
    buffer_load_dwordx4 v1, s[44:47], s11 offen offset:3072 lds
    s_waitcnt lgkmcnt(3)
    v_mfma_f32_32x32x16_bf16 v[164:179], a[252:255], v[108:111], v[164:179]
    ds_read_b128 a[236:239], v1 offset:27648
    s_waitcnt vmcnt(20) lgkmcnt(3)
    v_mfma_f32_32x32x16_bf16 v[132:147], a[224:227], v[112:115], v[132:147]
    ds_read_b128 a[240:243], v1 offset:28672
    s_add_u32 s10, s55, 114688
    s_mov_b32 m0, s10
    s_add_u32 s11, s8, 163840
    buffer_load_dwordx4 v1, s[44:47], s11 offen offset:0 lds
    s_waitcnt lgkmcnt(3)
    v_mfma_f32_32x32x16_bf16 v[148:163], a[228:231], v[112:115], v[148:163]
    ds_read_b128 a[244:247], v1 offset:29696
    s_waitcnt lgkmcnt(3)
    v_mfma_f32_32x32x16_bf16 v[164:179], a[232:235], v[112:115], v[164:179]
    ds_read_b128 a[248:251], v1 offset:30720
    buffer_load_dwordx4 v1, s[44:47], s11 offen offset:1024 lds
    s_waitcnt vmcnt(21) lgkmcnt(3)
    v_mfma_f32_32x32x16_bf16 v[132:147], a[236:239], v[116:119], v[132:147]
    ds_read_b128 a[252:255], v1 offset:31744
    s_waitcnt lgkmcnt(3)
    v_mfma_f32_32x32x16_bf16 v[148:163], a[240:243], v[116:119], v[148:163]
    ds_read_b128 a[224:227], v1 offset:32768
    buffer_load_dwordx4 v1, s[44:47], s11 offen offset:2048 lds
    s_waitcnt lgkmcnt(3)
    v_mfma_f32_32x32x16_bf16 v[164:179], a[244:247], v[116:119], v[164:179]
    ds_read_b128 a[228:231], v1 offset:33792
    s_waitcnt vmcnt(21) lgkmcnt(3)
    v_mfma_f32_32x32x16_bf16 v[132:147], a[248:251], v[120:123], v[132:147]
    ds_read_b128 a[232:235], v1 offset:34816
    buffer_load_dwordx4 v1, s[44:47], s11 offen offset:3072 lds
    s_waitcnt lgkmcnt(3)
    v_mfma_f32_32x32x16_bf16 v[148:163], a[252:255], v[120:123], v[148:163]
    ds_read_b128 a[236:239], v1 offset:35840
    s_waitcnt lgkmcnt(3)
    v_mfma_f32_32x32x16_bf16 v[164:179], a[224:227], v[120:123], v[164:179]
    ds_read_b128 a[240:243], v1 offset:36864
    s_add_u32 s10, s55, 131072
    s_mov_b32 m0, s10
    s_add_u32 s11, s8, 180224
    buffer_load_dwordx4 v1, s[44:47], s11 offen offset:0 lds
    s_waitcnt vmcnt(22) lgkmcnt(3)
    v_mfma_f32_32x32x16_bf16 v[132:147], a[228:231], v[124:127], v[132:147]
    ds_read_b128 a[244:247], v1 offset:37888
    s_waitcnt lgkmcnt(3)
    v_mfma_f32_32x32x16_bf16 v[148:163], a[232:235], v[124:127], v[148:163]
    ds_read_b128 a[248:251], v1 offset:38912
    buffer_load_dwordx4 v1, s[44:47], s11 offen offset:1024 lds
    s_waitcnt lgkmcnt(3)
    v_mfma_f32_32x32x16_bf16 v[164:179], a[236:239], v[124:127], v[164:179]
    ds_read_b128 a[252:255], v1 offset:39936
    s_waitcnt lgkmcnt(3)
    v_mfma_f32_32x32x16_bf16 v[132:147], a[240:243], v[128:131], v[132:147]
    ds_read_b128 a[224:227], v1 offset:40960
    buffer_load_dwordx4 v1, s[44:47], s11 offen offset:2048 lds
    s_waitcnt lgkmcnt(3)
    v_mfma_f32_32x32x16_bf16 v[148:163], a[244:247], v[128:131], v[148:163]
    ds_read_b128 a[228:231], v1 offset:41984
    s_waitcnt lgkmcnt(3)
    v_mfma_f32_32x32x16_bf16 v[164:179], a[248:251], v[128:131], v[164:179]
    ds_read_b128 a[232:235], v1 offset:43008
    buffer_load_dwordx4 v1, s[44:47], s11 offen offset:3072 lds
    s_waitcnt lgkmcnt(3)
    v_mfma_f32_32x32x16_bf16 v[180:195], a[252:255], v[16:19], 0
    ds_read_b128 a[236:239], v1 offset:44032
    s_waitcnt lgkmcnt(3)
    v_mfma_f32_32x32x16_bf16 v[196:211], a[224:227], v[16:19], 0
    ds_read_b128 a[240:243], v1 offset:45056
    s_add_u32 s10, s55, 147456
    s_mov_b32 m0, s10
    s_add_u32 s11, s8, 196608
    buffer_load_dwordx4 v1, s[44:47], s11 offen offset:0 lds
    v_max_f32 v132, 0, v132
    v_max_f32 v133, 0, v133
    v_max_f32 v134, 0, v134
    s_waitcnt lgkmcnt(3)
    v_mfma_f32_32x32x16_bf16 v[180:195], a[228:231], v[20:23], v[180:195]
    ds_read_b128 a[244:247], v1 offset:46080
    v_max_f32 v135, 0, v135
    v_max_f32 v136, 0, v136
    v_max_f32 v137, 0, v137
    s_waitcnt lgkmcnt(3)
    v_mfma_f32_32x32x16_bf16 v[196:211], a[232:235], v[20:23], v[196:211]
    ds_read_b128 a[248:251], v1 offset:47104
    buffer_load_dwordx4 v1, s[44:47], s11 offen offset:1024 lds
    v_max_f32 v138, 0, v138
    v_max_f32 v139, 0, v139
    v_mul_f32 v132, v132, v140
    s_waitcnt lgkmcnt(3)
    v_mfma_f32_32x32x16_bf16 v[180:195], a[236:239], v[24:27], v[180:195]
    ds_read_b128 a[252:255], v1 offset:48128
    v_mul_f32 v133, v133, v141
    v_mul_f32 v134, v134, v142
    v_mul_f32 v135, v135, v143
    s_waitcnt lgkmcnt(3)
    v_mfma_f32_32x32x16_bf16 v[196:211], a[240:243], v[24:27], v[196:211]
    s_waitcnt vmcnt(23)
    s_barrier
    ds_read_b128 a[224:227], v1 offset:49152
    buffer_load_dwordx4 v1, s[44:47], s11 offen offset:2048 lds
    v_mul_f32 v136, v136, v144
    v_mul_f32 v137, v137, v145
    v_mul_f32 v138, v138, v146
    s_waitcnt lgkmcnt(3)
    v_mfma_f32_32x32x16_bf16 v[180:195], a[244:247], v[28:31], v[180:195]
    ds_read_b128 a[228:231], v1 offset:50176
    v_mul_f32 v139, v139, v147
    v_cvt_pk_bf16_f32 v140, v132, v133
    v_cvt_pk_bf16_f32 v141, v134, v135
    s_waitcnt lgkmcnt(3)
    v_mfma_f32_32x32x16_bf16 v[196:211], a[248:251], v[28:31], v[196:211]
    ds_read_b128 a[232:235], v1 offset:51200
    buffer_load_dwordx4 v1, s[44:47], s11 offen offset:3072 lds
    v_cvt_pk_bf16_f32 v142, v136, v137
    v_cvt_pk_bf16_f32 v143, v138, v139
    buffer_store_dwordx4 v[140:143], v1, s[44:47], s13 offen offset:0 sc1
    s_waitcnt lgkmcnt(3)
    v_mfma_f32_32x32x16_bf16 v[180:195], a[252:255], v[32:35], v[180:195]
    ds_read_b128 a[236:239], v1 offset:52224
    v_max_f32 v148, 0, v148
    v_max_f32 v149, 0, v149
    v_max_f32 v150, 0, v150
    s_waitcnt lgkmcnt(3)
    v_mfma_f32_32x32x16_bf16 v[196:211], a[224:227], v[32:35], v[196:211]
    ds_read_b128 a[240:243], v1 offset:53248
    s_add_u32 s63, s59, 32768
    buffer_load_dwordx4 a[140:143], v1, s[44:47], s63 offen offset:2048
    v_max_f32 v151, 0, v151
    v_max_f32 v152, 0, v152
    v_max_f32 v153, 0, v153
    s_waitcnt lgkmcnt(3)
    v_mfma_f32_32x32x16_bf16 v[180:195], a[228:231], v[36:39], v[180:195]
    ds_read_b128 a[244:247], v1 offset:54272
    v_max_f32 v154, 0, v154
    v_max_f32 v155, 0, v155
    v_mul_f32 v148, v148, v156
    s_waitcnt lgkmcnt(3)
    v_mfma_f32_32x32x16_bf16 v[196:211], a[232:235], v[36:39], v[196:211]
    ds_read_b128 a[248:251], v1 offset:55296
    s_add_u32 s63, s58, 36864
    buffer_load_dwordx4 a[144:147], v1, s[44:47], s63 offen offset:0
    v_mul_f32 v149, v149, v157
    v_mul_f32 v150, v150, v158
    v_mul_f32 v151, v151, v159
    s_waitcnt lgkmcnt(3)
    v_mfma_f32_32x32x16_bf16 v[180:195], a[236:239], v[40:43], v[180:195]
    ds_read_b128 a[252:255], v1 offset:56320
    v_mul_f32 v152, v152, v160
    v_mul_f32 v153, v153, v161
    v_mul_f32 v154, v154, v162
    s_waitcnt lgkmcnt(3)
    v_mfma_f32_32x32x16_bf16 v[196:211], a[240:243], v[40:43], v[196:211]
    ds_read_b128 a[224:227], v1 offset:57344
    s_add_u32 s63, s59, 36864
    buffer_load_dwordx4 a[148:151], v1, s[44:47], s63 offen offset:0
    v_mul_f32 v155, v155, v163
    v_cvt_pk_bf16_f32 v156, v148, v149
    v_cvt_pk_bf16_f32 v157, v150, v151
    s_waitcnt lgkmcnt(3)
    v_mfma_f32_32x32x16_bf16 v[180:195], a[244:247], v[44:47], v[180:195]
    ds_read_b128 a[228:231], v1 offset:58368
    v_cvt_pk_bf16_f32 v158, v152, v153
    v_cvt_pk_bf16_f32 v159, v154, v155
    buffer_store_dwordx4 v[156:159], v1, s[44:47], s13 offen offset:1024 sc1
    s_waitcnt lgkmcnt(3)
    v_mfma_f32_32x32x16_bf16 v[196:211], a[248:251], v[44:47], v[196:211]
    ds_read_b128 a[232:235], v1 offset:59392
    s_add_u32 s63, s58, 49152
    buffer_load_dwordx4 a[192:195], v1, s[44:47], s63 offen offset:0
    v_max_f32 v164, 0, v164
    v_max_f32 v165, 0, v165
    v_max_f32 v166, 0, v166
    s_waitcnt lgkmcnt(3)
    v_mfma_f32_32x32x16_bf16 v[180:195], a[252:255], v[48:51], v[180:195]
    ds_read_b128 a[236:239], v1 offset:60416
    v_max_f32 v167, 0, v167
    v_max_f32 v168, 0, v168
    v_max_f32 v169, 0, v169
    s_waitcnt lgkmcnt(3)
    v_mfma_f32_32x32x16_bf16 v[196:211], a[224:227], v[48:51], v[196:211]
    ds_read_b128 a[240:243], v1 offset:61440
    s_add_u32 s63, s59, 49152
    buffer_load_dwordx4 a[196:199], v1, s[44:47], s63 offen offset:0
    v_max_f32 v170, 0, v170
    v_max_f32 v171, 0, v171
    v_mul_f32 v164, v164, v172
    s_waitcnt lgkmcnt(3)
    v_mfma_f32_32x32x16_bf16 v[180:195], a[228:231], v[52:55], v[180:195]
    ds_read_b128 a[244:247], v1 offset:62464
    v_mul_f32 v165, v165, v173
    v_mul_f32 v166, v166, v174
    v_mul_f32 v167, v167, v175
    s_waitcnt lgkmcnt(3)
    v_mfma_f32_32x32x16_bf16 v[196:211], a[232:235], v[52:55], v[196:211]
    ds_read_b128 a[248:251], v1 offset:63488
    s_add_u32 s63, s58, 49152
    buffer_load_dwordx4 a[200:203], v1, s[44:47], s63 offen offset:2048
    v_mul_f32 v168, v168, v176
    v_mul_f32 v169, v169, v177
    v_mul_f32 v170, v170, v178
    s_waitcnt lgkmcnt(3)
    v_mfma_f32_32x32x16_bf16 v[180:195], a[236:239], v[56:59], v[180:195]
    ds_read_b128 a[252:255], v1 offset:64512
    v_mul_f32 v171, v171, v179
    v_cvt_pk_bf16_f32 v172, v164, v165
    v_cvt_pk_bf16_f32 v173, v166, v167
    s_waitcnt lgkmcnt(3)
    v_mfma_f32_32x32x16_bf16 v[196:211], a[240:243], v[56:59], v[196:211]
    s_waitcnt vmcnt(29)
    s_barrier
    ds_read_b128 a[224:227], v2 offset:0
    s_add_u32 s63, s59, 49152
    buffer_load_dwordx4 a[204:207], v1, s[44:47], s63 offen offset:2048
    v_cvt_pk_bf16_f32 v174, v168, v169
    v_cvt_pk_bf16_f32 v175, v170, v171
    buffer_store_dwordx4 v[172:175], v1, s[44:47], s13 offen offset:2048 sc1
    s_waitcnt lgkmcnt(3)
    v_mfma_f32_32x32x16_bf16 v[180:195], a[244:247], v[60:63], v[180:195]
    ds_read_b128 a[228:231], v2 offset:1024
    s_waitcnt lgkmcnt(3)
    v_mfma_f32_32x32x16_bf16 v[196:211], a[248:251], v[60:63], v[196:211]
    ds_read_b128 a[232:235], v2 offset:2048
    s_add_u32 s63, s58, 8192
    buffer_load_dwordx4 a[40:43], v1, s[44:47], s63 offen offset:2048
    s_waitcnt lgkmcnt(3)
    v_mfma_f32_32x32x16_bf16 v[180:195], a[252:255], v[64:67], v[180:195]
    ds_read_b128 a[236:239], v2 offset:3072
    s_waitcnt lgkmcnt(3)
    v_mfma_f32_32x32x16_bf16 v[196:211], a[224:227], v[64:67], v[196:211]
    ds_read_b128 a[240:243], v2 offset:4096
    s_add_u32 s63, s59, 8192
    buffer_load_dwordx4 a[44:47], v1, s[44:47], s63 offen offset:2048
    s_waitcnt lgkmcnt(3)
    v_mfma_f32_32x32x16_bf16 v[180:195], a[228:231], v[68:71], v[180:195]
    ds_read_b128 a[244:247], v2 offset:5120
    s_waitcnt lgkmcnt(3)
    v_mfma_f32_32x32x16_bf16 v[196:211], a[232:235], v[68:71], v[196:211]
    ds_read_b128 a[248:251], v2 offset:6144
    s_add_u32 s63, s58, 12288
    buffer_load_dwordx4 a[48:51], v1, s[44:47], s63 offen offset:0
    s_waitcnt lgkmcnt(3)
    v_mfma_f32_32x32x16_bf16 v[180:195], a[236:239], v[72:75], v[180:195]
    ds_read_b128 a[252:255], v2 offset:7168
    s_waitcnt lgkmcnt(3)
    v_mfma_f32_32x32x16_bf16 v[196:211], a[240:243], v[72:75], v[196:211]
    ds_read_b128 a[224:227], v2 offset:8192
    s_add_u32 s63, s59, 12288
    buffer_load_dwordx4 a[52:55], v1, s[44:47], s63 offen offset:0
    s_waitcnt lgkmcnt(3)
    v_mfma_f32_32x32x16_bf16 v[180:195], a[244:247], v[76:79], v[180:195]
    ds_read_b128 a[228:231], v2 offset:9216
    s_waitcnt lgkmcnt(3)
    v_mfma_f32_32x32x16_bf16 v[196:211], a[248:251], v[76:79], v[196:211]
    ds_read_b128 a[232:235], v2 offset:10240
    s_add_u32 s63, s58, 24576
    buffer_load_dwordx4 a[96:99], v1, s[44:47], s63 offen offset:0
    s_waitcnt lgkmcnt(3)
    v_mfma_f32_32x32x16_bf16 v[180:195], a[252:255], v[80:83], v[180:195]
    ds_read_b128 a[236:239], v2 offset:11264
    s_waitcnt lgkmcnt(3)
    v_mfma_f32_32x32x16_bf16 v[196:211], a[224:227], v[80:83], v[196:211]
    ds_read_b128 a[240:243], v2 offset:12288
    s_add_u32 s63, s59, 24576
    buffer_load_dwordx4 a[100:103], v1, s[44:47], s63 offen offset:0
    s_waitcnt lgkmcnt(3)
    v_mfma_f32_32x32x16_bf16 v[180:195], a[228:231], v[84:87], v[180:195]
    ds_read_b128 a[244:247], v2 offset:13312
    s_waitcnt lgkmcnt(3)
    v_mfma_f32_32x32x16_bf16 v[196:211], a[232:235], v[84:87], v[196:211]
    ds_read_b128 a[248:251], v2 offset:14336
    s_add_u32 s63, s58, 24576
    buffer_load_dwordx4 a[104:107], v1, s[44:47], s63 offen offset:2048
    s_waitcnt lgkmcnt(3)
    v_mfma_f32_32x32x16_bf16 v[180:195], a[236:239], v[88:91], v[180:195]
    ds_read_b128 a[252:255], v2 offset:15360
    s_waitcnt lgkmcnt(3)
    v_mfma_f32_32x32x16_bf16 v[196:211], a[240:243], v[88:91], v[196:211]
    s_waitcnt vmcnt(34)
    s_barrier
    ds_read_b128 a[224:227], v2 offset:16384
    s_add_u32 s63, s59, 24576
    buffer_load_dwordx4 a[108:111], v1, s[44:47], s63 offen offset:2048
    s_waitcnt lgkmcnt(3)
    v_mfma_f32_32x32x16_bf16 v[180:195], a[244:247], v[92:95], v[180:195]
    ds_read_b128 a[228:231], v2 offset:17408
    s_waitcnt lgkmcnt(3)
    v_mfma_f32_32x32x16_bf16 v[196:211], a[248:251], v[92:95], v[196:211]
    ds_read_b128 a[232:235], v2 offset:18432
    s_add_u32 s63, s58, 36864
    buffer_load_dwordx4 a[152:155], v1, s[44:47], s63 offen offset:2048
    s_waitcnt lgkmcnt(3)
    v_mfma_f32_32x32x16_bf16 v[180:195], a[252:255], v[96:99], v[180:195]
    ds_read_b128 a[236:239], v2 offset:19456
    s_waitcnt lgkmcnt(3)
    v_mfma_f32_32x32x16_bf16 v[196:211], a[224:227], v[96:99], v[196:211]
    ds_read_b128 a[240:243], v2 offset:20480
    s_add_u32 s63, s59, 36864
    buffer_load_dwordx4 a[156:159], v1, s[44:47], s63 offen offset:2048
    s_waitcnt lgkmcnt(3)
    v_mfma_f32_32x32x16_bf16 v[180:195], a[228:231], v[100:103], v[180:195]
    ds_read_b128 a[244:247], v2 offset:21504
    s_waitcnt lgkmcnt(3)
    v_mfma_f32_32x32x16_bf16 v[196:211], a[232:235], v[100:103], v[196:211]
    ds_read_b128 a[248:251], v2 offset:22528
    s_add_u32 s63, s58, 40960
    buffer_load_dwordx4 a[160:163], v1, s[44:47], s63 offen offset:0
    s_waitcnt lgkmcnt(3)
    v_mfma_f32_32x32x16_bf16 v[180:195], a[236:239], v[104:107], v[180:195]
    ds_read_b128 a[252:255], v2 offset:23552
    s_waitcnt lgkmcnt(3)
    v_mfma_f32_32x32x16_bf16 v[196:211], a[240:243], v[104:107], v[196:211]
    ds_read_b128 a[224:227], v2 offset:24576
    s_add_u32 s63, s59, 40960
    buffer_load_dwordx4 a[164:167], v1, s[44:47], s63 offen offset:0
    s_lshl_b32 s15, s48, 6
    s_lshl_b32 s61, s49, 2
    s_add_u32 s15, s15, s61
    s_add_u32 s15, s15, 32768
    s_waitcnt vmcnt(12)
    s_mov_b64 exec, 1
    buffer_store_dword v15, v1, s[44:47], s15 offen
    s_mov_b64 exec, -1
    s_waitcnt lgkmcnt(3)
    v_mfma_f32_32x32x16_bf16 v[180:195], a[244:247], v[108:111], v[180:195]
    ds_read_b128 a[228:231], v2 offset:25600
    s_waitcnt lgkmcnt(3)
    v_mfma_f32_32x32x16_bf16 v[196:211], a[248:251], v[108:111], v[196:211]
    ds_read_b128 a[232:235], v2 offset:26624
    s_add_u32 s63, s58, 53248
    buffer_load_dwordx4 a[208:211], v1, s[44:47], s63 offen offset:0
    s_waitcnt lgkmcnt(3)
    v_mfma_f32_32x32x16_bf16 v[180:195], a[252:255], v[112:115], v[180:195]
    ds_read_b128 a[236:239], v2 offset:27648
    s_waitcnt lgkmcnt(3)
    v_mfma_f32_32x32x16_bf16 v[196:211], a[224:227], v[112:115], v[196:211]
    ds_read_b128 a[240:243], v2 offset:28672
    s_add_u32 s63, s59, 53248
    buffer_load_dwordx4 a[212:215], v1, s[44:47], s63 offen offset:0
    s_waitcnt lgkmcnt(3)
    v_mfma_f32_32x32x16_bf16 v[180:195], a[228:231], v[116:119], v[180:195]
    ds_read_b128 a[244:247], v2 offset:29696
    s_waitcnt lgkmcnt(3)
    v_mfma_f32_32x32x16_bf16 v[196:211], a[232:235], v[116:119], v[196:211]
    ds_read_b128 a[248:251], v2 offset:30720
    s_add_u32 s63, s58, 53248
    buffer_load_dwordx4 a[216:219], v1, s[44:47], s63 offen offset:2048
    s_waitcnt lgkmcnt(3)
    v_mfma_f32_32x32x16_bf16 v[180:195], a[236:239], v[120:123], v[180:195]
    ds_read_b128 a[252:255], v2 offset:31744
    s_waitcnt lgkmcnt(3)
    v_mfma_f32_32x32x16_bf16 v[196:211], a[240:243], v[120:123], v[196:211]
    s_barrier
    ds_read_b128 a[224:227], v2 offset:32768
    s_add_u32 s63, s59, 53248
    buffer_load_dwordx4 a[220:223], v1, s[44:47], s63 offen offset:2048
    s_waitcnt lgkmcnt(3)
    v_mfma_f32_32x32x16_bf16 v[180:195], a[244:247], v[124:127], v[180:195]
    ds_read_b128 a[228:231], v2 offset:33792
    s_waitcnt lgkmcnt(3)
    v_mfma_f32_32x32x16_bf16 v[196:211], a[248:251], v[124:127], v[196:211]
    ds_read_b128 a[232:235], v2 offset:34816
    s_waitcnt lgkmcnt(3)
    v_mfma_f32_32x32x16_bf16 v[180:195], a[252:255], v[128:131], v[180:195]
    ds_read_b128 a[236:239], v2 offset:35840
    s_waitcnt lgkmcnt(3)
    v_mfma_f32_32x32x16_bf16 v[196:211], a[224:227], v[128:131], v[196:211]
    ds_read_b128 a[240:243], v2 offset:36864
    s_waitcnt lgkmcnt(3)
    v_mfma_f32_32x32x16_bf16 v[212:227], a[228:231], v[16:19], 0
    ds_read_b128 a[244:247], v2 offset:37888
    s_waitcnt lgkmcnt(3)
    v_mfma_f32_32x32x16_bf16 v[228:243], a[232:235], v[16:19], 0
    ds_read_b128 a[248:251], v2 offset:38912
    s_nop 1
    v_max_f32 v180, 0, v180
    v_max_f32 v181, 0, v181
    v_max_f32 v182, 0, v182
    s_waitcnt lgkmcnt(3)
    v_mfma_f32_32x32x16_bf16 v[212:227], a[236:239], v[20:23], v[212:227]
    ds_read_b128 a[252:255], v2 offset:39936
    v_max_f32 v183, 0, v183
    v_max_f32 v184, 0, v184
    v_max_f32 v185, 0, v185
    s_waitcnt lgkmcnt(3)
    v_mfma_f32_32x32x16_bf16 v[228:243], a[240:243], v[20:23], v[228:243]
    ds_read_b128 a[224:227], v2 offset:40960
    v_max_f32 v186, 0, v186
    v_max_f32 v187, 0, v187
    v_mul_f32 v180, v180, v188
    s_waitcnt lgkmcnt(3)
    v_mfma_f32_32x32x16_bf16 v[212:227], a[244:247], v[24:27], v[212:227]
    ds_read_b128 a[228:231], v2 offset:41984
    v_mul_f32 v181, v181, v189
    v_mul_f32 v182, v182, v190
    v_mul_f32 v183, v183, v191
    s_waitcnt lgkmcnt(3)
    v_mfma_f32_32x32x16_bf16 v[228:243], a[248:251], v[24:27], v[228:243]
    ds_read_b128 a[232:235], v2 offset:43008
    v_mul_f32 v184, v184, v192
    v_mul_f32 v185, v185, v193
    v_mul_f32 v186, v186, v194
    s_waitcnt lgkmcnt(3)
    v_mfma_f32_32x32x16_bf16 v[212:227], a[252:255], v[28:31], v[212:227]
    ds_read_b128 a[236:239], v2 offset:44032
    v_mul_f32 v187, v187, v195
    v_cvt_pk_bf16_f32 v188, v180, v181
    v_cvt_pk_bf16_f32 v189, v182, v183
    s_waitcnt lgkmcnt(3)
    v_mfma_f32_32x32x16_bf16 v[228:243], a[224:227], v[28:31], v[228:243]
    ds_read_b128 a[240:243], v2 offset:45056
    v_cvt_pk_bf16_f32 v190, v184, v185
    v_cvt_pk_bf16_f32 v191, v186, v187
    buffer_store_dwordx4 v[188:191], v1, s[44:47], s13 offen offset:3072 sc1
    s_waitcnt lgkmcnt(3)
    v_mfma_f32_32x32x16_bf16 v[212:227], a[228:231], v[32:35], v[212:227]
    ds_read_b128 a[244:247], v2 offset:46080
    v_max_f32 v196, 0, v196
    v_max_f32 v197, 0, v197
    v_max_f32 v198, 0, v198
    s_waitcnt lgkmcnt(3)
    v_mfma_f32_32x32x16_bf16 v[228:243], a[232:235], v[32:35], v[228:243]
    ds_read_b128 a[248:251], v2 offset:47104
    v_max_f32 v199, 0, v199
    v_max_f32 v200, 0, v200
    v_max_f32 v201, 0, v201
    s_waitcnt lgkmcnt(3)
    v_mfma_f32_32x32x16_bf16 v[212:227], a[236:239], v[36:39], v[212:227]
    ds_read_b128 a[252:255], v2 offset:48128
    v_max_f32 v202, 0, v202
    v_max_f32 v203, 0, v203
    v_mul_f32 v196, v196, v204
    s_waitcnt lgkmcnt(3)
    v_mfma_f32_32x32x16_bf16 v[228:243], a[240:243], v[36:39], v[228:243]
    s_barrier
    ds_read_b128 a[224:227], v2 offset:49152
    v_mul_f32 v197, v197, v205
    v_mul_f32 v198, v198, v206
    v_mul_f32 v199, v199, v207
    s_waitcnt lgkmcnt(3)
    v_mfma_f32_32x32x16_bf16 v[212:227], a[244:247], v[40:43], v[212:227]
    ds_read_b128 a[228:231], v2 offset:50176
    v_mul_f32 v200, v200, v208
    v_mul_f32 v201, v201, v209
    v_mul_f32 v202, v202, v210
    s_waitcnt lgkmcnt(3)
    v_mfma_f32_32x32x16_bf16 v[228:243], a[248:251], v[40:43], v[228:243]
    ds_read_b128 a[232:235], v2 offset:51200
    v_mul_f32 v203, v203, v211
    v_cvt_pk_bf16_f32 v204, v196, v197
    v_cvt_pk_bf16_f32 v205, v198, v199
    s_waitcnt lgkmcnt(3)
    v_mfma_f32_32x32x16_bf16 v[212:227], a[252:255], v[44:47], v[212:227]
    ds_read_b128 a[236:239], v2 offset:52224
    v_cvt_pk_bf16_f32 v206, v200, v201
    v_cvt_pk_bf16_f32 v207, v202, v203
    buffer_store_dwordx4 v[204:207], v1, s[44:47], s14 offen offset:0 sc1
    s_waitcnt lgkmcnt(3)
    v_mfma_f32_32x32x16_bf16 v[228:243], a[224:227], v[44:47], v[228:243]
    ds_read_b128 a[240:243], v2 offset:53248
    s_waitcnt lgkmcnt(3)
    v_mfma_f32_32x32x16_bf16 v[212:227], a[228:231], v[48:51], v[212:227]
    ds_read_b128 a[244:247], v2 offset:54272
    s_waitcnt lgkmcnt(3)
    v_mfma_f32_32x32x16_bf16 v[228:243], a[232:235], v[48:51], v[228:243]
    ds_read_b128 a[248:251], v2 offset:55296
    s_waitcnt lgkmcnt(3)
    v_mfma_f32_32x32x16_bf16 v[212:227], a[236:239], v[52:55], v[212:227]
    ds_read_b128 a[252:255], v2 offset:56320
    s_waitcnt lgkmcnt(3)
    v_mfma_f32_32x32x16_bf16 v[228:243], a[240:243], v[52:55], v[228:243]
    ds_read_b128 a[224:227], v2 offset:57344
    s_waitcnt lgkmcnt(3)
    v_mfma_f32_32x32x16_bf16 v[212:227], a[244:247], v[56:59], v[212:227]
    ds_read_b128 a[228:231], v2 offset:58368
    s_waitcnt lgkmcnt(3)
    v_mfma_f32_32x32x16_bf16 v[228:243], a[248:251], v[56:59], v[228:243]
    ds_read_b128 a[232:235], v2 offset:59392
    s_waitcnt lgkmcnt(3)
    v_mfma_f32_32x32x16_bf16 v[212:227], a[252:255], v[60:63], v[212:227]
    ds_read_b128 a[236:239], v2 offset:60416
    s_waitcnt lgkmcnt(3)
    v_mfma_f32_32x32x16_bf16 v[228:243], a[224:227], v[60:63], v[228:243]
    ds_read_b128 a[240:243], v2 offset:61440
    s_waitcnt lgkmcnt(3)
    v_mfma_f32_32x32x16_bf16 v[212:227], a[228:231], v[64:67], v[212:227]
    ds_read_b128 a[244:247], v2 offset:62464
    s_waitcnt lgkmcnt(3)
    v_mfma_f32_32x32x16_bf16 v[228:243], a[232:235], v[64:67], v[228:243]
    ds_read_b128 a[248:251], v2 offset:63488
    s_waitcnt lgkmcnt(3)
    v_mfma_f32_32x32x16_bf16 v[212:227], a[236:239], v[68:71], v[212:227]
    ds_read_b128 a[252:255], v2 offset:64512
    s_waitcnt lgkmcnt(3)
    v_mfma_f32_32x32x16_bf16 v[228:243], a[240:243], v[68:71], v[228:243]
    ds_read_b128 a[224:227], v3 offset:0
    s_waitcnt lgkmcnt(3)
    v_mfma_f32_32x32x16_bf16 v[212:227], a[244:247], v[72:75], v[212:227]
    ds_read_b128 a[228:231], v3 offset:1024
    s_waitcnt lgkmcnt(3)
    v_mfma_f32_32x32x16_bf16 v[228:243], a[248:251], v[72:75], v[228:243]
    ds_read_b128 a[232:235], v3 offset:2048
    s_waitcnt lgkmcnt(3)
    v_mfma_f32_32x32x16_bf16 v[212:227], a[252:255], v[76:79], v[212:227]
    ds_read_b128 a[236:239], v3 offset:3072
    s_waitcnt lgkmcnt(3)
    v_mfma_f32_32x32x16_bf16 v[228:243], a[224:227], v[76:79], v[228:243]
    ds_read_b128 a[240:243], v3 offset:4096
    s_waitcnt lgkmcnt(3)
    v_mfma_f32_32x32x16_bf16 v[212:227], a[228:231], v[80:83], v[212:227]
    ds_read_b128 a[244:247], v3 offset:5120
    s_waitcnt lgkmcnt(3)
    v_mfma_f32_32x32x16_bf16 v[228:243], a[232:235], v[80:83], v[228:243]
    ds_read_b128 a[248:251], v3 offset:6144
    s_waitcnt lgkmcnt(3)
    v_mfma_f32_32x32x16_bf16 v[212:227], a[236:239], v[84:87], v[212:227]
    ds_read_b128 a[252:255], v3 offset:7168
    s_waitcnt lgkmcnt(3)
    v_mfma_f32_32x32x16_bf16 v[228:243], a[240:243], v[84:87], v[228:243]
    ds_read_b128 a[224:227], v3 offset:8192
    s_waitcnt lgkmcnt(3)
    v_mfma_f32_32x32x16_bf16 v[212:227], a[244:247], v[88:91], v[212:227]
    ds_read_b128 a[228:231], v3 offset:9216
    s_waitcnt lgkmcnt(3)
    v_mfma_f32_32x32x16_bf16 v[228:243], a[248:251], v[88:91], v[228:243]
    ds_read_b128 a[232:235], v3 offset:10240
    s_waitcnt lgkmcnt(3)
    v_mfma_f32_32x32x16_bf16 v[212:227], a[252:255], v[92:95], v[212:227]
    ds_read_b128 a[236:239], v3 offset:11264
    s_lshl_b32 s15, s48, 6
    s_lshl_b32 s61, s49, 2
    s_add_u32 s15, s15, s61
    s_add_u32 s15, s15, 36864
    s_waitcnt vmcnt(0)
    s_mov_b64 exec, 1
    buffer_store_dword v15, v1, s[44:47], s15 offen
    s_mov_b64 exec, -1
    s_waitcnt lgkmcnt(3)
    v_mfma_f32_32x32x16_bf16 v[228:243], a[224:227], v[92:95], v[228:243]
    ds_read_b128 a[240:243], v3 offset:12288
    s_waitcnt lgkmcnt(3)
    v_mfma_f32_32x32x16_bf16 v[212:227], a[228:231], v[96:99], v[212:227]
    ds_read_b128 a[244:247], v3 offset:13312
    s_waitcnt lgkmcnt(3)
    v_mfma_f32_32x32x16_bf16 v[228:243], a[232:235], v[96:99], v[228:243]
    ds_read_b128 a[248:251], v3 offset:14336
    s_waitcnt lgkmcnt(3)
    v_mfma_f32_32x32x16_bf16 v[212:227], a[236:239], v[100:103], v[212:227]
    ds_read_b128 a[252:255], v3 offset:15360
    s_waitcnt lgkmcnt(3)
    v_mfma_f32_32x32x16_bf16 v[228:243], a[240:243], v[100:103], v[228:243]
    ds_read_b128 a[224:227], v3 offset:16384
    s_waitcnt lgkmcnt(3)
    v_mfma_f32_32x32x16_bf16 v[212:227], a[244:247], v[104:107], v[212:227]
    ds_read_b128 a[228:231], v3 offset:17408
    s_waitcnt lgkmcnt(3)
    v_mfma_f32_32x32x16_bf16 v[228:243], a[248:251], v[104:107], v[228:243]
    ds_read_b128 a[232:235], v3 offset:18432
    s_waitcnt lgkmcnt(3)
    v_mfma_f32_32x32x16_bf16 v[212:227], a[252:255], v[108:111], v[212:227]
    ds_read_b128 a[236:239], v3 offset:19456
    s_waitcnt lgkmcnt(3)
    v_mfma_f32_32x32x16_bf16 v[228:243], a[224:227], v[108:111], v[228:243]
    ds_read_b128 a[240:243], v3 offset:20480
    s_waitcnt lgkmcnt(3)
    v_mfma_f32_32x32x16_bf16 v[212:227], a[228:231], v[112:115], v[212:227]
    ds_read_b128 a[244:247], v3 offset:21504
    s_waitcnt lgkmcnt(3)
    v_mfma_f32_32x32x16_bf16 v[228:243], a[232:235], v[112:115], v[228:243]
    ds_read_b128 a[248:251], v3 offset:22528
    s_mov_b32 s38, 36864
    buffer_load_dword v13, v14, s[44:47], s38 offen sc1
    s_waitcnt lgkmcnt(3)
    v_mfma_f32_32x32x16_bf16 v[212:227], a[236:239], v[116:119], v[212:227]
    ds_read_b128 a[252:255], v3 offset:23552
    s_waitcnt lgkmcnt(3)
    v_mfma_f32_32x32x16_bf16 v[228:243], a[240:243], v[116:119], v[228:243]
    ds_read_b128 a[224:227], v3 offset:24576
    s_waitcnt lgkmcnt(3)
    v_mfma_f32_32x32x16_bf16 v[212:227], a[244:247], v[120:123], v[212:227]
    ds_read_b128 a[228:231], v3 offset:25600
    s_waitcnt lgkmcnt(3)
    v_mfma_f32_32x32x16_bf16 v[228:243], a[248:251], v[120:123], v[228:243]
    ds_read_b128 a[232:235], v3 offset:26624
    s_waitcnt lgkmcnt(3)
    v_mfma_f32_32x32x16_bf16 v[212:227], a[252:255], v[124:127], v[212:227]
    s_waitcnt lgkmcnt(2)
    v_mfma_f32_32x32x16_bf16 v[228:243], a[224:227], v[124:127], v[228:243]
    s_waitcnt lgkmcnt(1)
    v_mfma_f32_32x32x16_bf16 v[212:227], a[228:231], v[128:131], v[212:227]
    s_waitcnt lgkmcnt(0)
    v_mfma_f32_32x32x16_bf16 v[228:243], a[232:235], v[128:131], v[228:243]
    s_cmp_ge_u32 s51, 7
    s_cbranch_scc1 L_F0_nog2
    s_mul_i32 s7, s52, 112*1024
    s_mul_i32 s10, s3, 28*1024
    s_add_u32 s7, s7, s10
    s_add_u32 s7, s7, 11665408
    s_xor_b32 s9, s52, 1
    s_mul_i32 s9, s9, 112*1024
    s_add_u32 s9, s9, s10
    s_add_u32 s9, s9, 11665408
    s_mov_b32 s62, 0
L4_chk:
    s_waitcnt vmcnt(0)
    v_cmp_ne_u32 vcc, s42, v13
    s_add_u32 s62, s62, 1
    s_cmp_lt_u32 s62, 0x20000
    s_cselect_b64 s[64:65], vcc, 0
    s_cmp_eq_u64 s[64:65], 0
    s_cbranch_scc1 L4_ok
    s_sleep 1
    s_mov_b32 s38, 36864
    buffer_load_dword v13, v14, s[44:47], s38 offen sc1
    s_waitcnt vmcnt(0) lgkmcnt(0)
    s_branch L4_chk
L4_ok:
    s_add_u32 s63, s7, 0
    buffer_load_dwordx4 v[100:103], v1, s[44:47], s63 offen offset:0 sc1
    s_add_u32 s63, s9, 0
    buffer_load_dwordx4 v[104:107], v1, s[44:47], s63 offen offset:0 sc1
    s_add_u32 s63, s7, 0
    buffer_load_dwordx4 v[108:111], v1, s[44:47], s63 offen offset:1024 sc1
    s_add_u32 s63, s9, 0
    buffer_load_dwordx4 v[112:115], v1, s[44:47], s63 offen offset:1024 sc1
    s_add_u32 s63, s7, 0
    buffer_load_dwordx4 v[116:119], v1, s[44:47], s63 offen offset:2048 sc1
    s_add_u32 s63, s9, 0
    buffer_load_dwordx4 v[120:123], v1, s[44:47], s63 offen offset:2048 sc1
    v_max_f32 v212, 0, v212
    v_max_f32 v213, 0, v213
    v_max_f32 v214, 0, v214
    v_max_f32 v215, 0, v215
    v_max_f32 v216, 0, v216
    v_max_f32 v217, 0, v217
    v_max_f32 v218, 0, v218
    v_max_f32 v219, 0, v219
    v_mul_f32 v212, v212, v220
    v_mul_f32 v213, v213, v221
    v_mul_f32 v214, v214, v222
    v_mul_f32 v215, v215, v223
    v_mul_f32 v216, v216, v224
    v_mul_f32 v217, v217, v225
    v_mul_f32 v218, v218, v226
    v_mul_f32 v219, v219, v227
    v_cvt_pk_bf16_f32 v220, v212, v213
    v_cvt_pk_bf16_f32 v221, v214, v215
    v_cvt_pk_bf16_f32 v222, v216, v217
    v_cvt_pk_bf16_f32 v223, v218, v219
    buffer_store_dwordx4 v[220:223], v1, s[44:47], s14 offen offset:1024 sc1
    v_max_f32 v228, 0, v228
    v_max_f32 v229, 0, v229
    v_max_f32 v230, 0, v230
    v_max_f32 v231, 0, v231
    v_max_f32 v232, 0, v232
    v_max_f32 v233, 0, v233
    v_max_f32 v234, 0, v234
    v_max_f32 v235, 0, v235
    v_mul_f32 v228, v228, v236
    v_mul_f32 v229, v229, v237
    v_mul_f32 v230, v230, v238
    v_mul_f32 v231, v231, v239
    v_mul_f32 v232, v232, v240
    v_mul_f32 v233, v233, v241
    v_mul_f32 v234, v234, v242
    v_mul_f32 v235, v235, v243
    v_cvt_pk_bf16_f32 v236, v228, v229
    v_cvt_pk_bf16_f32 v237, v230, v231
    v_cvt_pk_bf16_f32 v238, v232, v233
    v_cvt_pk_bf16_f32 v239, v234, v235
    buffer_store_dwordx4 v[236:239], v1, s[44:47], s14 offen offset:2048 sc1
    s_add_u32 s63, s7, 4096
    buffer_load_dwordx4 v[124:127], v1, s[44:47], s63 offen offset:3072 sc1
    s_add_u32 s63, s9, 4096
    buffer_load_dwordx4 v[128:131], v1, s[44:47], s63 offen offset:3072 sc1
    s_waitcnt vmcnt(9)
    v_mfma_f32_32x32x16_bf16 v[16:31], a[0:3], v[100:103], 0
    s_add_u32 s63, s7, 8192
    buffer_load_dwordx4 v[132:135], v1, s[44:47], s63 offen offset:0 sc1
    v_mfma_f32_32x32x16_bf16 v[32:47], a[4:7], v[100:103], 0
    s_add_u32 s63, s9, 8192
    buffer_load_dwordx4 v[136:139], v1, s[44:47], s63 offen offset:0 sc1
    s_waitcnt vmcnt(10)
    v_mfma_f32_32x32x16_bf16 v[48:63], a[0:3], v[104:107], 0
    s_add_u32 s63, s7, 8192
    buffer_load_dwordx4 v[140:143], v1, s[44:47], s63 offen offset:1024 sc1
    v_mfma_f32_32x32x16_bf16 v[64:79], a[4:7], v[104:107], 0
    s_add_u32 s63, s9, 8192
    buffer_load_dwordx4 v[144:147], v1, s[44:47], s63 offen offset:1024 sc1
    s_waitcnt vmcnt(11)
    v_mfma_f32_32x32x16_bf16 v[16:31], a[8:11], v[108:111], v[16:31]
    s_add_u32 s63, s7, 12288
    buffer_load_dwordx4 v[148:151], v1, s[44:47], s63 offen offset:2048 sc1
    v_mfma_f32_32x32x16_bf16 v[32:47], a[12:15], v[108:111], v[32:47]
    s_add_u32 s63, s9, 12288
    buffer_load_dwordx4 v[152:155], v1, s[44:47], s63 offen offset:2048 sc1
    s_waitcnt vmcnt(12)
    v_mfma_f32_32x32x16_bf16 v[48:63], a[8:11], v[112:115], v[48:63]
    s_add_u32 s63, s7, 12288
    buffer_load_dwordx4 v[156:159], v1, s[44:47], s63 offen offset:3072 sc1
    v_mfma_f32_32x32x16_bf16 v[64:79], a[12:15], v[112:115], v[64:79]
    s_add_u32 s63, s9, 12288
    buffer_load_dwordx4 v[160:163], v1, s[44:47], s63 offen offset:3072 sc1
    s_waitcnt vmcnt(13)
    v_mfma_f32_32x32x16_bf16 v[16:31], a[16:19], v[116:119], v[16:31]
    s_add_u32 s63, s7, 16384
    buffer_load_dwordx4 v[164:167], v1, s[44:47], s63 offen offset:0 sc1
    v_mfma_f32_32x32x16_bf16 v[32:47], a[20:23], v[116:119], v[32:47]
    s_add_u32 s63, s9, 16384
    buffer_load_dwordx4 v[168:171], v1, s[44:47], s63 offen offset:0 sc1
    s_waitcnt vmcnt(14)
    v_mfma_f32_32x32x16_bf16 v[48:63], a[16:19], v[120:123], v[48:63]
    s_add_u32 s63, s7, 20480
    buffer_load_dwordx4 v[172:175], v1, s[44:47], s63 offen offset:1024 sc1
    v_mfma_f32_32x32x16_bf16 v[64:79], a[20:23], v[120:123], v[64:79]
    s_add_u32 s63, s9, 20480
    buffer_load_dwordx4 v[176:179], v1, s[44:47], s63 offen offset:1024 sc1
    s_waitcnt vmcnt(13)
    v_mfma_f32_32x32x16_bf16 v[16:31], a[56:59], v[124:127], v[16:31]
    s_add_u32 s63, s7, 20480
    buffer_load_dwordx4 v[180:183], v1, s[44:47], s63 offen offset:2048 sc1
    v_mfma_f32_32x32x16_bf16 v[32:47], a[60:63], v[124:127], v[32:47]
    s_add_u32 s63, s9, 20480
    buffer_load_dwordx4 v[184:187], v1, s[44:47], s63 offen offset:2048 sc1
    s_waitcnt vmcnt(14)
    v_mfma_f32_32x32x16_bf16 v[48:63], a[56:59], v[128:131], v[48:63]
    s_lshl_b32 s15, s48, 6
    s_lshl_b32 s61, s49, 2
    s_add_u32 s15, s15, s61
    s_add_u32 s15, s15, 40960
    s_mov_b64 exec, 1
    buffer_store_dword v15, v1, s[44:47], s15 offen
    s_mov_b64 exec, -1
    s_add_u32 s63, s7, 20480
    buffer_load_dwordx4 v[188:191], v1, s[44:47], s63 offen offset:3072 sc1
    v_mfma_f32_32x32x16_bf16 v[64:79], a[60:63], v[128:131], v[64:79]
    s_add_u32 s63, s9, 20480
    buffer_load_dwordx4 v[192:195], v1, s[44:47], s63 offen offset:3072 sc1
    s_waitcnt vmcnt(16)
    v_mfma_f32_32x32x16_bf16 v[16:31], a[64:67], v[132:135], v[16:31]
    s_add_u32 s63, s7, 0
    buffer_load_dwordx4 v[196:199], v1, s[44:47], s63 offen offset:3072 sc1
    v_mfma_f32_32x32x16_bf16 v[32:47], a[68:71], v[132:135], v[32:47]
    s_add_u32 s63, s9, 0
    buffer_load_dwordx4 v[200:203], v1, s[44:47], s63 offen offset:3072 sc1
    s_waitcnt vmcnt(17)
    v_mfma_f32_32x32x16_bf16 v[48:63], a[64:67], v[136:139], v[48:63]
    s_add_u32 s63, s7, 4096
    buffer_load_dwordx4 v[204:207], v1, s[44:47], s63 offen offset:0 sc1
    v_mfma_f32_32x32x16_bf16 v[64:79], a[68:71], v[136:139], v[64:79]
    s_add_u32 s63, s9, 4096
    buffer_load_dwordx4 v[208:211], v1, s[44:47], s63 offen offset:0 sc1
    s_waitcnt vmcnt(18)
    v_mfma_f32_32x32x16_bf16 v[16:31], a[72:75], v[140:143], v[16:31]
    s_add_u32 s63, s7, 8192
    buffer_load_dwordx4 v[212:215], v1, s[44:47], s63 offen offset:2048 sc1
    v_mfma_f32_32x32x16_bf16 v[32:47], a[76:79], v[140:143], v[32:47]
    s_add_u32 s63, s9, 8192
    buffer_load_dwordx4 v[216:219], v1, s[44:47], s63 offen offset:2048 sc1
    s_waitcnt vmcnt(19)
    v_mfma_f32_32x32x16_bf16 v[48:63], a[72:75], v[144:147], v[48:63]
    s_add_u32 s63, s7, 8192
    buffer_load_dwordx4 v[220:223], v1, s[44:47], s63 offen offset:3072 sc1
    v_mfma_f32_32x32x16_bf16 v[64:79], a[76:79], v[144:147], v[64:79]
    s_add_u32 s63, s9, 8192
    buffer_load_dwordx4 v[224:227], v1, s[44:47], s63 offen offset:3072 sc1
    s_waitcnt vmcnt(20)
    v_mfma_f32_32x32x16_bf16 v[16:31], a[112:115], v[148:151], v[16:31]
    s_add_u32 s63, s7, 16384
    buffer_load_dwordx4 v[228:231], v1, s[44:47], s63 offen offset:1024 sc1
    v_mfma_f32_32x32x16_bf16 v[32:47], a[116:119], v[148:151], v[32:47]
    s_add_u32 s63, s9, 16384
    buffer_load_dwordx4 v[232:235], v1, s[44:47], s63 offen offset:1024 sc1
    s_waitcnt vmcnt(21)
    v_mfma_f32_32x32x16_bf16 v[48:63], a[112:115], v[152:155], v[48:63]
    s_mov_b32 s38, 40960
    buffer_load_dword v13, v14, s[44:47], s38 offen sc1
    v_mfma_f32_32x32x16_bf16 v[64:79], a[116:119], v[152:155], v[64:79]
    s_waitcnt vmcnt(21)
    v_mfma_f32_32x32x16_bf16 v[16:31], a[120:123], v[156:159], v[16:31]
    s_add_u32 s63, s7, 16384
    buffer_load_dwordx4 v[236:239], v1, s[44:47], s63 offen offset:2048 sc1
    v_mfma_f32_32x32x16_bf16 v[32:47], a[124:127], v[156:159], v[32:47]
    s_add_u32 s63, s9, 16384
    buffer_load_dwordx4 v[240:243], v1, s[44:47], s63 offen offset:2048 sc1
    s_waitcnt vmcnt(22)
    v_mfma_f32_32x32x16_bf16 v[48:63], a[120:123], v[160:163], v[48:63]
    v_mfma_f32_32x32x16_bf16 v[64:79], a[124:127], v[160:163], v[64:79]
    s_waitcnt vmcnt(21)
    v_mfma_f32_32x32x16_bf16 v[16:31], a[128:131], v[164:167], v[16:31]
    s_add_u32 s63, s7, 24576
    buffer_load_dwordx4 v[244:247], v1, s[44:47], s63 offen offset:0 sc1
    v_mfma_f32_32x32x16_bf16 v[32:47], a[132:135], v[164:167], v[32:47]
    s_add_u32 s63, s9, 24576
    buffer_load_dwordx4 v[248:251], v1, s[44:47], s63 offen offset:0 sc1
    s_waitcnt vmcnt(22)
    v_mfma_f32_32x32x16_bf16 v[48:63], a[128:131], v[168:171], v[48:63]
    v_mfma_f32_32x32x16_bf16 v[64:79], a[132:135], v[168:171], v[64:79]
    s_waitcnt vmcnt(21)
    v_mfma_f32_32x32x16_bf16 v[16:31], a[168:171], v[172:175], v[16:31]
    s_add_u32 s63, s7, 24576
    buffer_load_dwordx4 v[100:103], v1, s[44:47], s63 offen offset:1024 sc1
    v_mfma_f32_32x32x16_bf16 v[32:47], a[172:175], v[172:175], v[32:47]
    s_add_u32 s63, s9, 24576
    buffer_load_dwordx4 v[104:107], v1, s[44:47], s63 offen offset:1024 sc1
    s_waitcnt vmcnt(22)
    v_mfma_f32_32x32x16_bf16 v[48:63], a[168:171], v[176:179], v[48:63]
    s_mov_b32 s62, 0
L5_chk:
    s_waitcnt vmcnt(6)
    v_cmp_ne_u32 vcc, s42, v13
    s_add_u32 s62, s62, 1
    s_cmp_lt_u32 s62, 0x20000
    s_cselect_b64 s[64:65], vcc, 0
    s_cmp_eq_u64 s[64:65], 0
    s_cbranch_scc1 L5_ok
    s_sleep 1
    s_mov_b32 s38, 40960
    buffer_load_dword v13, v14, s[44:47], s38 offen sc1
    s_waitcnt vmcnt(0) lgkmcnt(0)
    s_branch L5_chk
L5_ok:
    v_mfma_f32_32x32x16_bf16 v[64:79], a[172:175], v[176:179], v[64:79]
    v_mfma_f32_32x32x16_bf16 v[16:31], a[176:179], v[180:183], v[16:31]
    s_add_u32 s63, s7, 4096
    buffer_load_dwordx4 v[108:111], v1, s[44:47], s63 offen offset:1024 sc1
    v_mfma_f32_32x32x16_bf16 v[32:47], a[180:183], v[180:183], v[32:47]
    s_add_u32 s63, s9, 4096
    buffer_load_dwordx4 v[112:115], v1, s[44:47], s63 offen offset:1024 sc1
    v_mfma_f32_32x32x16_bf16 v[48:63], a[176:179], v[184:187], v[48:63]
    v_mfma_f32_32x32x16_bf16 v[64:79], a[180:183], v[184:187], v[64:79]
    v_mfma_f32_32x32x16_bf16 v[16:31], a[184:187], v[188:191], v[16:31]
    s_add_u32 s63, s7, 4096
    buffer_load_dwordx4 v[116:119], v1, s[44:47], s63 offen offset:2048 sc1
    v_mfma_f32_32x32x16_bf16 v[32:47], a[188:191], v[188:191], v[32:47]
    s_add_u32 s63, s9, 4096
    buffer_load_dwordx4 v[120:123], v1, s[44:47], s63 offen offset:2048 sc1
    v_mfma_f32_32x32x16_bf16 v[48:63], a[184:187], v[192:195], v[48:63]
    v_mfma_f32_32x32x16_bf16 v[64:79], a[188:191], v[192:195], v[64:79]
    v_mfma_f32_32x32x16_bf16 v[16:31], a[24:27], v[196:199], v[16:31]
    s_add_u32 s63, s7, 12288
    buffer_load_dwordx4 v[124:127], v1, s[44:47], s63 offen offset:0 sc1
    v_mfma_f32_32x32x16_bf16 v[32:47], a[28:31], v[196:199], v[32:47]
    s_add_u32 s63, s9, 12288
    buffer_load_dwordx4 v[128:131], v1, s[44:47], s63 offen offset:0 sc1
    v_mfma_f32_32x32x16_bf16 v[48:63], a[24:27], v[200:203], v[48:63]
    v_mfma_f32_32x32x16_bf16 v[64:79], a[28:31], v[200:203], v[64:79]
    v_mfma_f32_32x32x16_bf16 v[16:31], a[32:35], v[204:207], v[16:31]
    s_add_u32 s63, s7, 12288
    buffer_load_dwordx4 v[132:135], v1, s[44:47], s63 offen offset:1024 sc1
    v_mfma_f32_32x32x16_bf16 v[32:47], a[36:39], v[204:207], v[32:47]
    s_add_u32 s63, s9, 12288
    buffer_load_dwordx4 v[136:139], v1, s[44:47], s63 offen offset:1024 sc1
    v_mfma_f32_32x32x16_bf16 v[48:63], a[32:35], v[208:211], v[48:63]
    v_mfma_f32_32x32x16_bf16 v[64:79], a[36:39], v[208:211], v[64:79]
    s_barrier
    v_mfma_f32_32x32x16_bf16 v[16:31], a[80:83], v[212:215], v[16:31]
    s_add_u32 s63, s7, 16384
    buffer_load_dwordx4 v[140:143], v1, s[44:47], s63 offen offset:3072 sc1
    v_mfma_f32_32x32x16_bf16 v[32:47], a[84:87], v[212:215], v[32:47]
    s_add_u32 s63, s9, 16384
    buffer_load_dwordx4 v[144:147], v1, s[44:47], s63 offen offset:3072 sc1
    v_mfma_f32_32x32x16_bf16 v[48:63], a[80:83], v[216:219], v[48:63]
    v_mfma_f32_32x32x16_bf16 v[64:79], a[84:87], v[216:219], v[64:79]
    v_mfma_f32_32x32x16_bf16 v[16:31], a[88:91], v[220:223], v[16:31]
    s_add_u32 s63, s7, 20480
    buffer_load_dwordx4 v[148:151], v1, s[44:47], s63 offen offset:0 sc1
    v_mfma_f32_32x32x16_bf16 v[32:47], a[92:95], v[220:223], v[32:47]
    s_add_u32 s63, s9, 20480
    buffer_load_dwordx4 v[152:155], v1, s[44:47], s63 offen offset:0 sc1
    v_mfma_f32_32x32x16_bf16 v[48:63], a[88:91], v[224:227], v[48:63]
    v_mfma_f32_32x32x16_bf16 v[64:79], a[92:95], v[224:227], v[64:79]
    v_mfma_f32_32x32x16_bf16 v[16:31], a[136:139], v[228:231], v[16:31]
    s_add_u32 s63, s7, 24576
    buffer_load_dwordx4 v[156:159], v1, s[44:47], s63 offen offset:2048 sc1
    v_mfma_f32_32x32x16_bf16 v[32:47], a[140:143], v[228:231], v[32:47]
    s_add_u32 s63, s9, 24576
    buffer_load_dwordx4 v[160:163], v1, s[44:47], s63 offen offset:2048 sc1
    v_mfma_f32_32x32x16_bf16 v[48:63], a[136:139], v[232:235], v[48:63]
    v_mfma_f32_32x32x16_bf16 v[64:79], a[140:143], v[232:235], v[64:79]
    s_waitcnt vmcnt(19)
    v_mfma_f32_32x32x16_bf16 v[16:31], a[144:147], v[236:239], v[16:31]
    s_add_u32 s63, s7, 24576
    buffer_load_dwordx4 v[164:167], v1, s[44:47], s63 offen offset:3072 sc1
    v_mfma_f32_32x32x16_bf16 v[32:47], a[148:151], v[236:239], v[32:47]
    s_add_u32 s63, s9, 24576
    buffer_load_dwordx4 v[168:171], v1, s[44:47], s63 offen offset:3072 sc1
    s_waitcnt vmcnt(20)
    v_mfma_f32_32x32x16_bf16 v[48:63], a[144:147], v[240:243], v[48:63]
    v_mfma_f32_32x32x16_bf16 v[64:79], a[148:151], v[240:243], v[64:79]
    s_waitcnt vmcnt(19)
    v_mfma_f32_32x32x16_bf16 v[16:31], a[192:195], v[244:247], v[16:31]
    s_add_u32 s10, s54, 4849664
    buffer_load_dwordx4 v[80:83], v12, s[44:47], s10 offen sc1
    buffer_load_dwordx4 v[84:87], v12, s[44:47], s10 offen offset:256 sc1
    v_lshrrev_b32 v6, 1, v8
    s_lshl_b32 s15, s52, 7
    s_add_u32 s15, s15, 65536
    buffer_load_dword v96, v6, s[44:47], s15 offen sc1
    s_add_u32 s10, s54, 19005440
    buffer_load_dwordx4 v[88:91], v12, s[44:47], s10 offen sc1
    buffer_load_dwordx4 v[92:95], v12, s[44:47], s10 offen offset:256 sc1
    s_mul_i32 s10, s52, 14*512
    s_add_u32 s10, s10, 655360
    v_min_u32 v6, 55, v0
    v_lshlrev_b32 v6, 7, v6
    buffer_load_dword v97, v6, s[44:47], s10 offen sc1
    s_lshl_b32 s10, s52, 12
    s_add_u32 s10, s10, 131072
    v_lshlrev_b32 v6, 6, v0
    buffer_load_dword v98, v6, s[44:47], s10 offen sc1
    v_mfma_f32_32x32x16_bf16 v[32:47], a[196:199], v[244:247], v[32:47]
    s_waitcnt vmcnt(25)
    v_mfma_f32_32x32x16_bf16 v[48:63], a[192:195], v[248:251], v[48:63]
    v_mfma_f32_32x32x16_bf16 v[64:79], a[196:199], v[248:251], v[64:79]
    s_waitcnt vmcnt(24)
    v_mfma_f32_32x32x16_bf16 v[16:31], a[200:203], v[100:103], v[16:31]
    v_mfma_f32_32x32x16_bf16 v[32:47], a[204:207], v[100:103], v[32:47]
    s_waitcnt vmcnt(23)
    v_mfma_f32_32x32x16_bf16 v[48:63], a[200:203], v[104:107], v[48:63]
    v_mfma_f32_32x32x16_bf16 v[64:79], a[204:207], v[104:107], v[64:79]
    s_waitcnt vmcnt(22)
    v_mfma_f32_32x32x16_bf16 v[16:31], a[40:43], v[108:111], v[16:31]
    v_mfma_f32_32x32x16_bf16 v[32:47], a[44:47], v[108:111], v[32:47]
    s_waitcnt vmcnt(21)
    v_mfma_f32_32x32x16_bf16 v[48:63], a[40:43], v[112:115], v[48:63]
    v_mfma_f32_32x32x16_bf16 v[64:79], a[44:47], v[112:115], v[64:79]
    s_waitcnt vmcnt(20)
    v_mfma_f32_32x32x16_bf16 v[16:31], a[48:51], v[116:119], v[16:31]
    v_mfma_f32_32x32x16_bf16 v[32:47], a[52:55], v[116:119], v[32:47]
    s_waitcnt vmcnt(19)
    v_mfma_f32_32x32x16_bf16 v[48:63], a[48:51], v[120:123], v[48:63]
    v_mfma_f32_32x32x16_bf16 v[64:79], a[52:55], v[120:123], v[64:79]
    s_waitcnt vmcnt(18)
    v_mfma_f32_32x32x16_bf16 v[16:31], a[96:99], v[124:127], v[16:31]
    v_mfma_f32_32x32x16_bf16 v[32:47], a[100:103], v[124:127], v[32:47]
    s_waitcnt vmcnt(17)
    v_mfma_f32_32x32x16_bf16 v[48:63], a[96:99], v[128:131], v[48:63]
    v_mfma_f32_32x32x16_bf16 v[64:79], a[100:103], v[128:131], v[64:79]
    s_waitcnt vmcnt(16)
    v_mfma_f32_32x32x16_bf16 v[16:31], a[104:107], v[132:135], v[16:31]
    v_mfma_f32_32x32x16_bf16 v[32:47], a[108:111], v[132:135], v[32:47]
    s_waitcnt vmcnt(15)
    v_mfma_f32_32x32x16_bf16 v[48:63], a[104:107], v[136:139], v[48:63]
    v_mfma_f32_32x32x16_bf16 v[64:79], a[108:111], v[136:139], v[64:79]
    s_waitcnt vmcnt(14)
    v_mfma_f32_32x32x16_bf16 v[16:31], a[152:155], v[140:143], v[16:31]
    v_mfma_f32_32x32x16_bf16 v[32:47], a[156:159], v[140:143], v[32:47]
    s_waitcnt vmcnt(13)
    v_mfma_f32_32x32x16_bf16 v[48:63], a[152:155], v[144:147], v[48:63]
    v_mfma_f32_32x32x16_bf16 v[64:79], a[156:159], v[144:147], v[64:79]
    s_waitcnt vmcnt(12)
    v_mfma_f32_32x32x16_bf16 v[32:47], a[164:167], v[148:151], v[32:47]
    s_waitcnt vmcnt(11)
    v_mfma_f32_32x32x16_bf16 v[48:63], a[160:163], v[152:155], v[48:63]
    v_mfma_f32_32x32x16_bf16 v[64:79], a[164:167], v[152:155], v[64:79]
    s_waitcnt vmcnt(10)
    v_mfma_f32_32x32x16_bf16 v[32:47], a[212:215], v[156:159], v[32:47]
    s_waitcnt vmcnt(9)
    v_mfma_f32_32x32x16_bf16 v[48:63], a[208:211], v[160:163], v[48:63]
    v_mfma_f32_32x32x16_bf16 v[64:79], a[212:215], v[160:163], v[64:79]
    s_waitcnt vmcnt(8)
    v_mfma_f32_32x32x16_bf16 v[32:47], a[220:223], v[164:167], v[32:47]
    s_waitcnt vmcnt(7)
    v_mfma_f32_32x32x16_bf16 v[48:63], a[216:219], v[168:171], v[48:63]
    v_mfma_f32_32x32x16_bf16 v[64:79], a[220:223], v[168:171], v[64:79]
    s_xor_b32 s10, s3, 1
    s_mul_i32 s10, s10, 12288
    s_add_u32 s10, s10, 114688
    v_add_u32 v4, s10, v1
    s_xor_b32 s10, s3, 2
    s_mul_i32 s10, s10, 12288
    s_add_u32 s10, s10, 118784
    v_add_u32 v5, s10, v1
    s_xor_b32 s10, s3, 3
    s_mul_i32 s10, s10, 12288
    s_add_u32 s10, s10, 122880
    v_add_u32 v6, s10, v1
    v_mfma_f32_32x32x16_bf16 v[16:31], a[160:163], v[148:151], v[16:31]
    ds_write_b128 v4, v[32:35] offset:0
    ds_write_b128 v4, v[36:39] offset:1024
    ds_write_b128 v4, v[40:43] offset:2048
    ds_write_b128 v4, v[44:47] offset:3072
    v_mfma_f32_32x32x16_bf16 v[16:31], a[208:211], v[156:159], v[16:31]
    ds_write_b128 v5, v[48:51] offset:0
    ds_write_b128 v5, v[52:55] offset:1024
    ds_write_b128 v5, v[56:59] offset:2048
    ds_write_b128 v5, v[60:63] offset:3072
    v_mfma_f32_32x32x16_bf16 v[16:31], a[216:219], v[164:167], v[16:31]
    ds_write_b128 v6, v[64:67] offset:0
    ds_write_b128 v6, v[68:71] offset:1024
    ds_write_b128 v6, v[72:75] offset:2048
    ds_write_b128 v6, v[76:79] offset:3072
    s_mul_i32 s10, s3, 12288
    s_add_u32 s10, s10, 114688
    v_add_u32 v7, s10, v1
    s_waitcnt lgkmcnt(0)
    s_barrier
    ds_read_b128 v[100:103], v7 offset:0
    ds_read_b128 v[104:107], v7 offset:1024
    ds_read_b128 v[108:111], v7 offset:2048
    ds_read_b128 v[112:115], v7 offset:3072
    ds_read_b128 v[116:119], v7 offset:4096
    ds_read_b128 v[120:123], v7 offset:5120
    ds_read_b128 v[124:127], v7 offset:6144
    ds_read_b128 v[128:131], v7 offset:7168
    ds_read_b128 v[132:135], v7 offset:8192
    ds_read_b128 v[136:139], v7 offset:9216
    ds_read_b128 v[140:143], v7 offset:10240
    ds_read_b128 v[144:147], v7 offset:11264
    s_waitcnt vmcnt(6)
    v_lshlrev_b32 v32, 16, v80
    v_and_b32 v33, s57, v80
    v_lshlrev_b32 v34, 16, v81
    v_and_b32 v35, s57, v81
    v_lshlrev_b32 v36, 16, v82
    v_and_b32 v37, s57, v82
    v_lshlrev_b32 v38, 16, v83
    v_and_b32 v39, s57, v83
    s_waitcnt vmcnt(5)
    v_lshlrev_b32 v40, 16, v84
    v_and_b32 v41, s57, v84
    v_lshlrev_b32 v42, 16, v85
    v_and_b32 v43, s57, v85
    v_lshlrev_b32 v44, 16, v86
    v_and_b32 v45, s57, v86
    v_lshlrev_b32 v46, 16, v87
    v_and_b32 v47, s57, v87
    s_waitcnt lgkmcnt(11)
    v_pk_add_f32 v[16:17], v[16:17], v[100:101]
    v_pk_add_f32 v[18:19], v[18:19], v[102:103]
    s_waitcnt lgkmcnt(10)
    v_pk_add_f32 v[20:21], v[20:21], v[104:105]
    v_pk_add_f32 v[22:23], v[22:23], v[106:107]
    s_waitcnt lgkmcnt(9)
    v_pk_add_f32 v[24:25], v[24:25], v[108:109]
    v_pk_add_f32 v[26:27], v[26:27], v[110:111]
    s_waitcnt lgkmcnt(8)
    v_pk_add_f32 v[28:29], v[28:29], v[112:113]
    v_pk_add_f32 v[30:31], v[30:31], v[114:115]
    s_waitcnt lgkmcnt(7)
    v_pk_add_f32 v[16:17], v[16:17], v[116:117]
    v_pk_add_f32 v[18:19], v[18:19], v[118:119]
    s_waitcnt lgkmcnt(6)
    v_pk_add_f32 v[20:21], v[20:21], v[120:121]
    v_pk_add_f32 v[22:23], v[22:23], v[122:123]
    s_waitcnt lgkmcnt(5)
    v_pk_add_f32 v[24:25], v[24:25], v[124:125]
    v_pk_add_f32 v[26:27], v[26:27], v[126:127]
    s_waitcnt lgkmcnt(4)
    v_pk_add_f32 v[28:29], v[28:29], v[128:129]
    v_pk_add_f32 v[30:31], v[30:31], v[130:131]
    s_waitcnt lgkmcnt(3)
    v_pk_add_f32 v[16:17], v[16:17], v[132:133]
    v_pk_add_f32 v[18:19], v[18:19], v[134:135]
    s_waitcnt lgkmcnt(2)
    v_pk_add_f32 v[20:21], v[20:21], v[136:137]
    v_pk_add_f32 v[22:23], v[22:23], v[138:139]
    s_waitcnt lgkmcnt(1)
    v_pk_add_f32 v[24:25], v[24:25], v[140:141]
    v_pk_add_f32 v[26:27], v[26:27], v[142:143]
    s_waitcnt lgkmcnt(0)
    v_pk_add_f32 v[28:29], v[28:29], v[144:145]
    v_pk_add_f32 v[30:31], v[30:31], v[146:147]
    s_waitcnt vmcnt(4)
    v_fmac_f32 v32, v96, v16
    v_fmac_f32 v33, v96, v17
    v_fmac_f32 v34, v96, v18
    v_fmac_f32 v35, v96, v19
    v_fmac_f32 v36, v96, v20
    v_fmac_f32 v37, v96, v21
    v_fmac_f32 v38, v96, v22
    v_fmac_f32 v39, v96, v23
    v_fmac_f32 v40, v96, v24
    v_fmac_f32 v41, v96, v25
    v_fmac_f32 v42, v96, v26
    v_fmac_f32 v43, v96, v27
    v_fmac_f32 v44, v96, v28
    v_fmac_f32 v45, v96, v29
    v_fmac_f32 v46, v96, v30
    v_fmac_f32 v47, v96, v31
    v_cvt_pk_bf16_f32 v80, v32, v33
    v_cvt_pk_bf16_f32 v81, v34, v35
    v_cvt_pk_bf16_f32 v82, v36, v37
    v_cvt_pk_bf16_f32 v83, v38, v39
    v_cvt_pk_bf16_f32 v84, v40, v41
    v_cvt_pk_bf16_f32 v85, v42, v43
    v_cvt_pk_bf16_f32 v86, v44, v45
    v_cvt_pk_bf16_f32 v87, v46, v47
    s_mul_i32 s10, s52, 14*512
    s_add_u32 s10, s10, 655360
    s_lshl_b32 s15, s53, 9
    s_add_u32 s15, s15, s10
    v_mov_b32 v4, 0
    v_mov_b32 v5, 0
    v_dot2c_f32_bf16 v4, s56, v80
    v_dot2c_f32_bf16 v5, v80, v80
    v_dot2c_f32_bf16 v4, s56, v81
    v_dot2c_f32_bf16 v5, v81, v81
    v_dot2c_f32_bf16 v4, s56, v82
    v_dot2c_f32_bf16 v5, v82, v82
    v_dot2c_f32_bf16 v4, s56, v83
    v_dot2c_f32_bf16 v5, v83, v83
    v_dot2c_f32_bf16 v4, s56, v84
    v_dot2c_f32_bf16 v5, v84, v84
    v_dot2c_f32_bf16 v4, s56, v85
    v_dot2c_f32_bf16 v5, v85, v85
    v_dot2c_f32_bf16 v4, s56, v86
    v_dot2c_f32_bf16 v5, v86, v86
    v_dot2c_f32_bf16 v4, s56, v87
    v_dot2c_f32_bf16 v5, v87, v87
    s_nop 1
    v_mov_b32 v6, v4
    s_nop 1
    v_permlane32_swap_b32 v4, v6
    v_add_f32 v4, v4, v6
    v_mov_b32 v6, v5
    s_nop 1
    v_permlane32_swap_b32 v5, v6
    v_add_f32 v5, v5, v6
    v_mov_b32 v6, v15
    v_lshlrev_b32 v10, 1, v8
    v_lshrrev_b32 v11, 5, v0
    v_mul_u32_u24 v11, 3584, v11
    v_add_u32 v11, v11, v10
    buffer_store_dwordx3 v[4:6], v10, s[44:47], s15 offen
    v_lshlrev_b32 v32, 16, v80
    v_and_b32 v33, s57, v80
    s_waitcnt vmcnt(4)
    v_lshlrev_b32 v48, 16, v88
    v_and_b32 v49, s57, v88
    v_lshlrev_b32 v34, 16, v81
    v_and_b32 v35, s57, v81
    v_lshlrev_b32 v50, 16, v89
    v_and_b32 v51, s57, v89
    v_lshlrev_b32 v36, 16, v82
    v_and_b32 v37, s57, v82
    v_lshlrev_b32 v52, 16, v90
    v_and_b32 v53, s57, v90
    v_lshlrev_b32 v38, 16, v83
    v_and_b32 v39, s57, v83
    v_lshlrev_b32 v54, 16, v91
    v_and_b32 v55, s57, v91
    v_lshlrev_b32 v40, 16, v84
    v_and_b32 v41, s57, v84
    s_waitcnt vmcnt(3)
    v_lshlrev_b32 v56, 16, v92
    v_and_b32 v57, s57, v92
    v_lshlrev_b32 v42, 16, v85
    v_and_b32 v43, s57, v85
    v_lshlrev_b32 v58, 16, v93
    v_and_b32 v59, s57, v93
    v_lshlrev_b32 v44, 16, v86
    v_and_b32 v45, s57, v86
    v_lshlrev_b32 v60, 16, v94
    v_and_b32 v61, s57, v94
    v_lshlrev_b32 v46, 16, v87
    v_and_b32 v47, s57, v87
    v_lshlrev_b32 v62, 16, v95
    v_and_b32 v63, s57, v95
    buffer_load_dwordx3 v[100:102], v11, s[44:47], s10 offen offset:0 sc1
    buffer_load_dwordx3 v[104:106], v11, s[44:47], s10 offen offset:512 sc1
    buffer_load_dwordx3 v[108:110], v11, s[44:47], s10 offen offset:1024 sc1
    buffer_load_dwordx3 v[112:114], v11, s[44:47], s10 offen offset:1536 sc1
    buffer_load_dwordx3 v[116:118], v11, s[44:47], s10 offen offset:2048 sc1
    buffer_load_dwordx3 v[120:122], v11, s[44:47], s10 offen offset:2560 sc1
    buffer_load_dwordx3 v[124:126], v11, s[44:47], s10 offen offset:3072 sc1
    s_mov_b32 s62, 0
L6_chk:
    s_waitcnt vmcnt(6)
    v_xor_b32 v6, s42, v102
    s_waitcnt vmcnt(5)
    v_xor_b32 v7, s42, v106
    v_or_b32 v6, v6, v7
    s_waitcnt vmcnt(4)
    v_xor_b32 v7, s42, v110
    v_or_b32 v6, v6, v7
    s_waitcnt vmcnt(3)
    v_xor_b32 v7, s42, v114
    v_or_b32 v6, v6, v7
    s_waitcnt vmcnt(2)
    v_xor_b32 v7, s42, v118
    v_or_b32 v6, v6, v7
    s_waitcnt vmcnt(1)
    v_xor_b32 v7, s42, v122
    v_or_b32 v6, v6, v7
    s_waitcnt vmcnt(0)
    v_xor_b32 v7, s42, v126
    v_or_b32 v6, v6, v7
    v_cmp_ne_u32 vcc, 0, v6
    s_add_u32 s62, s62, 1
    s_cmp_lt_u32 s62, 0x20000
    s_cselect_b64 s[64:65], vcc, 0
    s_cmp_eq_u64 s[64:65], 0
    s_cbranch_scc1 L6_ok
    s_sleep 1
    buffer_load_dwordx3 v[100:102], v11, s[44:47], s10 offen offset:0 sc1
    buffer_load_dwordx3 v[104:106], v11, s[44:47], s10 offen offset:512 sc1
    buffer_load_dwordx3 v[108:110], v11, s[44:47], s10 offen offset:1024 sc1
    buffer_load_dwordx3 v[112:114], v11, s[44:47], s10 offen offset:1536 sc1
    buffer_load_dwordx3 v[116:118], v11, s[44:47], s10 offen offset:2048 sc1
    buffer_load_dwordx3 v[120:122], v11, s[44:47], s10 offen offset:2560 sc1
    buffer_load_dwordx3 v[124:126], v11, s[44:47], s10 offen offset:3072 sc1
    s_waitcnt vmcnt(0) lgkmcnt(0)
    s_branch L6_chk
L6_ok:
    v_add_f32 v100, v100, v104
    v_add_f32 v101, v101, v105
    v_add_f32 v100, v100, v108
    v_add_f32 v101, v101, v109
    v_add_f32 v100, v100, v112
    v_add_f32 v101, v101, v113
    v_add_f32 v100, v100, v116
    v_add_f32 v101, v101, v117
    v_add_f32 v100, v100, v120
    v_add_f32 v101, v101, v121
    v_add_f32 v100, v100, v124
    v_add_f32 v101, v101, v125
    v_mov_b32 v6, v100
    s_nop 1
    v_permlane32_swap_b32 v100, v6
    v_add_f32 v100, v100, v6
    v_mov_b32 v6, v101
    s_nop 1
    v_permlane32_swap_b32 v101, v6
    v_add_f32 v101, v101, v6
    v_mul_f32 v6, 0x3b124925, v100
    v_mul_f32 v7, 0x3b124925, v101
    v_fma_f32 v7, -v6, v6, v7
    v_max_f32 v7, 0, v7
    v_add_f32 v7, 0x3727c5ac, v7
    v_rsq_f32 v7, v7
    s_nop 0
    v_mul_f32 v6, v6, v7
    v_fma_f32 v16, v32, v7, -v6
    v_fmac_f32 v32, v16, v48
    v_fma_f32 v17, v33, v7, -v6
    v_fmac_f32 v33, v17, v49
    v_fma_f32 v18, v34, v7, -v6
    v_fmac_f32 v34, v18, v50
    v_fma_f32 v19, v35, v7, -v6
    v_fmac_f32 v35, v19, v51
    v_fma_f32 v20, v36, v7, -v6
    v_fmac_f32 v36, v20, v52
    v_fma_f32 v21, v37, v7, -v6
    v_fmac_f32 v37, v21, v53
    v_fma_f32 v22, v38, v7, -v6
    v_fmac_f32 v38, v22, v54
    v_fma_f32 v23, v39, v7, -v6
    v_fmac_f32 v39, v23, v55
    v_fma_f32 v24, v40, v7, -v6
    v_fmac_f32 v40, v24, v56
    v_fma_f32 v25, v41, v7, -v6
    v_fmac_f32 v41, v25, v57
    v_fma_f32 v26, v42, v7, -v6
    v_fmac_f32 v42, v26, v58
    v_fma_f32 v27, v43, v7, -v6
    v_fmac_f32 v43, v27, v59
    v_fma_f32 v28, v44, v7, -v6
    v_fmac_f32 v44, v28, v60
    v_fma_f32 v29, v45, v7, -v6
    v_fmac_f32 v45, v29, v61
    v_fma_f32 v30, v46, v7, -v6
    v_fmac_f32 v46, v30, v62
    v_fma_f32 v31, v47, v7, -v6
    v_fmac_f32 v47, v31, v63
    v_cvt_pk_bf16_f32 v80, v32, v33
    v_cvt_pk_bf16_f32 v81, v34, v35
    v_cvt_pk_bf16_f32 v82, v36, v37
    v_cvt_pk_bf16_f32 v83, v38, v39
    v_cvt_pk_bf16_f32 v84, v40, v41
    v_cvt_pk_bf16_f32 v85, v42, v43
    v_cvt_pk_bf16_f32 v86, v44, v45
    v_cvt_pk_bf16_f32 v87, v46, v47
    s_add_u32 s10, s54, 4849664
    buffer_store_dwordx4 v[80:83], v12, s[44:47], s10 offen
    buffer_store_dwordx4 v[84:87], v12, s[44:47], s10 offen offset:256
    v_mov_b32 v4, 0
    v_mov_b32 v5, 0
    v_dot2c_f32_bf16 v4, s56, v80
    v_dot2c_f32_bf16 v5, v80, v80
    v_dot2c_f32_bf16 v4, s56, v81
    v_dot2c_f32_bf16 v5, v81, v81
    v_dot2c_f32_bf16 v4, s56, v82
    v_dot2c_f32_bf16 v5, v82, v82
    v_dot2c_f32_bf16 v4, s56, v83
    v_dot2c_f32_bf16 v5, v83, v83
    v_dot2c_f32_bf16 v4, s56, v84
    v_dot2c_f32_bf16 v5, v84, v84
    v_dot2c_f32_bf16 v4, s56, v85
    v_dot2c_f32_bf16 v5, v85, v85
    v_dot2c_f32_bf16 v4, s56, v86
    v_dot2c_f32_bf16 v5, v86, v86
    v_dot2c_f32_bf16 v4, s56, v87
    v_dot2c_f32_bf16 v5, v87, v87
    s_nop 1
    v_mov_b32 v6, v4
    s_nop 1
    v_permlane32_swap_b32 v4, v6
    v_add_f32 v4, v4, v6
    v_mov_b32 v6, v5
    s_nop 1
    v_permlane32_swap_b32 v5, v6
    v_add_f32 v5, v5, v6
    s_lshl_b32 s10, s52, 12
    s_lshl_b32 s15, s53, 6
    s_add_u32 s15, s15, s10
    s_add_u32 s15, s15, 131072
    s_mov_b32 exec_hi, 0
    buffer_store_dwordx2 v[4:5], v9, s[44:47], s15 offen
    s_mov_b32 exec_hi, -1
    s_lshl_b32 s15, s52, 6
    s_lshl_b32 s10, s53, 2
    s_add_u32 s15, s15, s10
    s_add_u32 s15, s15, 24576
    s_waitcnt vmcnt(0)
    s_mov_b64 exec, 1
    buffer_store_dword v15, v1, s[44:47], s15 offen
    s_mov_b64 exec, -1
    s_nop 0
    s_branch L_F0_join
L_F0_nog2:
    s_nop 7
    v_max_f32 v212, 0, v212
    v_max_f32 v213, 0, v213
    v_max_f32 v214, 0, v214
    v_max_f32 v215, 0, v215
    v_max_f32 v216, 0, v216
    v_max_f32 v217, 0, v217
    v_max_f32 v218, 0, v218
    v_max_f32 v219, 0, v219
    v_mul_f32 v212, v212, v220
    v_mul_f32 v213, v213, v221
    v_mul_f32 v214, v214, v222
    v_mul_f32 v215, v215, v223
    v_mul_f32 v216, v216, v224
    v_mul_f32 v217, v217, v225
    v_mul_f32 v218, v218, v226
    v_mul_f32 v219, v219, v227
    v_cvt_pk_bf16_f32 v220, v212, v213
    v_cvt_pk_bf16_f32 v221, v214, v215
    v_cvt_pk_bf16_f32 v222, v216, v217
    v_cvt_pk_bf16_f32 v223, v218, v219
    buffer_store_dwordx4 v[220:223], v1, s[44:47], s14 offen offset:1024 sc1
    v_max_f32 v228, 0, v228
    v_max_f32 v229, 0, v229
    v_max_f32 v230, 0, v230
    v_max_f32 v231, 0, v231
    v_max_f32 v232, 0, v232
    v_max_f32 v233, 0, v233
    v_max_f32 v234, 0, v234
    v_max_f32 v235, 0, v235
    v_mul_f32 v228, v228, v236
    v_mul_f32 v229, v229, v237
    v_mul_f32 v230, v230, v238
    v_mul_f32 v231, v231, v239
    v_mul_f32 v232, v232, v240
    v_mul_f32 v233, v233, v241
    v_mul_f32 v234, v234, v242
    v_mul_f32 v235, v235, v243
    v_cvt_pk_bf16_f32 v236, v228, v229
    v_cvt_pk_bf16_f32 v237, v230, v231
    v_cvt_pk_bf16_f32 v238, v232, v233
    v_cvt_pk_bf16_f32 v239, v234, v235
    buffer_store_dwordx4 v[236:239], v1, s[44:47], s14 offen offset:2048 sc1
    s_lshl_b32 s15, s48, 6
    s_lshl_b32 s61, s49, 2
    s_add_u32 s15, s15, s61
    s_add_u32 s15, s15, 40960
    s_waitcnt vmcnt(0)
    s_mov_b64 exec, 1
    buffer_store_dword v15, v1, s[44:47], s15 offen
    s_mov_b64 exec, -1
    s_and_b32 s10, s66, 1
    s_lshl_b32 s10, s10, 1
    s_add_u32 s10, s10, s49
    s_sub_u32 s10, s10, 14
    s_lshl_b32 s10, s10, 2
    s_add_u32 s10, s10, s3
    s_mul_i32 s10, s10, 207872
    s_add_u32 s10, s10, 8323072
    v_lshlrev_b32 v6, 7, v0
    buffer_load_dword v100, v6, s[44:47], s10 offen
    s_add_u32 s10, s10, 8192
    buffer_load_dword v101, v6, s[44:47], s10 offen
    s_add_u32 s10, s10, 8192
    buffer_load_dword v102, v6, s[44:47], s10 offen
    s_add_u32 s10, s10, 8192
    buffer_load_dword v103, v6, s[44:47], s10 offen
    s_add_u32 s10, s10, 8192
    buffer_load_dword v104, v6, s[44:47], s10 offen
    s_add_u32 s10, s10, 8192
    buffer_load_dword v105, v6, s[44:47], s10 offen
    s_add_u32 s10, s10, 122880
    buffer_load_dword v106, v6, s[44:47], s10 offen
    s_add_u32 s10, s10, 8192
    buffer_load_dword v107, v6, s[44:47], s10 offen
    s_add_u32 s10, s10, 8192
    buffer_load_dword v108, v6, s[44:47], s10 offen
    s_add_u32 s10, s10, 8192
    buffer_load_dword v109, v6, s[44:47], s10 offen
    s_add_u32 s10, s10, 8192
    buffer_load_dword v110, v6, s[44:47], s10 offen
    s_add_u32 s10, s10, 8192
    buffer_load_dword v111, v6, s[44:47], s10 offen
    s_add_u32 s10, s10, 8192
    s_waitcnt vmcnt(0) lgkmcnt(0)
L_F0_join:
    s_mul_i32 s7, s48, 28672
    s_add_u32 s7, s7, 4849664
    s_lshl_b32 s60, s48, 12
    s_add_u32 s60, s60, 131072
    s_barrier
    s_add_u32 s10, s55, 114688
    s_mov_b32 m0, s10
    s_add_u32 s11, s8, 0
    buffer_load_dwordx4 v1, s[44:47], s11 offen offset:0 lds
    buffer_load_dwordx4 v1, s[44:47], s11 offen offset:1024 lds
    buffer_load_dwordx4 v1, s[44:47], s11 offen offset:2048 lds
    buffer_load_dwordx4 v1, s[44:47], s11 offen offset:3072 lds
    s_add_u32 s10, s55, 131072
    s_mov_b32 m0, s10
    s_add_u32 s11, s8, 16384
    buffer_load_dwordx4 v1, s[44:47], s11 offen offset:0 lds
    buffer_load_dwordx4 v1, s[44:47], s11 offen offset:1024 lds
    buffer_load_dwordx4 v1, s[44:47], s11 offen offset:2048 lds
    buffer_load_dwordx4 v1, s[44:47], s11 offen offset:3072 lds
    s_add_u32 s10, s55, 147456
    s_mov_b32 m0, s10
    s_add_u32 s11, s8, 32768
    buffer_load_dwordx4 v1, s[44:47], s11 offen offset:0 lds
    buffer_load_dwordx4 v1, s[44:47], s11 offen offset:1024 lds
    buffer_load_dwordx4 v1, s[44:47], s11 offen offset:2048 lds
    buffer_load_dwordx4 v1, s[44:47], s11 offen offset:3072 lds
    v_min_u32 v7, 13, v0
    v_lshlrev_b32 v7, 2, v7
    s_lshl_b32 s38, s48, 6
    s_add_u32 s38, s38, 24576
    buffer_load_dword v6, v7, s[44:47], s38 offen sc1
    s_mov_b32 s62, 0
L7_chk:
    s_waitcnt vmcnt(0)
    v_cmp_ne_u32 vcc, s42, v6
    s_add_u32 s62, s62, 1
    s_cmp_lt_u32 s62, 0x20000
    s_cselect_b64 s[64:65], vcc, 0
    s_cmp_eq_u64 s[64:65], 0
    s_cbranch_scc1 L7_ok
    s_sleep 1
    buffer_load_dword v6, v7, s[44:47], s38 offen sc1
    s_waitcnt vmcnt(0) lgkmcnt(0)
    s_branch L7_chk
L7_ok:
    buffer_load_dwordx4 v[16:19], v12, s[44:47], s7 offen offset:0 sc1
    buffer_load_dwordx4 v[20:23], v12, s[44:47], s7 offen offset:256 sc1
    buffer_load_dwordx4 v[24:27], v12, s[44:47], s7 offen offset:512 sc1
    buffer_load_dwordx4 v[28:31], v12, s[44:47], s7 offen offset:768 sc1
    buffer_load_dwordx4 v[32:35], v12, s[44:47], s7 offen offset:1024 sc1
    buffer_load_dwordx4 v[36:39], v12, s[44:47], s7 offen offset:1280 sc1
    buffer_load_dwordx4 v[40:43], v12, s[44:47], s7 offen offset:1536 sc1
    buffer_load_dwordx4 v[44:47], v12, s[44:47], s7 offen offset:1792 sc1
    buffer_load_dwordx4 v[48:51], v12, s[44:47], s7 offen offset:2048 sc1
    s_barrier
    ds_read_b128 a[224:227], v2 offset:49152
    ds_read_b128 a[228:231], v2 offset:50176
    ds_read_b128 a[232:235], v2 offset:51200
    ds_read_b128 a[236:239], v2 offset:52224
    s_waitcnt vmcnt(8) lgkmcnt(3)
    v_mfma_f32_32x32x16_bf16 v[132:147], a[224:227], v[16:19], 0
    ds_read_b128 a[240:243], v2 offset:53248
    buffer_load_dwordx4 v[52:55], v12, s[44:47], s7 offen offset:2304 sc1
    s_waitcnt lgkmcnt(3)
    v_mfma_f32_32x32x16_bf16 v[148:163], a[228:231], v[16:19], 0
    ds_read_b128 a[244:247], v2 offset:54272
    s_waitcnt lgkmcnt(3)
    v_mfma_f32_32x32x16_bf16 v[164:179], a[232:235], v[16:19], 0
    ds_read_b128 a[248:251], v2 offset:55296
    s_waitcnt vmcnt(8) lgkmcnt(3)
    v_mfma_f32_32x32x16_bf16 v[132:147], a[236:239], v[20:23], v[132:147]
    ds_read_b128 a[252:255], v2 offset:56320
    buffer_load_dwordx4 v[56:59], v12, s[44:47], s7 offen offset:2560 sc1
    s_waitcnt lgkmcnt(3)
    v_mfma_f32_32x32x16_bf16 v[148:163], a[240:243], v[20:23], v[148:163]
    ds_read_b128 a[224:227], v2 offset:57344
    s_waitcnt lgkmcnt(3)
    v_mfma_f32_32x32x16_bf16 v[164:179], a[244:247], v[20:23], v[164:179]
    ds_read_b128 a[228:231], v2 offset:58368
    s_waitcnt vmcnt(8) lgkmcnt(3)
    v_mfma_f32_32x32x16_bf16 v[132:147], a[248:251], v[24:27], v[132:147]
    ds_read_b128 a[232:235], v2 offset:59392
    buffer_load_dwordx4 v[60:63], v12, s[44:47], s7 offen offset:2816 sc1
    s_waitcnt lgkmcnt(3)
    v_mfma_f32_32x32x16_bf16 v[148:163], a[252:255], v[24:27], v[148:163]
    ds_read_b128 a[236:239], v2 offset:60416
    s_waitcnt lgkmcnt(3)
    v_mfma_f32_32x32x16_bf16 v[164:179], a[224:227], v[24:27], v[164:179]
    ds_read_b128 a[240:243], v2 offset:61440
    s_waitcnt vmcnt(8) lgkmcnt(3)
    v_mfma_f32_32x32x16_bf16 v[132:147], a[228:231], v[28:31], v[132:147]
    ds_read_b128 a[244:247], v2 offset:62464
    buffer_load_dwordx4 v[64:67], v12, s[44:47], s7 offen offset:3072 sc1
    s_waitcnt lgkmcnt(3)
    v_mfma_f32_32x32x16_bf16 v[148:163], a[232:235], v[28:31], v[148:163]
    ds_read_b128 a[248:251], v2 offset:63488
    s_waitcnt lgkmcnt(3)
    v_mfma_f32_32x32x16_bf16 v[164:179], a[236:239], v[28:31], v[164:179]
    ds_read_b128 a[252:255], v2 offset:64512
    s_waitcnt vmcnt(8) lgkmcnt(3)
    v_mfma_f32_32x32x16_bf16 v[132:147], a[240:243], v[32:35], v[132:147]
    ds_read_b128 a[224:227], v3 offset:0
    buffer_load_dwordx4 v[68:71], v12, s[44:47], s7 offen offset:3328 sc1
    s_waitcnt lgkmcnt(3)
    v_mfma_f32_32x32x16_bf16 v[148:163], a[244:247], v[32:35], v[148:163]
    ds_read_b128 a[228:231], v3 offset:1024
    s_waitcnt lgkmcnt(3)
    v_mfma_f32_32x32x16_bf16 v[164:179], a[248:251], v[32:35], v[164:179]
    ds_read_b128 a[232:235], v3 offset:2048
    s_waitcnt vmcnt(8) lgkmcnt(3)
    v_mfma_f32_32x32x16_bf16 v[132:147], a[252:255], v[36:39], v[132:147]
    ds_read_b128 a[236:239], v3 offset:3072
    buffer_load_dwordx4 v[72:75], v12, s[44:47], s7 offen offset:3584 sc1
    s_waitcnt lgkmcnt(3)
    v_mfma_f32_32x32x16_bf16 v[148:163], a[224:227], v[36:39], v[148:163]
    ds_read_b128 a[240:243], v3 offset:4096
    s_waitcnt lgkmcnt(3)
    v_mfma_f32_32x32x16_bf16 v[164:179], a[228:231], v[36:39], v[164:179]
    ds_read_b128 a[244:247], v3 offset:5120
    s_waitcnt vmcnt(8) lgkmcnt(3)
    v_mfma_f32_32x32x16_bf16 v[132:147], a[232:235], v[40:43], v[132:147]
    ds_read_b128 a[248:251], v3 offset:6144
    buffer_load_dwordx4 v[76:79], v12, s[44:47], s7 offen offset:3840 sc1
    s_waitcnt lgkmcnt(3)
    v_mfma_f32_32x32x16_bf16 v[148:163], a[236:239], v[40:43], v[148:163]
    ds_read_b128 a[252:255], v3 offset:7168
    s_waitcnt lgkmcnt(3)
    v_mfma_f32_32x32x16_bf16 v[164:179], a[240:243], v[40:43], v[164:179]
    ds_read_b128 a[224:227], v3 offset:8192
    s_waitcnt vmcnt(8) lgkmcnt(3)
    v_mfma_f32_32x32x16_bf16 v[132:147], a[244:247], v[44:47], v[132:147]
    ds_read_b128 a[228:231], v3 offset:9216
    s_add_u32 s7, s7, 4096
    buffer_load_dwordx4 v[80:83], v12, s[44:47], s7 offen offset:0 sc1
    s_waitcnt lgkmcnt(3)
    v_mfma_f32_32x32x16_bf16 v[148:163], a[248:251], v[44:47], v[148:163]
    ds_read_b128 a[232:235], v3 offset:10240
    s_waitcnt lgkmcnt(3)
    v_mfma_f32_32x32x16_bf16 v[164:179], a[252:255], v[44:47], v[164:179]
    ds_read_b128 a[236:239], v3 offset:11264
    s_waitcnt vmcnt(8) lgkmcnt(3)
    v_mfma_f32_32x32x16_bf16 v[132:147], a[224:227], v[48:51], v[132:147]
    ds_read_b128 a[240:243], v3 offset:12288
    buffer_load_dwordx4 v[84:87], v12, s[44:47], s7 offen offset:256 sc1
    s_waitcnt lgkmcnt(3)
    v_mfma_f32_32x32x16_bf16 v[148:163], a[228:231], v[48:51], v[148:163]
    ds_read_b128 a[244:247], v3 offset:13312
    s_waitcnt lgkmcnt(3)
    v_mfma_f32_32x32x16_bf16 v[164:179], a[232:235], v[48:51], v[164:179]
    ds_read_b128 a[248:251], v3 offset:14336
    s_waitcnt vmcnt(8) lgkmcnt(3)
    v_mfma_f32_32x32x16_bf16 v[132:147], a[236:239], v[52:55], v[132:147]
    ds_read_b128 a[252:255], v3 offset:15360
    buffer_load_dwordx4 v[88:91], v12, s[44:47], s7 offen offset:512 sc1
    s_waitcnt lgkmcnt(3)
    v_mfma_f32_32x32x16_bf16 v[148:163], a[240:243], v[52:55], v[148:163]
    ds_read_b128 a[224:227], v3 offset:16384
    s_waitcnt lgkmcnt(3)
    v_mfma_f32_32x32x16_bf16 v[164:179], a[244:247], v[52:55], v[164:179]
    ds_read_b128 a[228:231], v3 offset:17408
    s_waitcnt vmcnt(8) lgkmcnt(3)
    v_mfma_f32_32x32x16_bf16 v[132:147], a[248:251], v[56:59], v[132:147]
    ds_read_b128 a[232:235], v3 offset:18432
    buffer_load_dwordx4 v[92:95], v12, s[44:47], s7 offen offset:768 sc1
    s_waitcnt lgkmcnt(3)
    v_mfma_f32_32x32x16_bf16 v[148:163], a[252:255], v[56:59], v[148:163]
    ds_read_b128 a[236:239], v3 offset:19456
    s_waitcnt lgkmcnt(3)
    v_mfma_f32_32x32x16_bf16 v[164:179], a[224:227], v[56:59], v[164:179]
    ds_read_b128 a[240:243], v3 offset:20480
    buffer_load_dwordx2 v[244:245], v9, s[44:47], s60 offen offset:0 sc1
    buffer_load_dwordx2 v[246:247], v9, s[44:47], s60 offen offset:64 sc1
    buffer_load_dwordx2 v[248:249], v9, s[44:47], s60 offen offset:128 sc1
    buffer_load_dwordx2 v[250:251], v9, s[44:47], s60 offen offset:192 sc1
    buffer_load_dwordx2 v[252:253], v9, s[44:47], s60 offen offset:256 sc1
    buffer_load_dwordx2 v[254:255], v9, s[44:47], s60 offen offset:320 sc1
    buffer_load_dwordx2 v[10:11], v9, s[44:47], s60 offen offset:384 sc1
    s_waitcnt vmcnt(15) lgkmcnt(3)
    v_mfma_f32_32x32x16_bf16 v[132:147], a[228:231], v[60:63], v[132:147]
    ds_read_b128 a[244:247], v3 offset:21504
    buffer_load_dwordx4 v[96:99], v12, s[44:47], s7 offen offset:1024 sc1
    s_waitcnt lgkmcnt(3)
    v_mfma_f32_32x32x16_bf16 v[148:163], a[232:235], v[60:63], v[148:163]
    ds_read_b128 a[248:251], v3 offset:22528
    s_waitcnt lgkmcnt(3)
    v_mfma_f32_32x32x16_bf16 v[164:179], a[236:239], v[60:63], v[164:179]
    ds_read_b128 a[252:255], v3 offset:23552
    s_waitcnt vmcnt(15) lgkmcnt(3)
    v_mfma_f32_32x32x16_bf16 v[132:147], a[240:243], v[64:67], v[132:147]
    ds_read_b128 a[224:227], v3 offset:24576
    buffer_load_dwordx4 v[100:103], v12, s[44:47], s7 offen offset:1280 sc1
    s_waitcnt lgkmcnt(3)
    v_mfma_f32_32x32x16_bf16 v[148:163], a[244:247], v[64:67], v[148:163]
    ds_read_b128 a[228:231], v3 offset:25600
    s_waitcnt lgkmcnt(3)
    v_mfma_f32_32x32x16_bf16 v[164:179], a[248:251], v[64:67], v[164:179]
    ds_read_b128 a[232:235], v3 offset:26624
    s_waitcnt vmcnt(15) lgkmcnt(3)
    v_mfma_f32_32x32x16_bf16 v[132:147], a[252:255], v[68:71], v[132:147]
    ds_read_b128 a[236:239], v3 offset:27648
    buffer_load_dwordx4 v[104:107], v12, s[44:47], s7 offen offset:1536 sc1
    s_waitcnt lgkmcnt(3)
    v_mfma_f32_32x32x16_bf16 v[148:163], a[224:227], v[68:71], v[148:163]
    ds_read_b128 a[240:243], v3 offset:28672
    s_waitcnt lgkmcnt(3)
    v_mfma_f32_32x32x16_bf16 v[164:179], a[228:231], v[68:71], v[164:179]
    ds_read_b128 a[244:247], v3 offset:29696
    s_waitcnt vmcnt(15) lgkmcnt(3)
    v_mfma_f32_32x32x16_bf16 v[132:147], a[232:235], v[72:75], v[132:147]
    ds_read_b128 a[248:251], v3 offset:30720
    buffer_load_dwordx4 v[108:111], v12, s[44:47], s7 offen offset:1792 sc1
    s_waitcnt lgkmcnt(3)
    v_mfma_f32_32x32x16_bf16 v[148:163], a[236:239], v[72:75], v[148:163]
    ds_read_b128 a[252:255], v3 offset:31744
    s_waitcnt lgkmcnt(3)
    v_mfma_f32_32x32x16_bf16 v[164:179], a[240:243], v[72:75], v[164:179]
    ds_read_b128 a[224:227], v1 offset:0
    s_waitcnt vmcnt(15) lgkmcnt(3)
    v_mfma_f32_32x32x16_bf16 v[132:147], a[244:247], v[76:79], v[132:147]
    ds_read_b128 a[228:231], v1 offset:1024
    buffer_load_dwordx4 v[112:115], v12, s[44:47], s7 offen offset:2048 sc1
    s_waitcnt lgkmcnt(3)
    v_mfma_f32_32x32x16_bf16 v[148:163], a[248:251], v[76:79], v[148:163]
    ds_read_b128 a[232:235], v1 offset:2048
    s_waitcnt lgkmcnt(3)
    v_mfma_f32_32x32x16_bf16 v[164:179], a[252:255], v[76:79], v[164:179]
    ds_read_b128 a[236:239], v1 offset:3072
    s_waitcnt vmcnt(15) lgkmcnt(3)
    v_mfma_f32_32x32x16_bf16 v[132:147], a[224:227], v[80:83], v[132:147]
    ds_read_b128 a[240:243], v1 offset:4096
    buffer_load_dwordx4 v[116:119], v12, s[44:47], s7 offen offset:2304 sc1
    s_waitcnt lgkmcnt(3)
    v_mfma_f32_32x32x16_bf16 v[148:163], a[228:231], v[80:83], v[148:163]
    s_barrier
    ds_read_b128 a[244:247], v1 offset:5120
    s_waitcnt lgkmcnt(3)
    v_mfma_f32_32x32x16_bf16 v[164:179], a[232:235], v[80:83], v[164:179]
    ds_read_b128 a[248:251], v1 offset:6144
    s_waitcnt vmcnt(15) lgkmcnt(3)
    v_mfma_f32_32x32x16_bf16 v[132:147], a[236:239], v[84:87], v[132:147]
    ds_read_b128 a[252:255], v1 offset:7168
    buffer_load_dwordx4 v[120:123], v12, s[44:47], s7 offen offset:2560 sc1
    s_waitcnt lgkmcnt(3)
    v_mfma_f32_32x32x16_bf16 v[148:163], a[240:243], v[84:87], v[148:163]
    ds_read_b128 a[224:227], v1 offset:8192
    s_waitcnt lgkmcnt(3)
    v_mfma_f32_32x32x16_bf16 v[164:179], a[244:247], v[84:87], v[164:179]
    ds_read_b128 a[228:231], v1 offset:9216
    s_waitcnt vmcnt(15) lgkmcnt(3)
    v_mfma_f32_32x32x16_bf16 v[132:147], a[248:251], v[88:91], v[132:147]
    ds_read_b128 a[232:235], v1 offset:10240
    buffer_load_dwordx4 v[124:127], v12, s[44:47], s7 offen offset:2816 sc1
    s_waitcnt lgkmcnt(3)
    v_mfma_f32_32x32x16_bf16 v[148:163], a[252:255], v[88:91], v[148:163]
    ds_read_b128 a[236:239], v1 offset:11264
    s_waitcnt lgkmcnt(3)
    v_mfma_f32_32x32x16_bf16 v[164:179], a[224:227], v[88:91], v[164:179]
    ds_read_b128 a[240:243], v1 offset:12288
    s_add_u32 s10, s55, 114688
    s_mov_b32 m0, s10
    s_add_u32 s11, s8, 163840
    buffer_load_dwordx4 v1, s[44:47], s11 offen offset:0 lds
    s_waitcnt vmcnt(16) lgkmcnt(3)
    v_mfma_f32_32x32x16_bf16 v[132:147], a[228:231], v[92:95], v[132:147]
    ds_read_b128 a[244:247], v1 offset:13312
    s_waitcnt vmcnt(14)
    v_add_f32 v244, v244, v246
    v_add_f32 v245, v245, v247
    s_waitcnt vmcnt(13)
    v_add_f32 v244, v244, v248
    s_waitcnt lgkmcnt(3)
    v_mfma_f32_32x32x16_bf16 v[148:163], a[232:235], v[92:95], v[148:163]
    ds_read_b128 a[248:251], v1 offset:14336
    buffer_load_dwordx4 v1, s[44:47], s11 offen offset:1024 lds
    v_add_f32 v245, v245, v249
    s_waitcnt vmcnt(13)
    v_add_f32 v244, v244, v250
    v_add_f32 v245, v245, v251
    s_waitcnt lgkmcnt(3)
    v_mfma_f32_32x32x16_bf16 v[164:179], a[236:239], v[92:95], v[164:179]
    ds_read_b128 a[252:255], v1 offset:15360
    s_waitcnt vmcnt(12)
    v_add_f32 v244, v244, v252
    v_add_f32 v245, v245, v253
    s_waitcnt vmcnt(11)
    v_add_f32 v244, v244, v254
    s_waitcnt vmcnt(9) lgkmcnt(3)
    v_mfma_f32_32x32x16_bf16 v[132:147], a[240:243], v[96:99], v[132:147]
    ds_read_b128 a[224:227], v1 offset:16384
    buffer_load_dwordx4 v1, s[44:47], s11 offen offset:2048 lds
    v_add_f32 v245, v245, v255
    v_add_f32 v4, v244, v10
    v_add_f32 v5, v245, v11
    s_waitcnt lgkmcnt(3)
    v_mfma_f32_32x32x16_bf16 v[148:163], a[244:247], v[96:99], v[148:163]
    ds_read_b128 a[228:231], v1 offset:17408
    v_mov_b32 v6, v4
    s_nop 1
    v_permlane32_swap_b32 v4, v6
    v_add_f32 v4, v4, v6
    s_waitcnt lgkmcnt(3)
    v_mfma_f32_32x32x16_bf16 v[164:179], a[248:251], v[96:99], v[164:179]
    ds_read_b128 a[232:235], v1 offset:18432
    buffer_load_dwordx4 v1, s[44:47], s11 offen offset:3072 lds
    v_mov_b32 v6, v5
    s_nop 1
    v_permlane32_swap_b32 v5, v6
    v_add_f32 v5, v5, v6
    s_waitcnt vmcnt(10) lgkmcnt(3)
    v_mfma_f32_32x32x16_bf16 v[132:147], a[252:255], v[100:103], v[132:147]
    ds_read_b128 a[236:239], v1 offset:19456
    v_mul_f32 v4, 0xbb124925, v4
    v_mul_f32 v5, 0x3b124925, v5
    v_fma_f32 v5, -v4, v4, v5
    s_waitcnt lgkmcnt(3)
    v_mfma_f32_32x32x16_bf16 v[148:163], a[224:227], v[100:103], v[148:163]
    ds_read_b128 a[240:243], v1 offset:20480
    s_add_u32 s10, s55, 131072
    s_mov_b32 m0, s10
    s_add_u32 s11, s8, 180224
    buffer_load_dwordx4 v1, s[44:47], s11 offen offset:0 lds
    v_max_f32 v5, 0, v5
    v_add_f32 v5, 0x3727c5ac, v5
    v_rcp_f32 v5, v5
    s_waitcnt lgkmcnt(3)
    v_mfma_f32_32x32x16_bf16 v[164:179], a[228:231], v[100:103], v[164:179]
    ds_read_b128 a[244:247], v1 offset:21504
    v_cvt_pk_bf16_f32 v128, v4, v4
    v_lshlrev_b32 v6, 16, v128
    v_sub_f32 v6, v4, v6
    s_waitcnt vmcnt(10) lgkmcnt(3)
    v_mfma_f32_32x32x16_bf16 v[132:147], a[232:235], v[104:107], v[132:147]
    ds_read_b128 a[248:251], v1 offset:22528
    buffer_load_dwordx4 v1, s[44:47], s11 offen offset:1024 lds
    v_cvt_pk_bf16_f32 v129, v6, v6
    v_mov_b32 v130, v128
    v_mov_b32 v131, v129
    s_waitcnt lgkmcnt(3)
    v_mfma_f32_32x32x16_bf16 v[148:163], a[236:239], v[104:107], v[148:163]
    ds_read_b128 a[252:255], v1 offset:23552
    v_lshrrev_b32 v6, 1, v8
    s_lshl_b32 s15, s48, 7
    s_add_u32 s15, s15, 65536
    s_waitcnt lgkmcnt(3)
    v_mfma_f32_32x32x16_bf16 v[164:179], a[240:243], v[104:107], v[164:179]
    ds_read_b128 a[224:227], v1 offset:24576
    buffer_load_dwordx4 v1, s[44:47], s11 offen offset:2048 lds
    buffer_store_dword v5, v6, s[44:47], s15 offen
    s_waitcnt vmcnt(12) lgkmcnt(3)
    v_mfma_f32_32x32x16_bf16 v[132:147], a[244:247], v[108:111], v[132:147]
    ds_read_b128 a[228:231], v1 offset:25600
    s_waitcnt lgkmcnt(3)
    v_mfma_f32_32x32x16_bf16 v[148:163], a[248:251], v[108:111], v[148:163]
    ds_read_b128 a[232:235], v1 offset:26624
    buffer_load_dwordx4 v1, s[44:47], s11 offen offset:3072 lds
    s_waitcnt lgkmcnt(3)
    v_mfma_f32_32x32x16_bf16 v[164:179], a[252:255], v[108:111], v[164:179]
    ds_read_b128 a[236:239], v1 offset:27648
    s_waitcnt vmcnt(12) lgkmcnt(3)
    v_mfma_f32_32x32x16_bf16 v[132:147], a[224:227], v[112:115], v[132:147]
    ds_read_b128 a[240:243], v1 offset:28672
    s_add_u32 s10, s55, 147456
    s_mov_b32 m0, s10
    s_add_u32 s11, s8, 196608
    buffer_load_dwordx4 v1, s[44:47], s11 offen offset:0 lds
    s_waitcnt lgkmcnt(3)
    v_mfma_f32_32x32x16_bf16 v[148:163], a[228:231], v[112:115], v[148:163]
    ds_read_b128 a[244:247], v1 offset:29696
    s_waitcnt lgkmcnt(3)
    v_mfma_f32_32x32x16_bf16 v[164:179], a[232:235], v[112:115], v[164:179]
    ds_read_b128 a[248:251], v1 offset:30720
    buffer_load_dwordx4 v1, s[44:47], s11 offen offset:1024 lds
    s_waitcnt vmcnt(13) lgkmcnt(3)
    v_mfma_f32_32x32x16_bf16 v[132:147], a[236:239], v[116:119], v[132:147]
    ds_read_b128 a[252:255], v1 offset:31744
    s_waitcnt lgkmcnt(3)
    v_mfma_f32_32x32x16_bf16 v[148:163], a[240:243], v[116:119], v[148:163]
    ds_read_b128 a[224:227], v1 offset:32768
    buffer_load_dwordx4 v1, s[44:47], s11 offen offset:2048 lds
    s_waitcnt lgkmcnt(3)
    v_mfma_f32_32x32x16_bf16 v[164:179], a[244:247], v[116:119], v[164:179]
    ds_read_b128 a[228:231], v1 offset:33792
    s_waitcnt vmcnt(13) lgkmcnt(3)
    v_mfma_f32_32x32x16_bf16 v[132:147], a[248:251], v[120:123], v[132:147]
    ds_read_b128 a[232:235], v1 offset:34816
    buffer_load_dwordx4 v1, s[44:47], s11 offen offset:3072 lds
    s_waitcnt lgkmcnt(3)
    v_mfma_f32_32x32x16_bf16 v[148:163], a[252:255], v[120:123], v[148:163]
    ds_read_b128 a[236:239], v1 offset:35840
    s_waitcnt lgkmcnt(3)
    v_mfma_f32_32x32x16_bf16 v[164:179], a[224:227], v[120:123], v[164:179]
    ds_read_b128 a[240:243], v1 offset:36864
    s_waitcnt vmcnt(13) lgkmcnt(3)
    v_mfma_f32_32x32x16_bf16 v[132:147], a[228:231], v[124:127], v[132:147]
    ds_read_b128 a[244:247], v1 offset:37888
    s_waitcnt lgkmcnt(3)
    v_mfma_f32_32x32x16_bf16 v[148:163], a[232:235], v[124:127], v[148:163]
    ds_read_b128 a[248:251], v1 offset:38912
    s_waitcnt lgkmcnt(3)
    v_mfma_f32_32x32x16_bf16 v[164:179], a[236:239], v[124:127], v[164:179]
    ds_read_b128 a[252:255], v1 offset:39936
    s_waitcnt lgkmcnt(3)
    v_mfma_f32_32x32x16_bf16 v[132:147], a[240:243], v[128:131], v[132:147]
    ds_read_b128 a[224:227], v1 offset:40960
    s_waitcnt lgkmcnt(3)
    v_mfma_f32_32x32x16_bf16 v[148:163], a[244:247], v[128:131], v[148:163]
    ds_read_b128 a[228:231], v1 offset:41984
    s_waitcnt lgkmcnt(3)
    v_mfma_f32_32x32x16_bf16 v[164:179], a[248:251], v[128:131], v[164:179]
    ds_read_b128 a[232:235], v1 offset:43008
    s_waitcnt lgkmcnt(3)
    v_mfma_f32_32x32x16_bf16 v[180:195], a[252:255], v[16:19], 0
    ds_read_b128 a[236:239], v1 offset:44032
    s_waitcnt lgkmcnt(3)
    v_mfma_f32_32x32x16_bf16 v[196:211], a[224:227], v[16:19], 0
    ds_read_b128 a[240:243], v1 offset:45056
    v_max_f32 v132, 0, v132
    v_max_f32 v133, 0, v133
    v_max_f32 v134, 0, v134
    s_waitcnt lgkmcnt(3)
    v_mfma_f32_32x32x16_bf16 v[180:195], a[228:231], v[20:23], v[180:195]
    ds_read_b128 a[244:247], v1 offset:46080
    v_max_f32 v135, 0, v135
    v_max_f32 v136, 0, v136
    v_max_f32 v137, 0, v137
    s_waitcnt lgkmcnt(3)
    v_mfma_f32_32x32x16_bf16 v[196:211], a[232:235], v[20:23], v[196:211]
    ds_read_b128 a[248:251], v1 offset:47104
    v_max_f32 v138, 0, v138
    v_max_f32 v139, 0, v139
    v_mul_f32 v132, v132, v140
    s_waitcnt lgkmcnt(3)
    v_mfma_f32_32x32x16_bf16 v[180:195], a[236:239], v[24:27], v[180:195]
    ds_read_b128 a[252:255], v1 offset:48128
    v_mul_f32 v133, v133, v141
    v_mul_f32 v134, v134, v142
    v_mul_f32 v135, v135, v143
    s_waitcnt lgkmcnt(3)
    v_mfma_f32_32x32x16_bf16 v[196:211], a[240:243], v[24:27], v[196:211]
    ds_read_b128 a[224:227], v1 offset:49152
    v_mul_f32 v136, v136, v144
    v_mul_f32 v137, v137, v145
    v_mul_f32 v138, v138, v146
    s_waitcnt lgkmcnt(3)
    v_mfma_f32_32x32x16_bf16 v[180:195], a[244:247], v[28:31], v[180:195]
    ds_read_b128 a[228:231], v1 offset:50176
    v_mul_f32 v139, v139, v147
    v_cvt_pk_bf16_f32 v140, v132, v133
    v_cvt_pk_bf16_f32 v141, v134, v135
    s_waitcnt lgkmcnt(3)
    v_mfma_f32_32x32x16_bf16 v[196:211], a[248:251], v[28:31], v[196:211]
    ds_read_b128 a[232:235], v1 offset:51200
    v_cvt_pk_bf16_f32 v142, v136, v137
    v_cvt_pk_bf16_f32 v143, v138, v139
    buffer_store_dwordx4 v[140:143], v1, s[44:47], s13 offen offset:0
    s_waitcnt lgkmcnt(3)
    v_mfma_f32_32x32x16_bf16 v[180:195], a[252:255], v[32:35], v[180:195]
    ds_read_b128 a[236:239], v1 offset:52224
    v_max_f32 v148, 0, v148
    v_max_f32 v149, 0, v149
    v_max_f32 v150, 0, v150
    s_waitcnt lgkmcnt(3)
    v_mfma_f32_32x32x16_bf16 v[196:211], a[224:227], v[32:35], v[196:211]
    ds_read_b128 a[240:243], v1 offset:53248
    v_max_f32 v151, 0, v151
    v_max_f32 v152, 0, v152
    v_max_f32 v153, 0, v153
    s_waitcnt lgkmcnt(3)
    v_mfma_f32_32x32x16_bf16 v[180:195], a[228:231], v[36:39], v[180:195]
    ds_read_b128 a[244:247], v1 offset:54272
    v_max_f32 v154, 0, v154
    v_max_f32 v155, 0, v155
    v_mul_f32 v148, v148, v156
    s_waitcnt lgkmcnt(3)
    v_mfma_f32_32x32x16_bf16 v[196:211], a[232:235], v[36:39], v[196:211]
    ds_read_b128 a[248:251], v1 offset:55296
    v_mul_f32 v149, v149, v157
    v_mul_f32 v150, v150, v158
    v_mul_f32 v151, v151, v159
    s_waitcnt lgkmcnt(3)
    v_mfma_f32_32x32x16_bf16 v[180:195], a[236:239], v[40:43], v[180:195]
    ds_read_b128 a[252:255], v1 offset:56320
    v_mul_f32 v152, v152, v160
    v_mul_f32 v153, v153, v161
    v_mul_f32 v154, v154, v162
    s_waitcnt lgkmcnt(3)
    v_mfma_f32_32x32x16_bf16 v[196:211], a[240:243], v[40:43], v[196:211]
    ds_read_b128 a[224:227], v1 offset:57344
    v_mul_f32 v155, v155, v163
    v_cvt_pk_bf16_f32 v156, v148, v149
    v_cvt_pk_bf16_f32 v157, v150, v151
    s_waitcnt lgkmcnt(3)
    v_mfma_f32_32x32x16_bf16 v[180:195], a[244:247], v[44:47], v[180:195]
    ds_read_b128 a[228:231], v1 offset:58368
    v_cvt_pk_bf16_f32 v158, v152, v153
    v_cvt_pk_bf16_f32 v159, v154, v155
    buffer_store_dwordx4 v[156:159], v1, s[44:47], s13 offen offset:1024
    s_waitcnt lgkmcnt(3)
    v_mfma_f32_32x32x16_bf16 v[196:211], a[248:251], v[44:47], v[196:211]
    ds_read_b128 a[232:235], v1 offset:59392
    v_max_f32 v164, 0, v164
    v_max_f32 v165, 0, v165
    v_max_f32 v166, 0, v166
    s_waitcnt lgkmcnt(3)
    v_mfma_f32_32x32x16_bf16 v[180:195], a[252:255], v[48:51], v[180:195]
    ds_read_b128 a[236:239], v1 offset:60416
    v_max_f32 v167, 0, v167
    v_max_f32 v168, 0, v168
    v_max_f32 v169, 0, v169
    s_waitcnt lgkmcnt(3)
    v_mfma_f32_32x32x16_bf16 v[196:211], a[224:227], v[48:51], v[196:211]
    ds_read_b128 a[240:243], v1 offset:61440
    v_max_f32 v170, 0, v170
    v_max_f32 v171, 0, v171
    v_mul_f32 v164, v164, v172
    s_waitcnt lgkmcnt(3)
    v_mfma_f32_32x32x16_bf16 v[180:195], a[228:231], v[52:55], v[180:195]
    ds_read_b128 a[244:247], v1 offset:62464
    v_mul_f32 v165, v165, v173
    v_mul_f32 v166, v166, v174
    v_mul_f32 v167, v167, v175
    s_waitcnt lgkmcnt(3)
    v_mfma_f32_32x32x16_bf16 v[196:211], a[232:235], v[52:55], v[196:211]
    ds_read_b128 a[248:251], v1 offset:63488
    v_mul_f32 v168, v168, v176
    v_mul_f32 v169, v169, v177
    v_mul_f32 v170, v170, v178
    s_waitcnt lgkmcnt(3)
    v_mfma_f32_32x32x16_bf16 v[180:195], a[236:239], v[56:59], v[180:195]
    ds_read_b128 a[252:255], v1 offset:64512
    v_mul_f32 v171, v171, v179
    v_cvt_pk_bf16_f32 v172, v164, v165
    v_cvt_pk_bf16_f32 v173, v166, v167
    s_waitcnt lgkmcnt(3)
    v_mfma_f32_32x32x16_bf16 v[196:211], a[240:243], v[56:59], v[196:211]
    ds_read_b128 a[224:227], v2 offset:0
    v_cvt_pk_bf16_f32 v174, v168, v169
    v_cvt_pk_bf16_f32 v175, v170, v171
    buffer_store_dwordx4 v[172:175], v1, s[44:47], s13 offen offset:2048
    s_waitcnt lgkmcnt(3)
    v_mfma_f32_32x32x16_bf16 v[180:195], a[244:247], v[60:63], v[180:195]
    ds_read_b128 a[228:231], v2 offset:1024
    s_waitcnt lgkmcnt(3)
    v_mfma_f32_32x32x16_bf16 v[196:211], a[248:251], v[60:63], v[196:211]
    ds_read_b128 a[232:235], v2 offset:2048
    s_waitcnt lgkmcnt(3)
    v_mfma_f32_32x32x16_bf16 v[180:195], a[252:255], v[64:67], v[180:195]
    ds_read_b128 a[236:239], v2 offset:3072
    s_waitcnt lgkmcnt(3)
    v_mfma_f32_32x32x16_bf16 v[196:211], a[224:227], v[64:67], v[196:211]
    ds_read_b128 a[240:243], v2 offset:4096
    s_waitcnt lgkmcnt(3)
    v_mfma_f32_32x32x16_bf16 v[180:195], a[228:231], v[68:71], v[180:195]
    ds_read_b128 a[244:247], v2 offset:5120
    s_waitcnt lgkmcnt(3)
    v_mfma_f32_32x32x16_bf16 v[196:211], a[232:235], v[68:71], v[196:211]
    ds_read_b128 a[248:251], v2 offset:6144
    s_waitcnt lgkmcnt(3)
    v_mfma_f32_32x32x16_bf16 v[180:195], a[236:239], v[72:75], v[180:195]
    ds_read_b128 a[252:255], v2 offset:7168
    s_waitcnt lgkmcnt(3)
    v_mfma_f32_32x32x16_bf16 v[196:211], a[240:243], v[72:75], v[196:211]
    ds_read_b128 a[224:227], v2 offset:8192
    s_waitcnt lgkmcnt(3)
    v_mfma_f32_32x32x16_bf16 v[180:195], a[244:247], v[76:79], v[180:195]
    ds_read_b128 a[228:231], v2 offset:9216
    s_waitcnt lgkmcnt(3)
    v_mfma_f32_32x32x16_bf16 v[196:211], a[248:251], v[76:79], v[196:211]
    ds_read_b128 a[232:235], v2 offset:10240
    s_lshl_b32 s15, s48, 6
    s_lshl_b32 s61, s49, 2
    s_add_u32 s15, s15, s61
    s_add_u32 s15, s15, 49152
    s_waitcnt vmcnt(0)
    s_mov_b64 exec, 1
    buffer_store_dword v15, v1, s[44:47], s15 offen
    s_mov_b64 exec, -1
    s_waitcnt lgkmcnt(3)
    v_mfma_f32_32x32x16_bf16 v[180:195], a[252:255], v[80:83], v[180:195]
    ds_read_b128 a[236:239], v2 offset:11264
    s_waitcnt lgkmcnt(3)
    v_mfma_f32_32x32x16_bf16 v[196:211], a[224:227], v[80:83], v[196:211]
    ds_read_b128 a[240:243], v2 offset:12288
    s_waitcnt lgkmcnt(3)
    v_mfma_f32_32x32x16_bf16 v[180:195], a[228:231], v[84:87], v[180:195]
    ds_read_b128 a[244:247], v2 offset:13312
    s_waitcnt lgkmcnt(3)
    v_mfma_f32_32x32x16_bf16 v[196:211], a[232:235], v[84:87], v[196:211]
    ds_read_b128 a[248:251], v2 offset:14336
    s_waitcnt lgkmcnt(3)
    v_mfma_f32_32x32x16_bf16 v[180:195], a[236:239], v[88:91], v[180:195]
    ds_read_b128 a[252:255], v2 offset:15360
    s_waitcnt lgkmcnt(3)
    v_mfma_f32_32x32x16_bf16 v[196:211], a[240:243], v[88:91], v[196:211]
    ds_read_b128 a[224:227], v2 offset:16384
    s_waitcnt lgkmcnt(3)
    v_mfma_f32_32x32x16_bf16 v[180:195], a[244:247], v[92:95], v[180:195]
    ds_read_b128 a[228:231], v2 offset:17408
    s_waitcnt lgkmcnt(3)
    v_mfma_f32_32x32x16_bf16 v[196:211], a[248:251], v[92:95], v[196:211]
    ds_read_b128 a[232:235], v2 offset:18432
    s_waitcnt lgkmcnt(3)
    v_mfma_f32_32x32x16_bf16 v[180:195], a[252:255], v[96:99], v[180:195]
    ds_read_b128 a[236:239], v2 offset:19456
    s_waitcnt lgkmcnt(3)
    v_mfma_f32_32x32x16_bf16 v[196:211], a[224:227], v[96:99], v[196:211]
    ds_read_b128 a[240:243], v2 offset:20480
    s_waitcnt lgkmcnt(3)
    v_mfma_f32_32x32x16_bf16 v[180:195], a[228:231], v[100:103], v[180:195]
    ds_read_b128 a[244:247], v2 offset:21504
    s_waitcnt lgkmcnt(3)
    v_mfma_f32_32x32x16_bf16 v[196:211], a[232:235], v[100:103], v[196:211]
    ds_read_b128 a[248:251], v2 offset:22528
    s_waitcnt lgkmcnt(3)
    v_mfma_f32_32x32x16_bf16 v[180:195], a[236:239], v[104:107], v[180:195]
    ds_read_b128 a[252:255], v2 offset:23552
    s_waitcnt lgkmcnt(3)
    v_mfma_f32_32x32x16_bf16 v[196:211], a[240:243], v[104:107], v[196:211]
    ds_read_b128 a[224:227], v2 offset:24576
    s_waitcnt lgkmcnt(3)
    v_mfma_f32_32x32x16_bf16 v[180:195], a[244:247], v[108:111], v[180:195]
    ds_read_b128 a[228:231], v2 offset:25600
    s_waitcnt lgkmcnt(3)
    v_mfma_f32_32x32x16_bf16 v[196:211], a[248:251], v[108:111], v[196:211]
    ds_read_b128 a[232:235], v2 offset:26624
    s_waitcnt lgkmcnt(3)
    v_mfma_f32_32x32x16_bf16 v[180:195], a[252:255], v[112:115], v[180:195]
    ds_read_b128 a[236:239], v2 offset:27648
    s_waitcnt lgkmcnt(3)
    v_mfma_f32_32x32x16_bf16 v[196:211], a[224:227], v[112:115], v[196:211]
    ds_read_b128 a[240:243], v2 offset:28672
    s_waitcnt lgkmcnt(3)
    v_mfma_f32_32x32x16_bf16 v[180:195], a[228:231], v[116:119], v[180:195]
    ds_read_b128 a[244:247], v2 offset:29696
    s_waitcnt lgkmcnt(3)
    v_mfma_f32_32x32x16_bf16 v[196:211], a[232:235], v[116:119], v[196:211]
    ds_read_b128 a[248:251], v2 offset:30720
    s_waitcnt lgkmcnt(3)
    v_mfma_f32_32x32x16_bf16 v[180:195], a[236:239], v[120:123], v[180:195]
    ds_read_b128 a[252:255], v2 offset:31744
    s_waitcnt lgkmcnt(3)
    v_mfma_f32_32x32x16_bf16 v[196:211], a[240:243], v[120:123], v[196:211]
    ds_read_b128 a[224:227], v2 offset:32768
    s_waitcnt lgkmcnt(3)
    v_mfma_f32_32x32x16_bf16 v[180:195], a[244:247], v[124:127], v[180:195]
    ds_read_b128 a[228:231], v2 offset:33792
    s_waitcnt lgkmcnt(3)
    v_mfma_f32_32x32x16_bf16 v[196:211], a[248:251], v[124:127], v[196:211]
    ds_read_b128 a[232:235], v2 offset:34816
    s_waitcnt lgkmcnt(3)
    v_mfma_f32_32x32x16_bf16 v[180:195], a[252:255], v[128:131], v[180:195]
    ds_read_b128 a[236:239], v2 offset:35840
    s_waitcnt lgkmcnt(3)
    v_mfma_f32_32x32x16_bf16 v[196:211], a[224:227], v[128:131], v[196:211]
    ds_read_b128 a[240:243], v2 offset:36864
    s_waitcnt lgkmcnt(3)
    v_mfma_f32_32x32x16_bf16 v[212:227], a[228:231], v[16:19], 0
    ds_read_b128 a[244:247], v2 offset:37888
    s_waitcnt lgkmcnt(3)
    v_mfma_f32_32x32x16_bf16 v[228:243], a[232:235], v[16:19], 0
    ds_read_b128 a[248:251], v2 offset:38912
    s_nop 1
    v_max_f32 v180, 0, v180
    v_max_f32 v181, 0, v181
    v_max_f32 v182, 0, v182
    s_waitcnt lgkmcnt(3)
    v_mfma_f32_32x32x16_bf16 v[212:227], a[236:239], v[20:23], v[212:227]
    ds_read_b128 a[252:255], v2 offset:39936
    v_max_f32 v183, 0, v183
    v_max_f32 v184, 0, v184
    v_max_f32 v185, 0, v185
    s_waitcnt lgkmcnt(3)
    v_mfma_f32_32x32x16_bf16 v[228:243], a[240:243], v[20:23], v[228:243]
    ds_read_b128 a[224:227], v2 offset:40960
    v_max_f32 v186, 0, v186
    v_max_f32 v187, 0, v187
    v_mul_f32 v180, v180, v188
    s_waitcnt lgkmcnt(3)
    v_mfma_f32_32x32x16_bf16 v[212:227], a[244:247], v[24:27], v[212:227]
    ds_read_b128 a[228:231], v2 offset:41984
    v_mul_f32 v181, v181, v189
    v_mul_f32 v182, v182, v190
    v_mul_f32 v183, v183, v191
    s_waitcnt lgkmcnt(3)
    v_mfma_f32_32x32x16_bf16 v[228:243], a[248:251], v[24:27], v[228:243]
    ds_read_b128 a[232:235], v2 offset:43008
    v_mul_f32 v184, v184, v192
    v_mul_f32 v185, v185, v193
    v_mul_f32 v186, v186, v194
    s_waitcnt lgkmcnt(3)
    v_mfma_f32_32x32x16_bf16 v[212:227], a[252:255], v[28:31], v[212:227]
    ds_read_b128 a[236:239], v2 offset:44032
    v_mul_f32 v187, v187, v195
    v_cvt_pk_bf16_f32 v188, v180, v181
    v_cvt_pk_bf16_f32 v189, v182, v183
    s_waitcnt lgkmcnt(3)
    v_mfma_f32_32x32x16_bf16 v[228:243], a[224:227], v[28:31], v[228:243]
    ds_read_b128 a[240:243], v2 offset:45056
    v_cvt_pk_bf16_f32 v190, v184, v185
    v_cvt_pk_bf16_f32 v191, v186, v187
    buffer_store_dwordx4 v[188:191], v1, s[44:47], s13 offen offset:3072
    s_waitcnt lgkmcnt(3)
    v_mfma_f32_32x32x16_bf16 v[212:227], a[228:231], v[32:35], v[212:227]
    ds_read_b128 a[244:247], v2 offset:46080
    v_max_f32 v196, 0, v196
    v_max_f32 v197, 0, v197
    v_max_f32 v198, 0, v198
    s_waitcnt lgkmcnt(3)
    v_mfma_f32_32x32x16_bf16 v[228:243], a[232:235], v[32:35], v[228:243]
    ds_read_b128 a[248:251], v2 offset:47104
    v_max_f32 v199, 0, v199
    v_max_f32 v200, 0, v200
    v_max_f32 v201, 0, v201
    s_waitcnt lgkmcnt(3)
    v_mfma_f32_32x32x16_bf16 v[212:227], a[236:239], v[36:39], v[212:227]
    ds_read_b128 a[252:255], v2 offset:48128
    v_max_f32 v202, 0, v202
    v_max_f32 v203, 0, v203
    v_mul_f32 v196, v196, v204
    s_waitcnt lgkmcnt(3)
    v_mfma_f32_32x32x16_bf16 v[228:243], a[240:243], v[36:39], v[228:243]
    s_barrier
    ds_read_b128 a[224:227], v2 offset:49152
    v_mul_f32 v197, v197, v205
    v_mul_f32 v198, v198, v206
    v_mul_f32 v199, v199, v207
    s_waitcnt lgkmcnt(3)
    v_mfma_f32_32x32x16_bf16 v[212:227], a[244:247], v[40:43], v[212:227]
    ds_read_b128 a[228:231], v2 offset:50176
    v_mul_f32 v200, v200, v208
    v_mul_f32 v201, v201, v209
    v_mul_f32 v202, v202, v210
    s_waitcnt lgkmcnt(3)
    v_mfma_f32_32x32x16_bf16 v[228:243], a[248:251], v[40:43], v[228:243]
    ds_read_b128 a[232:235], v2 offset:51200
    v_mul_f32 v203, v203, v211
    v_cvt_pk_bf16_f32 v204, v196, v197
    v_cvt_pk_bf16_f32 v205, v198, v199
    s_waitcnt lgkmcnt(3)
    v_mfma_f32_32x32x16_bf16 v[212:227], a[252:255], v[44:47], v[212:227]
    ds_read_b128 a[236:239], v2 offset:52224
    v_cvt_pk_bf16_f32 v206, v200, v201
    v_cvt_pk_bf16_f32 v207, v202, v203
    buffer_store_dwordx4 v[204:207], v1, s[44:47], s14 offen offset:0
    s_waitcnt lgkmcnt(3)
    v_mfma_f32_32x32x16_bf16 v[228:243], a[224:227], v[44:47], v[228:243]
    ds_read_b128 a[240:243], v2 offset:53248
    s_waitcnt lgkmcnt(3)
    v_mfma_f32_32x32x16_bf16 v[212:227], a[228:231], v[48:51], v[212:227]
    ds_read_b128 a[244:247], v2 offset:54272
    s_waitcnt lgkmcnt(3)
    v_mfma_f32_32x32x16_bf16 v[228:243], a[232:235], v[48:51], v[228:243]
    ds_read_b128 a[248:251], v2 offset:55296
    s_waitcnt lgkmcnt(3)
    v_mfma_f32_32x32x16_bf16 v[212:227], a[236:239], v[52:55], v[212:227]
    ds_read_b128 a[252:255], v2 offset:56320
    s_waitcnt lgkmcnt(3)
    v_mfma_f32_32x32x16_bf16 v[228:243], a[240:243], v[52:55], v[228:243]
    ds_read_b128 a[224:227], v2 offset:57344
    s_waitcnt lgkmcnt(3)
    v_mfma_f32_32x32x16_bf16 v[212:227], a[244:247], v[56:59], v[212:227]
    ds_read_b128 a[228:231], v2 offset:58368
    s_waitcnt lgkmcnt(3)
    v_mfma_f32_32x32x16_bf16 v[228:243], a[248:251], v[56:59], v[228:243]
    ds_read_b128 a[232:235], v2 offset:59392
    s_waitcnt lgkmcnt(3)
    v_mfma_f32_32x32x16_bf16 v[212:227], a[252:255], v[60:63], v[212:227]
    ds_read_b128 a[236:239], v2 offset:60416
    s_waitcnt lgkmcnt(3)
    v_mfma_f32_32x32x16_bf16 v[228:243], a[224:227], v[60:63], v[228:243]
    ds_read_b128 a[240:243], v2 offset:61440
    s_waitcnt lgkmcnt(3)
    v_mfma_f32_32x32x16_bf16 v[212:227], a[228:231], v[64:67], v[212:227]
    ds_read_b128 a[244:247], v2 offset:62464
    s_lshl_b32 s15, s48, 6
    s_lshl_b32 s61, s49, 2
    s_add_u32 s15, s15, s61
    s_add_u32 s15, s15, 53248
    s_waitcnt vmcnt(0)
    s_mov_b64 exec, 1
    buffer_store_dword v15, v1, s[44:47], s15 offen
    s_mov_b64 exec, -1
    s_waitcnt lgkmcnt(3)
    v_mfma_f32_32x32x16_bf16 v[228:243], a[232:235], v[64:67], v[228:243]
    ds_read_b128 a[248:251], v2 offset:63488
    s_waitcnt lgkmcnt(3)
    v_mfma_f32_32x32x16_bf16 v[212:227], a[236:239], v[68:71], v[212:227]
    ds_read_b128 a[252:255], v2 offset:64512
    s_waitcnt lgkmcnt(3)
    v_mfma_f32_32x32x16_bf16 v[228:243], a[240:243], v[68:71], v[228:243]
    ds_read_b128 a[224:227], v3 offset:0
    s_waitcnt lgkmcnt(3)
    v_mfma_f32_32x32x16_bf16 v[212:227], a[244:247], v[72:75], v[212:227]
    ds_read_b128 a[228:231], v3 offset:1024
    s_waitcnt lgkmcnt(3)
    v_mfma_f32_32x32x16_bf16 v[228:243], a[248:251], v[72:75], v[228:243]
    ds_read_b128 a[232:235], v3 offset:2048
    s_waitcnt lgkmcnt(3)
    v_mfma_f32_32x32x16_bf16 v[212:227], a[252:255], v[76:79], v[212:227]
    ds_read_b128 a[236:239], v3 offset:3072
    s_waitcnt lgkmcnt(3)
    v_mfma_f32_32x32x16_bf16 v[228:243], a[224:227], v[76:79], v[228:243]
    ds_read_b128 a[240:243], v3 offset:4096
    s_waitcnt lgkmcnt(3)
    v_mfma_f32_32x32x16_bf16 v[212:227], a[228:231], v[80:83], v[212:227]
    ds_read_b128 a[244:247], v3 offset:5120
    s_waitcnt lgkmcnt(3)
    v_mfma_f32_32x32x16_bf16 v[228:243], a[232:235], v[80:83], v[228:243]
    ds_read_b128 a[248:251], v3 offset:6144
    s_waitcnt lgkmcnt(3)
    v_mfma_f32_32x32x16_bf16 v[212:227], a[236:239], v[84:87], v[212:227]
    ds_read_b128 a[252:255], v3 offset:7168
    s_waitcnt lgkmcnt(3)
    v_mfma_f32_32x32x16_bf16 v[228:243], a[240:243], v[84:87], v[228:243]
    ds_read_b128 a[224:227], v3 offset:8192
    s_waitcnt lgkmcnt(3)
    v_mfma_f32_32x32x16_bf16 v[212:227], a[244:247], v[88:91], v[212:227]
    ds_read_b128 a[228:231], v3 offset:9216
    s_waitcnt lgkmcnt(3)
    v_mfma_f32_32x32x16_bf16 v[228:243], a[248:251], v[88:91], v[228:243]
    ds_read_b128 a[232:235], v3 offset:10240
    s_waitcnt lgkmcnt(3)
    v_mfma_f32_32x32x16_bf16 v[212:227], a[252:255], v[92:95], v[212:227]
    ds_read_b128 a[236:239], v3 offset:11264
    s_waitcnt lgkmcnt(3)
    v_mfma_f32_32x32x16_bf16 v[228:243], a[224:227], v[92:95], v[228:243]
    ds_read_b128 a[240:243], v3 offset:12288
    s_waitcnt lgkmcnt(3)
    v_mfma_f32_32x32x16_bf16 v[212:227], a[228:231], v[96:99], v[212:227]
    ds_read_b128 a[244:247], v3 offset:13312
    s_waitcnt lgkmcnt(3)
    v_mfma_f32_32x32x16_bf16 v[228:243], a[232:235], v[96:99], v[228:243]
    ds_read_b128 a[248:251], v3 offset:14336
    s_waitcnt lgkmcnt(3)
    v_mfma_f32_32x32x16_bf16 v[212:227], a[236:239], v[100:103], v[212:227]
    ds_read_b128 a[252:255], v3 offset:15360
    s_waitcnt lgkmcnt(3)
    v_mfma_f32_32x32x16_bf16 v[228:243], a[240:243], v[100:103], v[228:243]
    ds_read_b128 a[224:227], v3 offset:16384
    s_waitcnt lgkmcnt(3)
    v_mfma_f32_32x32x16_bf16 v[212:227], a[244:247], v[104:107], v[212:227]
    ds_read_b128 a[228:231], v3 offset:17408
    s_waitcnt lgkmcnt(3)
    v_mfma_f32_32x32x16_bf16 v[228:243], a[248:251], v[104:107], v[228:243]
    ds_read_b128 a[232:235], v3 offset:18432
    s_waitcnt lgkmcnt(3)
    v_mfma_f32_32x32x16_bf16 v[212:227], a[252:255], v[108:111], v[212:227]
    ds_read_b128 a[236:239], v3 offset:19456
    s_waitcnt lgkmcnt(3)
    v_mfma_f32_32x32x16_bf16 v[228:243], a[224:227], v[108:111], v[228:243]
    ds_read_b128 a[240:243], v3 offset:20480
    s_waitcnt lgkmcnt(3)
    v_mfma_f32_32x32x16_bf16 v[212:227], a[228:231], v[112:115], v[212:227]
    ds_read_b128 a[244:247], v3 offset:21504
    s_waitcnt lgkmcnt(3)
    v_mfma_f32_32x32x16_bf16 v[228:243], a[232:235], v[112:115], v[228:243]
    ds_read_b128 a[248:251], v3 offset:22528
    s_mov_b32 s38, 53248
    buffer_load_dword v13, v14, s[44:47], s38 offen sc1
    s_waitcnt lgkmcnt(3)
    v_mfma_f32_32x32x16_bf16 v[212:227], a[236:239], v[116:119], v[212:227]
    ds_read_b128 a[252:255], v3 offset:23552
    s_waitcnt lgkmcnt(3)
    v_mfma_f32_32x32x16_bf16 v[228:243], a[240:243], v[116:119], v[228:243]
    ds_read_b128 a[224:227], v3 offset:24576
    s_waitcnt lgkmcnt(3)
    v_mfma_f32_32x32x16_bf16 v[212:227], a[244:247], v[120:123], v[212:227]
    ds_read_b128 a[228:231], v3 offset:25600
    s_waitcnt lgkmcnt(3)
    v_mfma_f32_32x32x16_bf16 v[228:243], a[248:251], v[120:123], v[228:243]
    ds_read_b128 a[232:235], v3 offset:26624
    s_waitcnt lgkmcnt(3)
    v_mfma_f32_32x32x16_bf16 v[212:227], a[252:255], v[124:127], v[212:227]
    s_waitcnt lgkmcnt(2)
    v_mfma_f32_32x32x16_bf16 v[228:243], a[224:227], v[124:127], v[228:243]
    s_waitcnt lgkmcnt(1)
    v_mfma_f32_32x32x16_bf16 v[212:227], a[228:231], v[128:131], v[212:227]
    s_waitcnt lgkmcnt(0)
    v_mfma_f32_32x32x16_bf16 v[228:243], a[232:235], v[128:131], v[228:243]
    s_cmp_ge_u32 s51, 7
    s_cbranch_scc1 L_F1_nog2
    s_mul_i32 s7, s52, 112*1024
    s_mul_i32 s10, s3, 28*1024
    s_add_u32 s7, s7, s10
    s_add_u32 s7, s7, 11665408
    s_xor_b32 s9, s52, 1
    s_mul_i32 s9, s9, 112*1024
    s_add_u32 s9, s9, s10
    s_add_u32 s9, s9, 11665408
    s_mov_b32 s62, 0
L8_chk:
    s_waitcnt vmcnt(0)
    v_cmp_ne_u32 vcc, s42, v13
    s_add_u32 s62, s62, 1
    s_cmp_lt_u32 s62, 0x20000
    s_cselect_b64 s[64:65], vcc, 0
    s_cmp_eq_u64 s[64:65], 0
    s_cbranch_scc1 L8_ok
    s_sleep 1
    s_mov_b32 s38, 53248
    buffer_load_dword v13, v14, s[44:47], s38 offen sc1
    s_waitcnt vmcnt(0) lgkmcnt(0)
    s_branch L8_chk
L8_ok:
    s_add_u32 s63, s7, 0
    buffer_load_dwordx4 v[100:103], v1, s[44:47], s63 offen offset:0 sc1
    s_add_u32 s63, s9, 0
    buffer_load_dwordx4 v[104:107], v1, s[44:47], s63 offen offset:0 sc1
    s_add_u32 s63, s7, 0
    buffer_load_dwordx4 v[108:111], v1, s[44:47], s63 offen offset:1024 sc1
    s_add_u32 s63, s9, 0
    buffer_load_dwordx4 v[112:115], v1, s[44:47], s63 offen offset:1024 sc1
    s_add_u32 s63, s7, 0
    buffer_load_dwordx4 v[116:119], v1, s[44:47], s63 offen offset:2048 sc1
    s_add_u32 s63, s9, 0
    buffer_load_dwordx4 v[120:123], v1, s[44:47], s63 offen offset:2048 sc1
    v_max_f32 v212, 0, v212
    v_max_f32 v213, 0, v213
    v_max_f32 v214, 0, v214
    v_max_f32 v215, 0, v215
    v_max_f32 v216, 0, v216
    v_max_f32 v217, 0, v217
    v_max_f32 v218, 0, v218
    v_max_f32 v219, 0, v219
    v_mul_f32 v212, v212, v220
    v_mul_f32 v213, v213, v221
    v_mul_f32 v214, v214, v222
    v_mul_f32 v215, v215, v223
    v_mul_f32 v216, v216, v224
    v_mul_f32 v217, v217, v225
    v_mul_f32 v218, v218, v226
    v_mul_f32 v219, v219, v227
    v_cvt_pk_bf16_f32 v220, v212, v213
    v_cvt_pk_bf16_f32 v221, v214, v215
    v_cvt_pk_bf16_f32 v222, v216, v217
    v_cvt_pk_bf16_f32 v223, v218, v219
    buffer_store_dwordx4 v[220:223], v1, s[44:47], s14 offen offset:1024
    v_max_f32 v228, 0, v228
    v_max_f32 v229, 0, v229
    v_max_f32 v230, 0, v230
    v_max_f32 v231, 0, v231
    v_max_f32 v232, 0, v232
    v_max_f32 v233, 0, v233
    v_max_f32 v234, 0, v234
    v_max_f32 v235, 0, v235
    v_mul_f32 v228, v228, v236
    v_mul_f32 v229, v229, v237
    v_mul_f32 v230, v230, v238
    v_mul_f32 v231, v231, v239
    v_mul_f32 v232, v232, v240
    v_mul_f32 v233, v233, v241
    v_mul_f32 v234, v234, v242
    v_mul_f32 v235, v235, v243
    v_cvt_pk_bf16_f32 v236, v228, v229
    v_cvt_pk_bf16_f32 v237, v230, v231
    v_cvt_pk_bf16_f32 v238, v232, v233
    v_cvt_pk_bf16_f32 v239, v234, v235
    buffer_store_dwordx4 v[236:239], v1, s[44:47], s14 offen offset:2048
    s_add_u32 s63, s7, 4096
    buffer_load_dwordx4 v[124:127], v1, s[44:47], s63 offen offset:3072 sc1
    s_add_u32 s63, s9, 4096
    buffer_load_dwordx4 v[128:131], v1, s[44:47], s63 offen offset:3072 sc1
    s_waitcnt vmcnt(9)
    v_mfma_f32_32x32x16_bf16 v[16:31], a[0:3], v[100:103], 0
    s_add_u32 s63, s7, 8192
    buffer_load_dwordx4 v[132:135], v1, s[44:47], s63 offen offset:0 sc1
    v_mfma_f32_32x32x16_bf16 v[32:47], a[4:7], v[100:103], 0
    s_add_u32 s63, s9, 8192
    buffer_load_dwordx4 v[136:139], v1, s[44:47], s63 offen offset:0 sc1
    s_waitcnt vmcnt(10)
    v_mfma_f32_32x32x16_bf16 v[48:63], a[0:3], v[104:107], 0
    s_add_u32 s63, s7, 8192
    buffer_load_dwordx4 v[140:143], v1, s[44:47], s63 offen offset:1024 sc1
    v_mfma_f32_32x32x16_bf16 v[64:79], a[4:7], v[104:107], 0
    s_add_u32 s63, s9, 8192
    buffer_load_dwordx4 v[144:147], v1, s[44:47], s63 offen offset:1024 sc1
    s_waitcnt vmcnt(11)
    v_mfma_f32_32x32x16_bf16 v[16:31], a[8:11], v[108:111], v[16:31]
    s_add_u32 s63, s7, 12288
    buffer_load_dwordx4 v[148:151], v1, s[44:47], s63 offen offset:2048 sc1
    v_mfma_f32_32x32x16_bf16 v[32:47], a[12:15], v[108:111], v[32:47]
    s_add_u32 s63, s9, 12288
    buffer_load_dwordx4 v[152:155], v1, s[44:47], s63 offen offset:2048 sc1
    s_waitcnt vmcnt(12)
    v_mfma_f32_32x32x16_bf16 v[48:63], a[8:11], v[112:115], v[48:63]
    s_lshl_b32 s15, s48, 6
    s_lshl_b32 s61, s49, 2
    s_add_u32 s15, s15, s61
    s_add_u32 s15, s15, 57344
    s_waitcnt vmcnt(8)
    s_mov_b64 exec, 1
    buffer_store_dword v15, v1, s[44:47], s15 offen
    s_mov_b64 exec, -1
    s_add_u32 s63, s7, 12288
    buffer_load_dwordx4 v[156:159], v1, s[44:47], s63 offen offset:3072 sc1
    v_mfma_f32_32x32x16_bf16 v[64:79], a[12:15], v[112:115], v[64:79]
    s_add_u32 s63, s9, 12288
    buffer_load_dwordx4 v[160:163], v1, s[44:47], s63 offen offset:3072 sc1
    v_mfma_f32_32x32x16_bf16 v[16:31], a[16:19], v[116:119], v[16:31]
    s_add_u32 s63, s7, 16384
    buffer_load_dwordx4 v[164:167], v1, s[44:47], s63 offen offset:0 sc1
    v_mfma_f32_32x32x16_bf16 v[32:47], a[20:23], v[116:119], v[32:47]
    s_add_u32 s63, s9, 16384
    buffer_load_dwordx4 v[168:171], v1, s[44:47], s63 offen offset:0 sc1
    v_mfma_f32_32x32x16_bf16 v[48:63], a[16:19], v[120:123], v[48:63]
    v_mfma_f32_32x32x16_bf16 v[64:79], a[20:23], v[120:123], v[64:79]
    s_waitcnt vmcnt(12)
    v_mfma_f32_32x32x16_bf16 v[16:31], a[56:59], v[124:127], v[16:31]
    s_add_u32 s63, s7, 20480
    buffer_load_dwordx4 v[172:175], v1, s[44:47], s63 offen offset:1024 sc1
    v_mfma_f32_32x32x16_bf16 v[32:47], a[60:63], v[124:127], v[32:47]
    s_add_u32 s63, s9, 20480
    buffer_load_dwordx4 v[176:179], v1, s[44:47], s63 offen offset:1024 sc1
    s_waitcnt vmcnt(13)
    v_mfma_f32_32x32x16_bf16 v[48:63], a[56:59], v[128:131], v[48:63]
    v_mfma_f32_32x32x16_bf16 v[64:79], a[60:63], v[128:131], v[64:79]
    s_waitcnt vmcnt(12)
    v_mfma_f32_32x32x16_bf16 v[16:31], a[64:67], v[132:135], v[16:31]
    s_add_u32 s63, s7, 20480
    buffer_load_dwordx4 v[180:183], v1, s[44:47], s63 offen offset:2048 sc1
    v_mfma_f32_32x32x16_bf16 v[32:47], a[68:71], v[132:135], v[32:47]
    s_add_u32 s63, s9, 20480
    buffer_load_dwordx4 v[184:187], v1, s[44:47], s63 offen offset:2048 sc1
    s_waitcnt vmcnt(13)
    v_mfma_f32_32x32x16_bf16 v[48:63], a[64:67], v[136:139], v[48:63]
    v_mfma_f32_32x32x16_bf16 v[64:79], a[68:71], v[136:139], v[64:79]
    s_waitcnt vmcnt(12)
    v_mfma_f32_32x32x16_bf16 v[16:31], a[72:75], v[140:143], v[16:31]
    s_add_u32 s63, s7, 20480
    buffer_load_dwordx4 v[188:191], v1, s[44:47], s63 offen offset:3072 sc1
    v_mfma_f32_32x32x16_bf16 v[32:47], a[76:79], v[140:143], v[32:47]
    s_add_u32 s63, s9, 20480
    buffer_load_dwordx4 v[192:195], v1, s[44:47], s63 offen offset:3072 sc1
    s_waitcnt vmcnt(13)
    v_mfma_f32_32x32x16_bf16 v[48:63], a[72:75], v[144:147], v[48:63]
    v_mfma_f32_32x32x16_bf16 v[64:79], a[76:79], v[144:147], v[64:79]
    s_waitcnt vmcnt(12)
    v_mfma_f32_32x32x16_bf16 v[16:31], a[112:115], v[148:151], v[16:31]
    s_add_u32 s63, s7, 0
    buffer_load_dwordx4 v[196:199], v1, s[44:47], s63 offen offset:3072 sc1
    v_mfma_f32_32x32x16_bf16 v[32:47], a[116:119], v[148:151], v[32:47]
    s_add_u32 s63, s9, 0
    buffer_load_dwordx4 v[200:203], v1, s[44:47], s63 offen offset:3072 sc1
    s_waitcnt vmcnt(13)
    v_mfma_f32_32x32x16_bf16 v[48:63], a[112:115], v[152:155], v[48:63]
    v_mfma_f32_32x32x16_bf16 v[64:79], a[116:119], v[152:155], v[64:79]
    s_waitcnt vmcnt(11)
    v_mfma_f32_32x32x16_bf16 v[16:31], a[120:123], v[156:159], v[16:31]
    s_add_u32 s63, s7, 4096
    buffer_load_dwordx4 v[204:207], v1, s[44:47], s63 offen offset:0 sc1
    v_mfma_f32_32x32x16_bf16 v[32:47], a[124:127], v[156:159], v[32:47]
    s_add_u32 s63, s9, 4096
    buffer_load_dwordx4 v[208:211], v1, s[44:47], s63 offen offset:0 sc1
    s_waitcnt vmcnt(12)
    v_mfma_f32_32x32x16_bf16 v[48:63], a[120:123], v[160:163], v[48:63]
    v_mfma_f32_32x32x16_bf16 v[64:79], a[124:127], v[160:163], v[64:79]
    s_waitcnt vmcnt(11)
    v_mfma_f32_32x32x16_bf16 v[16:31], a[128:131], v[164:167], v[16:31]
    s_add_u32 s63, s7, 8192
    buffer_load_dwordx4 v[212:215], v1, s[44:47], s63 offen offset:2048 sc1
    v_mfma_f32_32x32x16_bf16 v[32:47], a[132:135], v[164:167], v[32:47]
    s_add_u32 s63, s9, 8192
    buffer_load_dwordx4 v[216:219], v1, s[44:47], s63 offen offset:2048 sc1
    s_waitcnt vmcnt(12)
    v_mfma_f32_32x32x16_bf16 v[48:63], a[128:131], v[168:171], v[48:63]
    v_mfma_f32_32x32x16_bf16 v[64:79], a[132:135], v[168:171], v[64:79]
    s_waitcnt vmcnt(11)
    v_mfma_f32_32x32x16_bf16 v[16:31], a[168:171], v[172:175], v[16:31]
    s_add_u32 s63, s7, 8192
    buffer_load_dwordx4 v[220:223], v1, s[44:47], s63 offen offset:3072 sc1
    v_mfma_f32_32x32x16_bf16 v[32:47], a[172:175], v[172:175], v[32:47]
    s_add_u32 s63, s9, 8192
    buffer_load_dwordx4 v[224:227], v1, s[44:47], s63 offen offset:3072 sc1
    s_waitcnt vmcnt(12)
    v_mfma_f32_32x32x16_bf16 v[48:63], a[168:171], v[176:179], v[48:63]
    v_mfma_f32_32x32x16_bf16 v[64:79], a[172:175], v[176:179], v[64:79]
    s_waitcnt vmcnt(11)
    v_mfma_f32_32x32x16_bf16 v[16:31], a[176:179], v[180:183], v[16:31]
    s_add_u32 s63, s7, 16384
    buffer_load_dwordx4 v[228:231], v1, s[44:47], s63 offen offset:1024 sc1
    v_mfma_f32_32x32x16_bf16 v[32:47], a[180:183], v[180:183], v[32:47]
    s_add_u32 s63, s9, 16384
    buffer_load_dwordx4 v[232:235], v1, s[44:47], s63 offen offset:1024 sc1
    s_waitcnt vmcnt(12)
    v_mfma_f32_32x32x16_bf16 v[48:63], a[176:179], v[184:187], v[48:63]
    s_mov_b32 s38, 57344
    buffer_load_dword v13, v14, s[44:47], s38 offen sc1
    v_mfma_f32_32x32x16_bf16 v[64:79], a[180:183], v[184:187], v[64:79]
    s_waitcnt vmcnt(12)
    v_mfma_f32_32x32x16_bf16 v[16:31], a[184:187], v[188:191], v[16:31]
    s_add_u32 s63, s7, 16384
    buffer_load_dwordx4 v[236:239], v1, s[44:47], s63 offen offset:2048 sc1
    v_mfma_f32_32x32x16_bf16 v[32:47], a[188:191], v[188:191], v[32:47]
    s_add_u32 s63, s9, 16384
    buffer_load_dwordx4 v[240:243], v1, s[44:47], s63 offen offset:2048 sc1
    s_waitcnt vmcnt(13)
    v_mfma_f32_32x32x16_bf16 v[48:63], a[184:187], v[192:195], v[48:63]
    v_mfma_f32_32x32x16_bf16 v[64:79], a[188:191], v[192:195], v[64:79]
    s_waitcnt vmcnt(12)
    v_mfma_f32_32x32x16_bf16 v[16:31], a[24:27], v[196:199], v[16:31]
    s_add_u32 s63, s7, 24576
    buffer_load_dwordx4 v[244:247], v1, s[44:47], s63 offen offset:0 sc1
    v_mfma_f32_32x32x16_bf16 v[32:47], a[28:31], v[196:199], v[32:47]
    s_add_u32 s63, s9, 24576
    buffer_load_dwordx4 v[248:251], v1, s[44:47], s63 offen offset:0 sc1
    s_waitcnt vmcnt(13)
    v_mfma_f32_32x32x16_bf16 v[48:63], a[24:27], v[200:203], v[48:63]
    v_mfma_f32_32x32x16_bf16 v[64:79], a[28:31], v[200:203], v[64:79]
    s_waitcnt vmcnt(12)
    v_mfma_f32_32x32x16_bf16 v[16:31], a[32:35], v[204:207], v[16:31]
    s_add_u32 s63, s7, 24576
    buffer_load_dwordx4 v[100:103], v1, s[44:47], s63 offen offset:1024 sc1
    v_mfma_f32_32x32x16_bf16 v[32:47], a[36:39], v[204:207], v[32:47]
    s_add_u32 s63, s9, 24576
    buffer_load_dwordx4 v[104:107], v1, s[44:47], s63 offen offset:1024 sc1
    s_waitcnt vmcnt(13)
    v_mfma_f32_32x32x16_bf16 v[48:63], a[32:35], v[208:211], v[48:63]
    s_mov_b32 s62, 0
L9_chk:
    s_waitcnt vmcnt(6)
    v_cmp_ne_u32 vcc, s42, v13
    s_add_u32 s62, s62, 1
    s_cmp_lt_u32 s62, 0x20000
    s_cselect_b64 s[64:65], vcc, 0
    s_cmp_eq_u64 s[64:65], 0
    s_cbranch_scc1 L9_ok
    s_sleep 1
    s_mov_b32 s38, 57344
    buffer_load_dword v13, v14, s[44:47], s38 offen sc1
    s_waitcnt vmcnt(0) lgkmcnt(0)
    s_branch L9_chk
L9_ok:
    v_mfma_f32_32x32x16_bf16 v[64:79], a[36:39], v[208:211], v[64:79]
    s_barrier
    v_mfma_f32_32x32x16_bf16 v[16:31], a[80:83], v[212:215], v[16:31]
    s_add_u32 s63, s7, 4096
    buffer_load_dwordx4 v[108:111], v1, s[44:47], s63 offen offset:1024 sc1
    v_mfma_f32_32x32x16_bf16 v[32:47], a[84:87], v[212:215], v[32:47]
    s_add_u32 s63, s9, 4096
    buffer_load_dwordx4 v[112:115], v1, s[44:47], s63 offen offset:1024 sc1
    v_mfma_f32_32x32x16_bf16 v[48:63], a[80:83], v[216:219], v[48:63]
    v_mfma_f32_32x32x16_bf16 v[64:79], a[84:87], v[216:219], v[64:79]
    v_mfma_f32_32x32x16_bf16 v[16:31], a[88:91], v[220:223], v[16:31]
    s_add_u32 s63, s7, 4096
    buffer_load_dwordx4 v[116:119], v1, s[44:47], s63 offen offset:2048 sc1
    v_mfma_f32_32x32x16_bf16 v[32:47], a[92:95], v[220:223], v[32:47]
    s_add_u32 s63, s9, 4096
    buffer_load_dwordx4 v[120:123], v1, s[44:47], s63 offen offset:2048 sc1
    v_mfma_f32_32x32x16_bf16 v[48:63], a[88:91], v[224:227], v[48:63]
    v_mfma_f32_32x32x16_bf16 v[64:79], a[92:95], v[224:227], v[64:79]
    v_mfma_f32_32x32x16_bf16 v[16:31], a[136:139], v[228:231], v[16:31]
    s_add_u32 s63, s7, 12288
    buffer_load_dwordx4 v[124:127], v1, s[44:47], s63 offen offset:0 sc1
    v_mfma_f32_32x32x16_bf16 v[32:47], a[140:143], v[228:231], v[32:47]
    s_add_u32 s63, s9, 12288
    buffer_load_dwordx4 v[128:131], v1, s[44:47], s63 offen offset:0 sc1
    v_mfma_f32_32x32x16_bf16 v[48:63], a[136:139], v[232:235], v[48:63]
    v_mfma_f32_32x32x16_bf16 v[64:79], a[140:143], v[232:235], v[64:79]
    s_waitcnt vmcnt(11)
    v_mfma_f32_32x32x16_bf16 v[16:31], a[144:147], v[236:239], v[16:31]
    s_add_u32 s63, s7, 12288
    buffer_load_dwordx4 v[132:135], v1, s[44:47], s63 offen offset:1024 sc1
    v_mfma_f32_32x32x16_bf16 v[32:47], a[148:151], v[236:239], v[32:47]
    s_add_u32 s63, s9, 12288
    buffer_load_dwordx4 v[136:139], v1, s[44:47], s63 offen offset:1024 sc1
    s_waitcnt vmcnt(12)
    v_mfma_f32_32x32x16_bf16 v[48:63], a[144:147], v[240:243], v[48:63]
    v_mfma_f32_32x32x16_bf16 v[64:79], a[148:151], v[240:243], v[64:79]
    s_waitcnt vmcnt(11)
    v_mfma_f32_32x32x16_bf16 v[16:31], a[192:195], v[244:247], v[16:31]
    s_add_u32 s63, s7, 16384
    buffer_load_dwordx4 v[140:143], v1, s[44:47], s63 offen offset:3072 sc1
    v_mfma_f32_32x32x16_bf16 v[32:47], a[196:199], v[244:247], v[32:47]
    s_add_u32 s63, s9, 16384
    buffer_load_dwordx4 v[144:147], v1, s[44:47], s63 offen offset:3072 sc1
    s_waitcnt vmcnt(12)
    v_mfma_f32_32x32x16_bf16 v[48:63], a[192:195], v[248:251], v[48:63]
    v_mfma_f32_32x32x16_bf16 v[64:79], a[196:199], v[248:251], v[64:79]
    s_waitcnt vmcnt(11)
    v_mfma_f32_32x32x16_bf16 v[16:31], a[200:203], v[100:103], v[16:31]
    s_add_u32 s63, s7, 20480
    buffer_load_dwordx4 v[148:151], v1, s[44:47], s63 offen offset:0 sc1
    v_mfma_f32_32x32x16_bf16 v[32:47], a[204:207], v[100:103], v[32:47]
    s_add_u32 s63, s9, 20480
    buffer_load_dwordx4 v[152:155], v1, s[44:47], s63 offen offset:0 sc1
    s_waitcnt vmcnt(12)
    v_mfma_f32_32x32x16_bf16 v[48:63], a[200:203], v[104:107], v[48:63]
    v_mfma_f32_32x32x16_bf16 v[64:79], a[204:207], v[104:107], v[64:79]
    s_waitcnt vmcnt(11)
    v_mfma_f32_32x32x16_bf16 v[16:31], a[40:43], v[108:111], v[16:31]
    s_add_u32 s63, s7, 24576
    buffer_load_dwordx4 v[156:159], v1, s[44:47], s63 offen offset:2048 sc1
    v_mfma_f32_32x32x16_bf16 v[32:47], a[44:47], v[108:111], v[32:47]
    s_add_u32 s63, s9, 24576
    buffer_load_dwordx4 v[160:163], v1, s[44:47], s63 offen offset:2048 sc1
    s_waitcnt vmcnt(12)
    v_mfma_f32_32x32x16_bf16 v[48:63], a[40:43], v[112:115], v[48:63]
    v_mfma_f32_32x32x16_bf16 v[64:79], a[44:47], v[112:115], v[64:79]
    s_waitcnt vmcnt(11)
    v_mfma_f32_32x32x16_bf16 v[16:31], a[48:51], v[116:119], v[16:31]
    s_add_u32 s63, s7, 24576
    buffer_load_dwordx4 v[164:167], v1, s[44:47], s63 offen offset:3072 sc1
    v_mfma_f32_32x32x16_bf16 v[32:47], a[52:55], v[116:119], v[32:47]
    s_add_u32 s63, s9, 24576
    buffer_load_dwordx4 v[168:171], v1, s[44:47], s63 offen offset:3072 sc1
    s_waitcnt vmcnt(12)
    v_mfma_f32_32x32x16_bf16 v[48:63], a[48:51], v[120:123], v[48:63]
    v_mfma_f32_32x32x16_bf16 v[64:79], a[52:55], v[120:123], v[64:79]
    s_waitcnt vmcnt(11)
    v_mfma_f32_32x32x16_bf16 v[16:31], a[96:99], v[124:127], v[16:31]
    s_add_u32 s10, s54, 4849664
    buffer_load_dwordx4 v[80:83], v12, s[44:47], s10 offen sc1
    buffer_load_dwordx4 v[84:87], v12, s[44:47], s10 offen offset:256 sc1
    v_lshrrev_b32 v6, 1, v8
    s_lshl_b32 s15, s52, 7
    s_add_u32 s15, s15, 65536
    buffer_load_dword v96, v6, s[44:47], s15 offen sc1
    v_mfma_f32_32x32x16_bf16 v[32:47], a[100:103], v[124:127], v[32:47]
    s_waitcnt vmcnt(13)
    v_mfma_f32_32x32x16_bf16 v[48:63], a[96:99], v[128:131], v[48:63]
    v_mfma_f32_32x32x16_bf16 v[64:79], a[100:103], v[128:131], v[64:79]
    s_waitcnt vmcnt(12)
    v_mfma_f32_32x32x16_bf16 v[16:31], a[104:107], v[132:135], v[16:31]
    v_mfma_f32_32x32x16_bf16 v[32:47], a[108:111], v[132:135], v[32:47]
    s_waitcnt vmcnt(11)
    v_mfma_f32_32x32x16_bf16 v[48:63], a[104:107], v[136:139], v[48:63]
    v_mfma_f32_32x32x16_bf16 v[64:79], a[108:111], v[136:139], v[64:79]
    s_waitcnt vmcnt(10)
    v_mfma_f32_32x32x16_bf16 v[16:31], a[152:155], v[140:143], v[16:31]
    v_mfma_f32_32x32x16_bf16 v[32:47], a[156:159], v[140:143], v[32:47]
    s_waitcnt vmcnt(9)
    v_mfma_f32_32x32x16_bf16 v[48:63], a[152:155], v[144:147], v[48:63]
    v_mfma_f32_32x32x16_bf16 v[64:79], a[156:159], v[144:147], v[64:79]
    s_waitcnt vmcnt(8)
    v_mfma_f32_32x32x16_bf16 v[32:47], a[164:167], v[148:151], v[32:47]
    s_waitcnt vmcnt(7)
    v_mfma_f32_32x32x16_bf16 v[48:63], a[160:163], v[152:155], v[48:63]
    v_mfma_f32_32x32x16_bf16 v[64:79], a[164:167], v[152:155], v[64:79]
    s_waitcnt vmcnt(6)
    v_mfma_f32_32x32x16_bf16 v[32:47], a[212:215], v[156:159], v[32:47]
    s_waitcnt vmcnt(5)
    v_mfma_f32_32x32x16_bf16 v[48:63], a[208:211], v[160:163], v[48:63]
    v_mfma_f32_32x32x16_bf16 v[64:79], a[212:215], v[160:163], v[64:79]
    s_waitcnt vmcnt(4)
    v_mfma_f32_32x32x16_bf16 v[32:47], a[220:223], v[164:167], v[32:47]
    s_waitcnt vmcnt(3)
    v_mfma_f32_32x32x16_bf16 v[48:63], a[216:219], v[168:171], v[48:63]
    v_mfma_f32_32x32x16_bf16 v[64:79], a[220:223], v[168:171], v[64:79]
    s_xor_b32 s10, s3, 1
    s_mul_i32 s10, s10, 12288
    s_add_u32 s10, s10, 114688
    v_add_u32 v4, s10, v1
    s_xor_b32 s10, s3, 2
    s_mul_i32 s10, s10, 12288
    s_add_u32 s10, s10, 118784
    v_add_u32 v5, s10, v1
    s_xor_b32 s10, s3, 3
    s_mul_i32 s10, s10, 12288
    s_add_u32 s10, s10, 122880
    v_add_u32 v6, s10, v1
    v_mfma_f32_32x32x16_bf16 v[16:31], a[160:163], v[148:151], v[16:31]
    ds_write_b128 v4, v[32:35] offset:0
    ds_write_b128 v4, v[36:39] offset:1024
    ds_write_b128 v4, v[40:43] offset:2048
    ds_write_b128 v4, v[44:47] offset:3072
    v_mfma_f32_32x32x16_bf16 v[16:31], a[208:211], v[156:159], v[16:31]
    ds_write_b128 v5, v[48:51] offset:0
    ds_write_b128 v5, v[52:55] offset:1024
    ds_write_b128 v5, v[56:59] offset:2048
    ds_write_b128 v5, v[60:63] offset:3072
    v_mfma_f32_32x32x16_bf16 v[16:31], a[216:219], v[164:167], v[16:31]
    ds_write_b128 v6, v[64:67] offset:0
    ds_write_b128 v6, v[68:71] offset:1024
    ds_write_b128 v6, v[72:75] offset:2048
    ds_write_b128 v6, v[76:79] offset:3072
    s_mul_i32 s10, s3, 12288
    s_add_u32 s10, s10, 114688
    v_add_u32 v7, s10, v1
    s_waitcnt lgkmcnt(0)
    s_barrier
    ds_read_b128 v[100:103], v7 offset:0
    ds_read_b128 v[104:107], v7 offset:1024
    ds_read_b128 v[108:111], v7 offset:2048
    ds_read_b128 v[112:115], v7 offset:3072
    ds_read_b128 v[116:119], v7 offset:4096
    ds_read_b128 v[120:123], v7 offset:5120
    ds_read_b128 v[124:127], v7 offset:6144
    ds_read_b128 v[128:131], v7 offset:7168
    ds_read_b128 v[132:135], v7 offset:8192
    ds_read_b128 v[136:139], v7 offset:9216
    ds_read_b128 v[140:143], v7 offset:10240
    ds_read_b128 v[144:147], v7 offset:11264
    s_waitcnt vmcnt(2)
    v_lshlrev_b32 v32, 16, v80
    v_and_b32 v33, s57, v80
    v_lshlrev_b32 v34, 16, v81
    v_and_b32 v35, s57, v81
    v_lshlrev_b32 v36, 16, v82
    v_and_b32 v37, s57, v82
    v_lshlrev_b32 v38, 16, v83
    v_and_b32 v39, s57, v83
    s_waitcnt vmcnt(1)
    v_lshlrev_b32 v40, 16, v84
    v_and_b32 v41, s57, v84
    v_lshlrev_b32 v42, 16, v85
    v_and_b32 v43, s57, v85
    v_lshlrev_b32 v44, 16, v86
    v_and_b32 v45, s57, v86
    v_lshlrev_b32 v46, 16, v87
    v_and_b32 v47, s57, v87
    s_waitcnt lgkmcnt(11)
    v_pk_add_f32 v[16:17], v[16:17], v[100:101]
    v_pk_add_f32 v[18:19], v[18:19], v[102:103]
    s_waitcnt lgkmcnt(10)
    v_pk_add_f32 v[20:21], v[20:21], v[104:105]
    v_pk_add_f32 v[22:23], v[22:23], v[106:107]
    s_waitcnt lgkmcnt(9)
    v_pk_add_f32 v[24:25], v[24:25], v[108:109]
    v_pk_add_f32 v[26:27], v[26:27], v[110:111]
    s_waitcnt lgkmcnt(8)
    v_pk_add_f32 v[28:29], v[28:29], v[112:113]
    v_pk_add_f32 v[30:31], v[30:31], v[114:115]
    s_waitcnt lgkmcnt(7)
    v_pk_add_f32 v[16:17], v[16:17], v[116:117]
    v_pk_add_f32 v[18:19], v[18:19], v[118:119]
    s_waitcnt lgkmcnt(6)
    v_pk_add_f32 v[20:21], v[20:21], v[120:121]
    v_pk_add_f32 v[22:23], v[22:23], v[122:123]
    s_waitcnt lgkmcnt(5)
    v_pk_add_f32 v[24:25], v[24:25], v[124:125]
    v_pk_add_f32 v[26:27], v[26:27], v[126:127]
    s_waitcnt lgkmcnt(4)
    v_pk_add_f32 v[28:29], v[28:29], v[128:129]
    v_pk_add_f32 v[30:31], v[30:31], v[130:131]
    s_waitcnt lgkmcnt(3)
    v_pk_add_f32 v[16:17], v[16:17], v[132:133]
    v_pk_add_f32 v[18:19], v[18:19], v[134:135]
    s_waitcnt lgkmcnt(2)
    v_pk_add_f32 v[20:21], v[20:21], v[136:137]
    v_pk_add_f32 v[22:23], v[22:23], v[138:139]
    s_waitcnt lgkmcnt(1)
    v_pk_add_f32 v[24:25], v[24:25], v[140:141]
    v_pk_add_f32 v[26:27], v[26:27], v[142:143]
    s_waitcnt lgkmcnt(0)
    v_pk_add_f32 v[28:29], v[28:29], v[144:145]
    v_pk_add_f32 v[30:31], v[30:31], v[146:147]
    s_waitcnt vmcnt(0)
    v_fmac_f32 v32, v96, v16
    v_fmac_f32 v33, v96, v17
    v_fmac_f32 v34, v96, v18
    v_fmac_f32 v35, v96, v19
    v_fmac_f32 v36, v96, v20
    v_fmac_f32 v37, v96, v21
    v_fmac_f32 v38, v96, v22
    v_fmac_f32 v39, v96, v23
    v_fmac_f32 v40, v96, v24
    v_fmac_f32 v41, v96, v25
    v_fmac_f32 v42, v96, v26
    v_fmac_f32 v43, v96, v27
    v_fmac_f32 v44, v96, v28
    v_fmac_f32 v45, v96, v29
    v_fmac_f32 v46, v96, v30
    v_fmac_f32 v47, v96, v31
    v_cvt_pk_bf16_f32 v80, v32, v33
    v_cvt_pk_bf16_f32 v81, v34, v35
    v_cvt_pk_bf16_f32 v82, v36, v37
    v_cvt_pk_bf16_f32 v83, v38, v39
    v_cvt_pk_bf16_f32 v84, v40, v41
    v_cvt_pk_bf16_f32 v85, v42, v43
    v_cvt_pk_bf16_f32 v86, v44, v45
    v_cvt_pk_bf16_f32 v87, v46, v47
    s_lshl_b32 s10, s52, 5
    v_and_b32 v6, 31, v0
    v_add_u32 v6, s10, v6
    v_mul_u32_u24 v6, 896, v6
    v_lshrrev_b32 v7, 5, v0
    v_lshl_add_u32 v6, v7, 4, v6
    s_lshl_b32 s10, s53, 6
    buffer_store_dwordx4 v[80:83], v6, s[68:71], s10 offen
    buffer_store_dwordx4 v[84:87], v6, s[68:71], s10 offen offset:32
    s_endpgm
L_F1_nog2:
    s_nop 7
    v_max_f32 v212, 0, v212
    v_max_f32 v213, 0, v213
    v_max_f32 v214, 0, v214
    v_max_f32 v215, 0, v215
    v_max_f32 v216, 0, v216
    v_max_f32 v217, 0, v217
    v_max_f32 v218, 0, v218
    v_max_f32 v219, 0, v219
    v_mul_f32 v212, v212, v220
    v_mul_f32 v213, v213, v221
    v_mul_f32 v214, v214, v222
    v_mul_f32 v215, v215, v223
    v_mul_f32 v216, v216, v224
    v_mul_f32 v217, v217, v225
    v_mul_f32 v218, v218, v226
    v_mul_f32 v219, v219, v227
    v_cvt_pk_bf16_f32 v220, v212, v213
    v_cvt_pk_bf16_f32 v221, v214, v215
    v_cvt_pk_bf16_f32 v222, v216, v217
    v_cvt_pk_bf16_f32 v223, v218, v219
    buffer_store_dwordx4 v[220:223], v1, s[44:47], s14 offen offset:1024
    v_max_f32 v228, 0, v228
    v_max_f32 v229, 0, v229
    v_max_f32 v230, 0, v230
    v_max_f32 v231, 0, v231
    v_max_f32 v232, 0, v232
    v_max_f32 v233, 0, v233
    v_max_f32 v234, 0, v234
    v_max_f32 v235, 0, v235
    v_mul_f32 v228, v228, v236
    v_mul_f32 v229, v229, v237
    v_mul_f32 v230, v230, v238
    v_mul_f32 v231, v231, v239
    v_mul_f32 v232, v232, v240
    v_mul_f32 v233, v233, v241
    v_mul_f32 v234, v234, v242
    v_mul_f32 v235, v235, v243
    v_cvt_pk_bf16_f32 v236, v228, v229
    v_cvt_pk_bf16_f32 v237, v230, v231
    v_cvt_pk_bf16_f32 v238, v232, v233
    v_cvt_pk_bf16_f32 v239, v234, v235
    buffer_store_dwordx4 v[236:239], v1, s[44:47], s14 offen offset:2048
    s_lshl_b32 s15, s48, 6
    s_lshl_b32 s61, s49, 2
    s_add_u32 s15, s15, s61
    s_add_u32 s15, s15, 57344
    s_waitcnt vmcnt(0)
    s_mov_b64 exec, 1
    buffer_store_dword v15, v1, s[44:47], s15 offen
    s_mov_b64 exec, -1
    s_endpgm
L_code_end:
L_slow:
    s_cmp_lt_u32 s3, 2
    s_cbranch_scc1 L_S_rj
    s_lshl_b32 s9, s67, 10
    s_add_u32 s9, s9, 0
    s_add_u32 s9, s9, s41
    s_add_u32 s10, s9, 4849664
    buffer_store_dwordx4 v[64:67], v1, s[44:47], s10 offen sc1
    s_lshl_b32 s9, s67, 10
    s_add_u32 s9, s9, 2048
    s_add_u32 s9, s9, s41
    s_add_u32 s10, s9, 4849664
    buffer_store_dwordx4 v[72:75], v1, s[44:47], s10 offen sc1
    s_lshl_b32 s9, s67, 10
    s_add_u32 s9, s9, 4096
    s_add_u32 s9, s9, s41
    s_add_u32 s10, s9, 4849664
    buffer_store_dwordx4 v[80:83], v1, s[44:47], s10 offen sc1
    s_add_u32 s9, s41, 6144
    s_cmp_eq_u32 s3, 3
    s_cselect_b32 s9, 0x7f000000, s9
    s_add_u32 s10, s9, 4849664
    buffer_store_dwordx4 v[88:91], v1, s[44:47], s10 offen sc1
    v_mov_b32 v112, 0
    v_mov_b32 v113, 0
    v_dot2c_f32_bf16 v112, s56, v64
    v_dot2c_f32_bf16 v113, v64, v64
    v_dot2c_f32_bf16 v112, s56, v65
    v_dot2c_f32_bf16 v113, v65, v65
    v_dot2c_f32_bf16 v112, s56, v66
    v_dot2c_f32_bf16 v113, v66, v66
    v_dot2c_f32_bf16 v112, s56, v67
    v_dot2c_f32_bf16 v113, v67, v67
    v_mov_b32 v114, 0
    v_mov_b32 v115, 0
    v_dot2c_f32_bf16 v114, s56, v72
    v_dot2c_f32_bf16 v115, v72, v72
    v_dot2c_f32_bf16 v114, s56, v73
    v_dot2c_f32_bf16 v115, v73, v73
    v_dot2c_f32_bf16 v114, s56, v74
    v_dot2c_f32_bf16 v115, v74, v74
    v_dot2c_f32_bf16 v114, s56, v75
    v_dot2c_f32_bf16 v115, v75, v75
    v_mov_b32 v116, 0
    v_mov_b32 v117, 0
    v_dot2c_f32_bf16 v116, s56, v80
    v_dot2c_f32_bf16 v117, v80, v80
    v_dot2c_f32_bf16 v116, s56, v81
    v_dot2c_f32_bf16 v117, v81, v81
    v_dot2c_f32_bf16 v116, s56, v82
    v_dot2c_f32_bf16 v117, v82, v82
    v_dot2c_f32_bf16 v116, s56, v83
    v_dot2c_f32_bf16 v117, v83, v83
    v_mov_b32 v118, 0
    v_mov_b32 v119, 0
    v_dot2c_f32_bf16 v118, s56, v88
    v_dot2c_f32_bf16 v119, v88, v88
    v_dot2c_f32_bf16 v118, s56, v89
    v_dot2c_f32_bf16 v119, v89, v89
    v_dot2c_f32_bf16 v118, s56, v90
    v_dot2c_f32_bf16 v119, v90, v90
    v_dot2c_f32_bf16 v118, s56, v91
    v_dot2c_f32_bf16 v119, v91, v91
    v_add_f32_dpp v112, v112, v112 row_ror:8 row_mask:0xf bank_mask:0xf
    v_add_f32_dpp v113, v113, v113 row_ror:8 row_mask:0xf bank_mask:0xf
    v_add_f32_dpp v114, v114, v114 row_ror:8 row_mask:0xf bank_mask:0xf
    v_add_f32_dpp v115, v115, v115 row_ror:8 row_mask:0xf bank_mask:0xf
    v_add_f32_dpp v116, v116, v116 row_ror:8 row_mask:0xf bank_mask:0xf
    v_add_f32_dpp v117, v117, v117 row_ror:8 row_mask:0xf bank_mask:0xf
    v_add_f32_dpp v118, v118, v118 row_ror:8 row_mask:0xf bank_mask:0xf
    v_add_f32_dpp v119, v119, v119 row_ror:8 row_mask:0xf bank_mask:0xf
    v_mov_b32 v120, v112
    v_mov_b32 v121, v113
    v_mov_b32 v122, v114
    v_mov_b32 v123, v115
    v_mov_b32 v124, v116
    v_mov_b32 v125, v117
    v_mov_b32 v126, v118
    v_mov_b32 v127, v119
    v_permlane16_swap_b32 v112, v120
    v_permlane16_swap_b32 v113, v121
    v_permlane16_swap_b32 v114, v122
    v_permlane16_swap_b32 v115, v123
    v_permlane16_swap_b32 v116, v124
    v_permlane16_swap_b32 v117, v125
    v_permlane16_swap_b32 v118, v126
    v_permlane16_swap_b32 v119, v127
    v_add_f32 v112, v112, v120
    v_add_f32 v113, v113, v121
    v_add_f32 v114, v114, v122
    v_add_f32 v115, v115, v123
    v_add_f32 v116, v116, v124
    v_add_f32 v117, v117, v125
    v_add_f32 v118, v118, v126
    v_add_f32 v119, v119, v127
    s_lshl_b32 s9, s67, 7
    s_add_u32 s9, s9, 0
    s_add_u32 s9, s9, s40
    buffer_store_dwordx2 v[112:113], v11, s[44:47], s9 offen sc1
    s_lshl_b32 s9, s67, 7
    s_add_u32 s9, s9, 256
    s_add_u32 s9, s9, s40
    buffer_store_dwordx2 v[114:115], v11, s[44:47], s9 offen sc1
    s_lshl_b32 s9, s67, 7
    s_add_u32 s9, s9, 512
    s_add_u32 s9, s9, s40
    buffer_store_dwordx2 v[116:117], v11, s[44:47], s9 offen sc1
    s_add_u32 s9, s40, 768
    s_cmp_eq_u32 s3, 3
    s_cselect_b32 s9, 0x7f000000, s9
    buffer_store_dwordx2 v[118:119], v11, s[44:47], s9 offen sc1
    s_lshl_b32 s10, s66, 8
    s_lshr_b32 s11, s49, 2
    s_lshl_b32 s11, s11, 6
    s_add_u32 s10, s10, s11
    s_and_b32 s11, s49, 3
    s_lshl_b32 s11, s11, 3
    s_add_u32 s10, s10, s11
    s_lshl_b32 s11, s67, 2
    s_add_u32 s10, s10, s11
    s_add_u32 s10, s10, 20480
    s_waitcnt vmcnt(0)
    s_mov_b64 exec, 1
    buffer_store_dword v15, v234, s[44:47], s10 offen sc1
    s_mov_b64 exec, -1
    s_lshl_b32 s9, s67, 10
    s_add_u32 s9, s9, 0
    s_add_u32 s9, s9, s41
    s_add_u32 s10, s9, 19005440
    buffer_store_dwordx4 v[68:71], v1, s[44:47], s10 offen sc1
    s_lshl_b32 s9, s67, 10
    s_add_u32 s9, s9, 2048
    s_add_u32 s9, s9, s41
    s_add_u32 s10, s9, 19005440
    buffer_store_dwordx4 v[76:79], v1, s[44:47], s10 offen sc1
    s_lshl_b32 s9, s67, 10
    s_add_u32 s9, s9, 4096
    s_add_u32 s9, s9, s41
    s_add_u32 s10, s9, 19005440
    buffer_store_dwordx4 v[84:87], v1, s[44:47], s10 offen sc1
    s_add_u32 s9, s41, 6144
    s_cmp_eq_u32 s3, 3
    s_cselect_b32 s9, 0x7f000000, s9
    s_add_u32 s10, s9, 19005440
    buffer_store_dwordx4 v[92:95], v1, s[44:47], s10 offen sc1
    s_nop 1
L_S_rj:
    s_add_u32 s8, s8, s55
    v_add_u32 v2, 0x10000, v1
    v_add_u32 v3, 0x20000, v1
    v_and_b32 v8, 31, v0
    v_lshlrev_b32 v8, 3, v8
    v_bfe_u32 v6, v0, 3, 2
    v_and_b32 v7, 7, v0
    v_lshrrev_b32 v4, 5, v0
    v_mul_u32_u24 v12, 7168, v6
    v_lshl_add_u32 v12, v4, 7, v12
    v_lshl_add_u32 v12, v7, 4, v12
    v_lshlrev_b32 v9, 10, v6
    v_lshl_add_u32 v9, v7, 3, v9
    v_mul_u32_u24 v4, 448, v4
    v_add_u32 v9, v9, v4
    v_min_u32 v6, 7, v0
    v_lshrrev_b32 v7, 2, v6
    v_and_b32 v6, 3, v6
    v_lshlrev_b32 v14, 6, v7
    v_lshl_add_u32 v14, v6, 2, v14
    s_lshl_b32 s40, s50, 6
    s_lshl_b32 s41, s3, 4
    s_add_u32 s40, s40, s41
    v_add_u32 v14, s40, v14
    s_mul_i32 s7, s48, 28672
    s_add_u32 s7, s7, 4849664
    s_lshl_b32 s60, s48, 12
    s_add_u32 s60, s60, 131072
    s_barrier
    v_min_u32 v7, 7, v0
    v_lshlrev_b32 v7, 2, v7
    s_lshl_b32 s38, s48, 6
    s_add_u32 s38, s38, 20480
    buffer_load_dword v6, v7, s[44:47], s38 offen sc1
    s_mov_b32 s62, 0
L10_chk:
    s_waitcnt vmcnt(0)
    v_cmp_ne_u32 vcc, s42, v6
    s_add_u32 s62, s62, 1
    s_cmp_lt_u32 s62, 0x20000
    s_cselect_b64 s[64:65], vcc, 0
    s_cmp_eq_u64 s[64:65], 0
    s_cbranch_scc1 L10_ok
    s_sleep 1
    buffer_load_dword v6, v7, s[44:47], s38 offen sc1
    s_waitcnt vmcnt(0) lgkmcnt(0)
    s_branch L10_chk
L10_ok:
    buffer_load_dwordx4 v[16:19], v12, s[44:47], s7 offen offset:0 sc1
    buffer_load_dwordx4 v[20:23], v12, s[44:47], s7 offen offset:256 sc1
    buffer_load_dwordx4 v[24:27], v12, s[44:47], s7 offen offset:512 sc1
    buffer_load_dwordx4 v[28:31], v12, s[44:47], s7 offen offset:768 sc1
    buffer_load_dwordx4 v[32:35], v12, s[44:47], s7 offen offset:1024 sc1
    buffer_load_dwordx4 v[36:39], v12, s[44:47], s7 offen offset:1280 sc1
    buffer_load_dwordx4 v[40:43], v12, s[44:47], s7 offen offset:1536 sc1
    buffer_load_dwordx4 v[44:47], v12, s[44:47], s7 offen offset:1792 sc1
    buffer_load_dwordx4 v[48:51], v12, s[44:47], s7 offen offset:2048 sc1
    ds_read_b128 a[224:227], v2 offset:49152
    ds_read_b128 a[228:231], v2 offset:50176
    ds_read_b128 a[232:235], v2 offset:51200
    ds_read_b128 a[236:239], v2 offset:52224
    s_waitcnt vmcnt(8) lgkmcnt(3)
    v_mfma_f32_32x32x16_bf16 v[132:147], a[224:227], v[16:19], 0
    ds_read_b128 a[240:243], v2 offset:53248
    buffer_load_dwordx4 v[52:55], v12, s[44:47], s7 offen offset:2304 sc1
    s_waitcnt lgkmcnt(3)
    v_mfma_f32_32x32x16_bf16 v[148:163], a[228:231], v[16:19], 0
    ds_read_b128 a[244:247], v2 offset:54272
    s_waitcnt lgkmcnt(3)
    v_mfma_f32_32x32x16_bf16 v[164:179], a[232:235], v[16:19], 0
    ds_read_b128 a[248:251], v2 offset:55296
    buffer_load_dwordx4 v[56:59], v12, s[44:47], s7 offen offset:2560 sc1
    s_waitcnt vmcnt(9) lgkmcnt(3)
    v_mfma_f32_32x32x16_bf16 v[132:147], a[236:239], v[20:23], v[132:147]
    ds_read_b128 a[252:255], v2 offset:56320
    s_waitcnt lgkmcnt(3)
    v_mfma_f32_32x32x16_bf16 v[148:163], a[240:243], v[20:23], v[148:163]
    ds_read_b128 a[224:227], v2 offset:57344
    buffer_load_dwordx4 v[60:63], v12, s[44:47], s7 offen offset:2816 sc1
    s_waitcnt lgkmcnt(3)
    v_mfma_f32_32x32x16_bf16 v[164:179], a[244:247], v[20:23], v[164:179]
    ds_read_b128 a[228:231], v2 offset:58368
    s_waitcnt vmcnt(9) lgkmcnt(3)
    v_mfma_f32_32x32x16_bf16 v[132:147], a[248:251], v[24:27], v[132:147]
    ds_read_b128 a[232:235], v2 offset:59392
    buffer_load_dwordx4 v[64:67], v12, s[44:47], s7 offen offset:3072 sc1
    s_waitcnt lgkmcnt(3)
    v_mfma_f32_32x32x16_bf16 v[148:163], a[252:255], v[24:27], v[148:163]
    ds_read_b128 a[236:239], v2 offset:60416
    s_waitcnt lgkmcnt(3)
    v_mfma_f32_32x32x16_bf16 v[164:179], a[224:227], v[24:27], v[164:179]
    ds_read_b128 a[240:243], v2 offset:61440
    buffer_load_dwordx4 v[68:71], v12, s[44:47], s7 offen offset:3328 sc1
    s_waitcnt vmcnt(10) lgkmcnt(3)
    v_mfma_f32_32x32x16_bf16 v[132:147], a[228:231], v[28:31], v[132:147]
    ds_read_b128 a[244:247], v2 offset:62464
    s_waitcnt lgkmcnt(3)
    v_mfma_f32_32x32x16_bf16 v[148:163], a[232:235], v[28:31], v[148:163]
    ds_read_b128 a[248:251], v2 offset:63488
    buffer_load_dwordx4 v[72:75], v12, s[44:47], s7 offen offset:3584 sc1
    s_waitcnt lgkmcnt(3)
    v_mfma_f32_32x32x16_bf16 v[164:179], a[236:239], v[28:31], v[164:179]
    ds_read_b128 a[252:255], v2 offset:64512
    s_waitcnt vmcnt(10) lgkmcnt(3)
    v_mfma_f32_32x32x16_bf16 v[132:147], a[240:243], v[32:35], v[132:147]
    ds_read_b128 a[224:227], v3 offset:0
    buffer_load_dwordx4 v[76:79], v12, s[44:47], s7 offen offset:3840 sc1
    s_waitcnt lgkmcnt(3)
    v_mfma_f32_32x32x16_bf16 v[148:163], a[244:247], v[32:35], v[148:163]
    ds_read_b128 a[228:231], v3 offset:1024
    s_waitcnt lgkmcnt(3)
    v_mfma_f32_32x32x16_bf16 v[164:179], a[248:251], v[32:35], v[164:179]
    ds_read_b128 a[232:235], v3 offset:2048
    s_add_u32 s7, s7, 4096
    buffer_load_dwordx4 v[80:83], v12, s[44:47], s7 offen offset:0 sc1
    s_waitcnt vmcnt(11) lgkmcnt(3)
    v_mfma_f32_32x32x16_bf16 v[132:147], a[252:255], v[36:39], v[132:147]
    ds_read_b128 a[236:239], v3 offset:3072
    s_waitcnt lgkmcnt(3)
    v_mfma_f32_32x32x16_bf16 v[148:163], a[224:227], v[36:39], v[148:163]
    ds_read_b128 a[240:243], v3 offset:4096
    buffer_load_dwordx4 v[84:87], v12, s[44:47], s7 offen offset:256 sc1
    s_waitcnt lgkmcnt(3)
    v_mfma_f32_32x32x16_bf16 v[164:179], a[228:231], v[36:39], v[164:179]
    ds_read_b128 a[244:247], v3 offset:5120
    s_waitcnt vmcnt(11) lgkmcnt(3)
    v_mfma_f32_32x32x16_bf16 v[132:147], a[232:235], v[40:43], v[132:147]
    ds_read_b128 a[248:251], v3 offset:6144
    buffer_load_dwordx4 v[88:91], v12, s[44:47], s7 offen offset:512 sc1
    s_waitcnt lgkmcnt(3)
    v_mfma_f32_32x32x16_bf16 v[148:163], a[236:239], v[40:43], v[148:163]
    ds_read_b128 a[252:255], v3 offset:7168
    s_waitcnt lgkmcnt(3)
    v_mfma_f32_32x32x16_bf16 v[164:179], a[240:243], v[40:43], v[164:179]
    ds_read_b128 a[224:227], v3 offset:8192
    buffer_load_dwordx4 v[92:95], v12, s[44:47], s7 offen offset:768 sc1
    s_waitcnt vmcnt(12) lgkmcnt(3)
    v_mfma_f32_32x32x16_bf16 v[132:147], a[244:247], v[44:47], v[132:147]
    ds_read_b128 a[228:231], v3 offset:9216
    s_waitcnt lgkmcnt(3)
    v_mfma_f32_32x32x16_bf16 v[148:163], a[248:251], v[44:47], v[148:163]
    ds_read_b128 a[232:235], v3 offset:10240
    buffer_load_dwordx2 v[244:245], v9, s[44:47], s60 offen offset:0 sc1
    buffer_load_dwordx2 v[246:247], v9, s[44:47], s60 offen offset:64 sc1
    buffer_load_dwordx2 v[248:249], v9, s[44:47], s60 offen offset:128 sc1
    buffer_load_dwordx2 v[250:251], v9, s[44:47], s60 offen offset:192 sc1
    buffer_load_dwordx2 v[252:253], v9, s[44:47], s60 offen offset:256 sc1
    buffer_load_dwordx2 v[254:255], v9, s[44:47], s60 offen offset:320 sc1
    buffer_load_dwordx2 v[10:11], v9, s[44:47], s60 offen offset:384 sc1
    s_waitcnt lgkmcnt(3)
    v_mfma_f32_32x32x16_bf16 v[164:179], a[252:255], v[44:47], v[164:179]
    ds_read_b128 a[236:239], v3 offset:11264
    s_waitcnt vmcnt(18) lgkmcnt(3)
    v_mfma_f32_32x32x16_bf16 v[132:147], a[224:227], v[48:51], v[132:147]
    ds_read_b128 a[240:243], v3 offset:12288
    buffer_load_dwordx4 v[96:99], v12, s[44:47], s7 offen offset:1024 sc1
    s_waitcnt lgkmcnt(3)
    v_mfma_f32_32x32x16_bf16 v[148:163], a[228:231], v[48:51], v[148:163]
    ds_read_b128 a[244:247], v3 offset:13312
    s_waitcnt lgkmcnt(3)
    v_mfma_f32_32x32x16_bf16 v[164:179], a[232:235], v[48:51], v[164:179]
    ds_read_b128 a[248:251], v3 offset:14336
    buffer_load_dwordx4 v[100:103], v12, s[44:47], s7 offen offset:1280 sc1
    s_waitcnt vmcnt(19) lgkmcnt(3)
    v_mfma_f32_32x32x16_bf16 v[132:147], a[236:239], v[52:55], v[132:147]
    ds_read_b128 a[252:255], v3 offset:15360
    s_waitcnt lgkmcnt(3)
    v_mfma_f32_32x32x16_bf16 v[148:163], a[240:243], v[52:55], v[148:163]
    ds_read_b128 a[224:227], v3 offset:16384
    buffer_load_dwordx4 v[104:107], v12, s[44:47], s7 offen offset:1536 sc1
    s_waitcnt lgkmcnt(3)
    v_mfma_f32_32x32x16_bf16 v[164:179], a[244:247], v[52:55], v[164:179]
    ds_read_b128 a[228:231], v3 offset:17408
    s_waitcnt vmcnt(19) lgkmcnt(3)
    v_mfma_f32_32x32x16_bf16 v[132:147], a[248:251], v[56:59], v[132:147]
    ds_read_b128 a[232:235], v3 offset:18432
    buffer_load_dwordx4 v[108:111], v12, s[44:47], s7 offen offset:1792 sc1
    s_waitcnt lgkmcnt(3)
    v_mfma_f32_32x32x16_bf16 v[148:163], a[252:255], v[56:59], v[148:163]
    ds_read_b128 a[236:239], v3 offset:19456
    s_waitcnt lgkmcnt(3)
    v_mfma_f32_32x32x16_bf16 v[164:179], a[224:227], v[56:59], v[164:179]
    ds_read_b128 a[240:243], v3 offset:20480
    buffer_load_dwordx4 v[112:115], v12, s[44:47], s7 offen offset:2048 sc1
    s_waitcnt vmcnt(20) lgkmcnt(3)
    v_mfma_f32_32x32x16_bf16 v[132:147], a[228:231], v[60:63], v[132:147]
    ds_read_b128 a[244:247], v3 offset:21504
    s_waitcnt lgkmcnt(3)
    v_mfma_f32_32x32x16_bf16 v[148:163], a[232:235], v[60:63], v[148:163]
    ds_read_b128 a[248:251], v3 offset:22528
    buffer_load_dwordx4 v[116:119], v12, s[44:47], s7 offen offset:2304 sc1
    s_waitcnt lgkmcnt(3)
    v_mfma_f32_32x32x16_bf16 v[164:179], a[236:239], v[60:63], v[164:179]
    ds_read_b128 a[252:255], v3 offset:23552
    s_waitcnt vmcnt(20) lgkmcnt(3)
    v_mfma_f32_32x32x16_bf16 v[132:147], a[240:243], v[64:67], v[132:147]
    ds_read_b128 a[224:227], v3 offset:24576
    buffer_load_dwordx4 v[120:123], v12, s[44:47], s7 offen offset:2560 sc1
    s_waitcnt lgkmcnt(3)
    v_mfma_f32_32x32x16_bf16 v[148:163], a[244:247], v[64:67], v[148:163]
    ds_read_b128 a[228:231], v3 offset:25600
    s_waitcnt lgkmcnt(3)
    v_mfma_f32_32x32x16_bf16 v[164:179], a[248:251], v[64:67], v[164:179]
    ds_read_b128 a[232:235], v3 offset:26624
    buffer_load_dwordx4 v[124:127], v12, s[44:47], s7 offen offset:2816 sc1
    s_waitcnt vmcnt(21) lgkmcnt(3)
    v_mfma_f32_32x32x16_bf16 v[132:147], a[252:255], v[68:71], v[132:147]
    ds_read_b128 a[236:239], v3 offset:27648
    s_waitcnt lgkmcnt(3)
    v_mfma_f32_32x32x16_bf16 v[148:163], a[224:227], v[68:71], v[148:163]
    ds_read_b128 a[240:243], v3 offset:28672
    s_add_u32 s10, s55, 49152
    s_mov_b32 m0, s10
    s_add_u32 s11, s8, 98304
    buffer_load_dwordx4 v1, s[44:47], s11 offen offset:0 lds
    s_waitcnt lgkmcnt(3)
    v_mfma_f32_32x32x16_bf16 v[164:179], a[228:231], v[68:71], v[164:179]
    ds_read_b128 a[244:247], v3 offset:29696
    s_waitcnt vmcnt(21) lgkmcnt(3)
    v_mfma_f32_32x32x16_bf16 v[132:147], a[232:235], v[72:75], v[132:147]
    ds_read_b128 a[248:251], v3 offset:30720
    buffer_load_dwordx4 v1, s[44:47], s11 offen offset:1024 lds
    s_waitcnt lgkmcnt(3)
    v_mfma_f32_32x32x16_bf16 v[148:163], a[236:239], v[72:75], v[148:163]
    ds_read_b128 a[252:255], v3 offset:31744
    s_waitcnt lgkmcnt(3)
    v_mfma_f32_32x32x16_bf16 v[164:179], a[240:243], v[72:75], v[164:179]
    ds_read_b128 a[224:227], v1 offset:0
    buffer_load_dwordx4 v1, s[44:47], s11 offen offset:2048 lds
    s_waitcnt vmcnt(22) lgkmcnt(3)
    v_mfma_f32_32x32x16_bf16 v[132:147], a[244:247], v[76:79], v[132:147]
    ds_read_b128 a[228:231], v1 offset:1024
    s_waitcnt lgkmcnt(3)
    v_mfma_f32_32x32x16_bf16 v[148:163], a[248:251], v[76:79], v[148:163]
    ds_read_b128 a[232:235], v1 offset:2048
    buffer_load_dwordx4 v1, s[44:47], s11 offen offset:3072 lds
    s_waitcnt lgkmcnt(3)
    v_mfma_f32_32x32x16_bf16 v[164:179], a[252:255], v[76:79], v[164:179]
    ds_read_b128 a[236:239], v1 offset:3072
    s_waitcnt vmcnt(22) lgkmcnt(3)
    v_mfma_f32_32x32x16_bf16 v[132:147], a[224:227], v[80:83], v[132:147]
    ds_read_b128 a[240:243], v1 offset:4096
    s_add_u32 s10, s55, 65536
    s_mov_b32 m0, s10
    s_add_u32 s11, s8, 114688
    buffer_load_dwordx4 v1, s[44:47], s11 offen offset:0 lds
    s_waitcnt lgkmcnt(3)
    v_mfma_f32_32x32x16_bf16 v[148:163], a[228:231], v[80:83], v[148:163]
    s_barrier
    ds_read_b128 a[244:247], v1 offset:5120
    s_waitcnt lgkmcnt(3)
    v_mfma_f32_32x32x16_bf16 v[164:179], a[232:235], v[80:83], v[164:179]
    ds_read_b128 a[248:251], v1 offset:6144
    buffer_load_dwordx4 v1, s[44:47], s11 offen offset:1024 lds
    s_waitcnt vmcnt(23) lgkmcnt(3)
    v_mfma_f32_32x32x16_bf16 v[132:147], a[236:239], v[84:87], v[132:147]
    ds_read_b128 a[252:255], v1 offset:7168
    s_waitcnt lgkmcnt(3)
    v_mfma_f32_32x32x16_bf16 v[148:163], a[240:243], v[84:87], v[148:163]
    ds_read_b128 a[224:227], v1 offset:8192
    buffer_load_dwordx4 v1, s[44:47], s11 offen offset:2048 lds
    s_waitcnt lgkmcnt(3)
    v_mfma_f32_32x32x16_bf16 v[164:179], a[244:247], v[84:87], v[164:179]
    ds_read_b128 a[228:231], v1 offset:9216
    s_waitcnt vmcnt(23) lgkmcnt(3)
    v_mfma_f32_32x32x16_bf16 v[132:147], a[248:251], v[88:91], v[132:147]
    ds_read_b128 a[232:235], v1 offset:10240
    buffer_load_dwordx4 v1, s[44:47], s11 offen offset:3072 lds
    s_waitcnt lgkmcnt(3)
    v_mfma_f32_32x32x16_bf16 v[148:163], a[252:255], v[88:91], v[148:163]
    ds_read_b128 a[236:239], v1 offset:11264
    s_waitcnt lgkmcnt(3)
    v_mfma_f32_32x32x16_bf16 v[164:179], a[224:227], v[88:91], v[164:179]
    ds_read_b128 a[240:243], v1 offset:12288
    s_add_u32 s10, s55, 81920
    s_mov_b32 m0, s10
    s_add_u32 s11, s8, 131072
    buffer_load_dwordx4 v1, s[44:47], s11 offen offset:0 lds
    s_waitcnt vmcnt(24) lgkmcnt(3)
    v_mfma_f32_32x32x16_bf16 v[132:147], a[228:231], v[92:95], v[132:147]
    ds_read_b128 a[244:247], v1 offset:13312
    s_waitcnt vmcnt(22)
    v_add_f32 v244, v244, v246
    v_add_f32 v245, v245, v247
    s_waitcnt vmcnt(21)
    v_add_f32 v244, v244, v248
    s_waitcnt lgkmcnt(3)
    v_mfma_f32_32x32x16_bf16 v[148:163], a[232:235], v[92:95], v[148:163]
    ds_read_b128 a[248:251], v1 offset:14336
    buffer_load_dwordx4 v1, s[44:47], s11 offen offset:1024 lds
    v_add_f32 v245, v245, v249
    s_waitcnt vmcnt(21)
    v_add_f32 v244, v244, v250
    v_add_f32 v245, v245, v251
    s_waitcnt lgkmcnt(3)
    v_mfma_f32_32x32x16_bf16 v[164:179], a[236:239], v[92:95], v[164:179]
    ds_read_b128 a[252:255], v1 offset:15360
    s_waitcnt vmcnt(20)
    v_add_f32 v244, v244, v252
    v_add_f32 v245, v245, v253
    s_waitcnt vmcnt(19)
    v_add_f32 v244, v244, v254
    s_waitcnt vmcnt(17) lgkmcnt(3)
    v_mfma_f32_32x32x16_bf16 v[132:147], a[240:243], v[96:99], v[132:147]
    ds_read_b128 a[224:227], v1 offset:16384
    buffer_load_dwordx4 v1, s[44:47], s11 offen offset:2048 lds
    v_add_f32 v245, v245, v255
    v_add_f32 v4, v244, v10
    v_add_f32 v5, v245, v11
    s_waitcnt lgkmcnt(3)
    v_mfma_f32_32x32x16_bf16 v[148:163], a[244:247], v[96:99], v[148:163]
    ds_read_b128 a[228:231], v1 offset:17408
    v_mov_b32 v6, v4
    s_nop 1
    v_permlane32_swap_b32 v4, v6
    v_add_f32 v4, v4, v6
    s_waitcnt lgkmcnt(3)
    v_mfma_f32_32x32x16_bf16 v[164:179], a[248:251], v[96:99], v[164:179]
    ds_read_b128 a[232:235], v1 offset:18432
    buffer_load_dwordx4 v1, s[44:47], s11 offen offset:3072 lds
    v_mov_b32 v6, v5
    s_nop 1
    v_permlane32_swap_b32 v5, v6
    v_add_f32 v5, v5, v6
    s_waitcnt vmcnt(18) lgkmcnt(3)
    v_mfma_f32_32x32x16_bf16 v[132:147], a[252:255], v[100:103], v[132:147]
    ds_read_b128 a[236:239], v1 offset:19456
    v_mul_f32 v4, 0xbb124925, v4
    v_mul_f32 v5, 0x3b124925, v5
    v_fma_f32 v5, -v4, v4, v5
    s_waitcnt lgkmcnt(3)
    v_mfma_f32_32x32x16_bf16 v[148:163], a[224:227], v[100:103], v[148:163]
    ds_read_b128 a[240:243], v1 offset:20480
    s_add_u32 s10, s55, 98304
    s_mov_b32 m0, s10
    s_add_u32 s11, s8, 147456
    buffer_load_dwordx4 v1, s[44:47], s11 offen offset:0 lds
    v_max_f32 v5, 0, v5
    v_add_f32 v5, 0x3727c5ac, v5
    v_rcp_f32 v5, v5
    s_waitcnt lgkmcnt(3)
    v_mfma_f32_32x32x16_bf16 v[164:179], a[228:231], v[100:103], v[164:179]
    ds_read_b128 a[244:247], v1 offset:21504
    v_cvt_pk_bf16_f32 v128, v4, v4
    v_lshlrev_b32 v6, 16, v128
    v_sub_f32 v6, v4, v6
    s_waitcnt vmcnt(18) lgkmcnt(3)
    v_mfma_f32_32x32x16_bf16 v[132:147], a[232:235], v[104:107], v[132:147]
    ds_read_b128 a[248:251], v1 offset:22528
    buffer_load_dwordx4 v1, s[44:47], s11 offen offset:1024 lds
    v_cvt_pk_bf16_f32 v129, v6, v6
    v_mov_b32 v130, v128
    v_mov_b32 v131, v129
    s_waitcnt lgkmcnt(3)
    v_mfma_f32_32x32x16_bf16 v[148:163], a[236:239], v[104:107], v[148:163]
    ds_read_b128 a[252:255], v1 offset:23552
    v_lshrrev_b32 v6, 1, v8
    s_lshl_b32 s15, s48, 7
    s_add_u32 s15, s15, 65536
    s_waitcnt lgkmcnt(3)
    v_mfma_f32_32x32x16_bf16 v[164:179], a[240:243], v[104:107], v[164:179]
    ds_read_b128 a[224:227], v1 offset:24576
    buffer_load_dwordx4 v1, s[44:47], s11 offen offset:2048 lds
    buffer_store_dword v5, v6, s[44:47], s15 offen sc1
    s_waitcnt vmcnt(20) lgkmcnt(3)
    v_mfma_f32_32x32x16_bf16 v[132:147], a[244:247], v[108:111], v[132:147]
    ds_read_b128 a[228:231], v1 offset:25600
    s_waitcnt lgkmcnt(3)
    v_mfma_f32_32x32x16_bf16 v[148:163], a[248:251], v[108:111], v[148:163]
    ds_read_b128 a[232:235], v1 offset:26624
    buffer_load_dwordx4 v1, s[44:47], s11 offen offset:3072 lds
    s_waitcnt lgkmcnt(3)
    v_mfma_f32_32x32x16_bf16 v[164:179], a[252:255], v[108:111], v[164:179]
    ds_read_b128 a[236:239], v1 offset:27648
    s_waitcnt vmcnt(20) lgkmcnt(3)
    v_mfma_f32_32x32x16_bf16 v[132:147], a[224:227], v[112:115], v[132:147]
    ds_read_b128 a[240:243], v1 offset:28672
    s_add_u32 s10, s55, 114688
    s_mov_b32 m0, s10
    s_add_u32 s11, s8, 163840
    buffer_load_dwordx4 v1, s[44:47], s11 offen offset:0 lds
    s_waitcnt lgkmcnt(3)
    v_mfma_f32_32x32x16_bf16 v[148:163], a[228:231], v[112:115], v[148:163]
    ds_read_b128 a[244:247], v1 offset:29696
    s_waitcnt lgkmcnt(3)
    v_mfma_f32_32x32x16_bf16 v[164:179], a[232:235], v[112:115], v[164:179]
    ds_read_b128 a[248:251], v1 offset:30720
    buffer_load_dwordx4 v1, s[44:47], s11 offen offset:1024 lds
    s_waitcnt vmcnt(21) lgkmcnt(3)
    v_mfma_f32_32x32x16_bf16 v[132:147], a[236:239], v[116:119], v[132:147]
    ds_read_b128 a[252:255], v1 offset:31744
    s_waitcnt lgkmcnt(3)
    v_mfma_f32_32x32x16_bf16 v[148:163], a[240:243], v[116:119], v[148:163]
    ds_read_b128 a[224:227], v1 offset:32768
    buffer_load_dwordx4 v1, s[44:47], s11 offen offset:2048 lds
    s_waitcnt lgkmcnt(3)
    v_mfma_f32_32x32x16_bf16 v[164:179], a[244:247], v[116:119], v[164:179]
    ds_read_b128 a[228:231], v1 offset:33792
    s_waitcnt vmcnt(21) lgkmcnt(3)
    v_mfma_f32_32x32x16_bf16 v[132:147], a[248:251], v[120:123], v[132:147]
    ds_read_b128 a[232:235], v1 offset:34816
    buffer_load_dwordx4 v1, s[44:47], s11 offen offset:3072 lds
    s_waitcnt lgkmcnt(3)
    v_mfma_f32_32x32x16_bf16 v[148:163], a[252:255], v[120:123], v[148:163]
    ds_read_b128 a[236:239], v1 offset:35840
    s_waitcnt lgkmcnt(3)
    v_mfma_f32_32x32x16_bf16 v[164:179], a[224:227], v[120:123], v[164:179]
    ds_read_b128 a[240:243], v1 offset:36864
    s_add_u32 s10, s55, 131072
    s_mov_b32 m0, s10
    s_add_u32 s11, s8, 180224
    buffer_load_dwordx4 v1, s[44:47], s11 offen offset:0 lds
    s_waitcnt vmcnt(22) lgkmcnt(3)
    v_mfma_f32_32x32x16_bf16 v[132:147], a[228:231], v[124:127], v[132:147]
    ds_read_b128 a[244:247], v1 offset:37888
    s_waitcnt lgkmcnt(3)
    v_mfma_f32_32x32x16_bf16 v[148:163], a[232:235], v[124:127], v[148:163]
    ds_read_b128 a[248:251], v1 offset:38912
    buffer_load_dwordx4 v1, s[44:47], s11 offen offset:1024 lds
    s_waitcnt lgkmcnt(3)
    v_mfma_f32_32x32x16_bf16 v[164:179], a[236:239], v[124:127], v[164:179]
    ds_read_b128 a[252:255], v1 offset:39936
    s_waitcnt lgkmcnt(3)
    v_mfma_f32_32x32x16_bf16 v[132:147], a[240:243], v[128:131], v[132:147]
    ds_read_b128 a[224:227], v1 offset:40960
    buffer_load_dwordx4 v1, s[44:47], s11 offen offset:2048 lds
    s_waitcnt lgkmcnt(3)
    v_mfma_f32_32x32x16_bf16 v[148:163], a[244:247], v[128:131], v[148:163]
    ds_read_b128 a[228:231], v1 offset:41984
    s_waitcnt lgkmcnt(3)
    v_mfma_f32_32x32x16_bf16 v[164:179], a[248:251], v[128:131], v[164:179]
    ds_read_b128 a[232:235], v1 offset:43008
    buffer_load_dwordx4 v1, s[44:47], s11 offen offset:3072 lds
    s_waitcnt lgkmcnt(3)
    v_mfma_f32_32x32x16_bf16 v[180:195], a[252:255], v[16:19], 0
    ds_read_b128 a[236:239], v1 offset:44032
    s_waitcnt lgkmcnt(3)
    v_mfma_f32_32x32x16_bf16 v[196:211], a[224:227], v[16:19], 0
    ds_read_b128 a[240:243], v1 offset:45056
    s_add_u32 s10, s55, 147456
    s_mov_b32 m0, s10
    s_add_u32 s11, s8, 196608
    buffer_load_dwordx4 v1, s[44:47], s11 offen offset:0 lds
    v_max_f32 v132, 0, v132
    v_max_f32 v133, 0, v133
    v_max_f32 v134, 0, v134
    s_waitcnt lgkmcnt(3)
    v_mfma_f32_32x32x16_bf16 v[180:195], a[228:231], v[20:23], v[180:195]
    ds_read_b128 a[244:247], v1 offset:46080
    v_max_f32 v135, 0, v135
    v_max_f32 v136, 0, v136
    v_max_f32 v137, 0, v137
    s_waitcnt lgkmcnt(3)
    v_mfma_f32_32x32x16_bf16 v[196:211], a[232:235], v[20:23], v[196:211]
    ds_read_b128 a[248:251], v1 offset:47104
    buffer_load_dwordx4 v1, s[44:47], s11 offen offset:1024 lds
    v_max_f32 v138, 0, v138
    v_max_f32 v139, 0, v139
    v_mul_f32 v132, v132, v140
    s_waitcnt lgkmcnt(3)
    v_mfma_f32_32x32x16_bf16 v[180:195], a[236:239], v[24:27], v[180:195]
    ds_read_b128 a[252:255], v1 offset:48128
    v_mul_f32 v133, v133, v141
    v_mul_f32 v134, v134, v142
    v_mul_f32 v135, v135, v143
    s_waitcnt lgkmcnt(3)
    v_mfma_f32_32x32x16_bf16 v[196:211], a[240:243], v[24:27], v[196:211]
    s_waitcnt vmcnt(23)
    s_barrier
    ds_read_b128 a[224:227], v1 offset:49152
    buffer_load_dwordx4 v1, s[44:47], s11 offen offset:2048 lds
    v_mul_f32 v136, v136, v144
    v_mul_f32 v137, v137, v145
    v_mul_f32 v138, v138, v146
    s_waitcnt lgkmcnt(3)
    v_mfma_f32_32x32x16_bf16 v[180:195], a[244:247], v[28:31], v[180:195]
    ds_read_b128 a[228:231], v1 offset:50176
    v_mul_f32 v139, v139, v147
    v_cvt_pk_bf16_f32 v140, v132, v133
    v_cvt_pk_bf16_f32 v141, v134, v135
    s_waitcnt lgkmcnt(3)
    v_mfma_f32_32x32x16_bf16 v[196:211], a[248:251], v[28:31], v[196:211]
    ds_read_b128 a[232:235], v1 offset:51200
    buffer_load_dwordx4 v1, s[44:47], s11 offen offset:3072 lds
    v_cvt_pk_bf16_f32 v142, v136, v137
    v_cvt_pk_bf16_f32 v143, v138, v139
    buffer_store_dwordx4 v[140:143], v1, s[44:47], s13 offen offset:0 sc1
    s_waitcnt lgkmcnt(3)
    v_mfma_f32_32x32x16_bf16 v[180:195], a[252:255], v[32:35], v[180:195]
    ds_read_b128 a[236:239], v1 offset:52224
    v_max_f32 v148, 0, v148
    v_max_f32 v149, 0, v149
    v_max_f32 v150, 0, v150
    s_waitcnt lgkmcnt(3)
    v_mfma_f32_32x32x16_bf16 v[196:211], a[224:227], v[32:35], v[196:211]
    ds_read_b128 a[240:243], v1 offset:53248
    s_add_u32 s63, s59, 32768
    buffer_load_dwordx4 a[140:143], v1, s[44:47], s63 offen offset:2048
    v_max_f32 v151, 0, v151
    v_max_f32 v152, 0, v152
    v_max_f32 v153, 0, v153
    s_waitcnt lgkmcnt(3)
    v_mfma_f32_32x32x16_bf16 v[180:195], a[228:231], v[36:39], v[180:195]
    ds_read_b128 a[244:247], v1 offset:54272
    v_max_f32 v154, 0, v154
    v_max_f32 v155, 0, v155
    v_mul_f32 v148, v148, v156
    s_waitcnt lgkmcnt(3)
    v_mfma_f32_32x32x16_bf16 v[196:211], a[232:235], v[36:39], v[196:211]
    ds_read_b128 a[248:251], v1 offset:55296
    s_add_u32 s63, s58, 36864
    buffer_load_dwordx4 a[144:147], v1, s[44:47], s63 offen offset:0
    v_mul_f32 v149, v149, v157
    v_mul_f32 v150, v150, v158
    v_mul_f32 v151, v151, v159
    s_waitcnt lgkmcnt(3)
    v_mfma_f32_32x32x16_bf16 v[180:195], a[236:239], v[40:43], v[180:195]
    ds_read_b128 a[252:255], v1 offset:56320
    v_mul_f32 v152, v152, v160
    v_mul_f32 v153, v153, v161
    v_mul_f32 v154, v154, v162
    s_waitcnt lgkmcnt(3)
    v_mfma_f32_32x32x16_bf16 v[196:211], a[240:243], v[40:43], v[196:211]
    ds_read_b128 a[224:227], v1 offset:57344
    s_add_u32 s63, s59, 36864
    buffer_load_dwordx4 a[148:151], v1, s[44:47], s63 offen offset:0
    v_mul_f32 v155, v155, v163
    v_cvt_pk_bf16_f32 v156, v148, v149
    v_cvt_pk_bf16_f32 v157, v150, v151
    s_waitcnt lgkmcnt(3)
    v_mfma_f32_32x32x16_bf16 v[180:195], a[244:247], v[44:47], v[180:195]
    ds_read_b128 a[228:231], v1 offset:58368
    v_cvt_pk_bf16_f32 v158, v152, v153
    v_cvt_pk_bf16_f32 v159, v154, v155
    buffer_store_dwordx4 v[156:159], v1, s[44:47], s13 offen offset:1024 sc1
    s_waitcnt lgkmcnt(3)
    v_mfma_f32_32x32x16_bf16 v[196:211], a[248:251], v[44:47], v[196:211]
    ds_read_b128 a[232:235], v1 offset:59392
    s_add_u32 s63, s58, 49152
    buffer_load_dwordx4 a[192:195], v1, s[44:47], s63 offen offset:0
    v_max_f32 v164, 0, v164
    v_max_f32 v165, 0, v165
    v_max_f32 v166, 0, v166
    s_waitcnt lgkmcnt(3)
    v_mfma_f32_32x32x16_bf16 v[180:195], a[252:255], v[48:51], v[180:195]
    ds_read_b128 a[236:239], v1 offset:60416
    v_max_f32 v167, 0, v167
    v_max_f32 v168, 0, v168
    v_max_f32 v169, 0, v169
    s_waitcnt lgkmcnt(3)
    v_mfma_f32_32x32x16_bf16 v[196:211], a[224:227], v[48:51], v[196:211]
    ds_read_b128 a[240:243], v1 offset:61440
    s_add_u32 s63, s59, 49152
    buffer_load_dwordx4 a[196:199], v1, s[44:47], s63 offen offset:0
    v_max_f32 v170, 0, v170
    v_max_f32 v171, 0, v171
    v_mul_f32 v164, v164, v172
    s_waitcnt lgkmcnt(3)
    v_mfma_f32_32x32x16_bf16 v[180:195], a[228:231], v[52:55], v[180:195]
    ds_read_b128 a[244:247], v1 offset:62464
    v_mul_f32 v165, v165, v173
    v_mul_f32 v166, v166, v174
    v_mul_f32 v167, v167, v175
    s_waitcnt lgkmcnt(3)
    v_mfma_f32_32x32x16_bf16 v[196:211], a[232:235], v[52:55], v[196:211]
    ds_read_b128 a[248:251], v1 offset:63488
    s_add_u32 s63, s58, 49152
    buffer_load_dwordx4 a[200:203], v1, s[44:47], s63 offen offset:2048
    v_mul_f32 v168, v168, v176
    v_mul_f32 v169, v169, v177
    v_mul_f32 v170, v170, v178
    s_waitcnt lgkmcnt(3)
    v_mfma_f32_32x32x16_bf16 v[180:195], a[236:239], v[56:59], v[180:195]
    ds_read_b128 a[252:255], v1 offset:64512
    v_mul_f32 v171, v171, v179
    v_cvt_pk_bf16_f32 v172, v164, v165
    v_cvt_pk_bf16_f32 v173, v166, v167
    s_waitcnt lgkmcnt(3)
    v_mfma_f32_32x32x16_bf16 v[196:211], a[240:243], v[56:59], v[196:211]
    s_waitcnt vmcnt(29)
    s_barrier
    ds_read_b128 a[224:227], v2 offset:0
    s_add_u32 s63, s59, 49152
    buffer_load_dwordx4 a[204:207], v1, s[44:47], s63 offen offset:2048
    v_cvt_pk_bf16_f32 v174, v168, v169
    v_cvt_pk_bf16_f32 v175, v170, v171
    buffer_store_dwordx4 v[172:175], v1, s[44:47], s13 offen offset:2048 sc1
    s_waitcnt lgkmcnt(3)
    v_mfma_f32_32x32x16_bf16 v[180:195], a[244:247], v[60:63], v[180:195]
    ds_read_b128 a[228:231], v2 offset:1024
    s_waitcnt lgkmcnt(3)
    v_mfma_f32_32x32x16_bf16 v[196:211], a[248:251], v[60:63], v[196:211]
    ds_read_b128 a[232:235], v2 offset:2048
    s_add_u32 s63, s58, 8192
    buffer_load_dwordx4 a[40:43], v1, s[44:47], s63 offen offset:2048
    s_waitcnt lgkmcnt(3)
    v_mfma_f32_32x32x16_bf16 v[180:195], a[252:255], v[64:67], v[180:195]
    ds_read_b128 a[236:239], v2 offset:3072
    s_waitcnt lgkmcnt(3)
    v_mfma_f32_32x32x16_bf16 v[196:211], a[224:227], v[64:67], v[196:211]
    ds_read_b128 a[240:243], v2 offset:4096
    s_add_u32 s63, s59, 8192
    buffer_load_dwordx4 a[44:47], v1, s[44:47], s63 offen offset:2048
    s_waitcnt lgkmcnt(3)
    v_mfma_f32_32x32x16_bf16 v[180:195], a[228:231], v[68:71], v[180:195]
    ds_read_b128 a[244:247], v2 offset:5120
    s_waitcnt lgkmcnt(3)
    v_mfma_f32_32x32x16_bf16 v[196:211], a[232:235], v[68:71], v[196:211]
    ds_read_b128 a[248:251], v2 offset:6144
    s_add_u32 s63, s58, 12288
    buffer_load_dwordx4 a[48:51], v1, s[44:47], s63 offen offset:0
    s_waitcnt lgkmcnt(3)
    v_mfma_f32_32x32x16_bf16 v[180:195], a[236:239], v[72:75], v[180:195]
    ds_read_b128 a[252:255], v2 offset:7168
    s_waitcnt lgkmcnt(3)
    v_mfma_f32_32x32x16_bf16 v[196:211], a[240:243], v[72:75], v[196:211]
    ds_read_b128 a[224:227], v2 offset:8192
    s_add_u32 s63, s59, 12288
    buffer_load_dwordx4 a[52:55], v1, s[44:47], s63 offen offset:0
    s_waitcnt lgkmcnt(3)
    v_mfma_f32_32x32x16_bf16 v[180:195], a[244:247], v[76:79], v[180:195]
    ds_read_b128 a[228:231], v2 offset:9216
    s_waitcnt lgkmcnt(3)
    v_mfma_f32_32x32x16_bf16 v[196:211], a[248:251], v[76:79], v[196:211]
    ds_read_b128 a[232:235], v2 offset:10240
    s_add_u32 s63, s58, 24576
    buffer_load_dwordx4 a[96:99], v1, s[44:47], s63 offen offset:0
    s_waitcnt lgkmcnt(3)
    v_mfma_f32_32x32x16_bf16 v[180:195], a[252:255], v[80:83], v[180:195]
    ds_read_b128 a[236:239], v2 offset:11264
    s_waitcnt lgkmcnt(3)
    v_mfma_f32_32x32x16_bf16 v[196:211], a[224:227], v[80:83], v[196:211]
    ds_read_b128 a[240:243], v2 offset:12288
    s_add_u32 s63, s59, 24576
    buffer_load_dwordx4 a[100:103], v1, s[44:47], s63 offen offset:0
    s_waitcnt lgkmcnt(3)
    v_mfma_f32_32x32x16_bf16 v[180:195], a[228:231], v[84:87], v[180:195]
    ds_read_b128 a[244:247], v2 offset:13312
    s_waitcnt lgkmcnt(3)
    v_mfma_f32_32x32x16_bf16 v[196:211], a[232:235], v[84:87], v[196:211]
    ds_read_b128 a[248:251], v2 offset:14336
    s_add_u32 s63, s58, 24576
    buffer_load_dwordx4 a[104:107], v1, s[44:47], s63 offen offset:2048
    s_waitcnt lgkmcnt(3)
    v_mfma_f32_32x32x16_bf16 v[180:195], a[236:239], v[88:91], v[180:195]
    ds_read_b128 a[252:255], v2 offset:15360
    s_waitcnt lgkmcnt(3)
    v_mfma_f32_32x32x16_bf16 v[196:211], a[240:243], v[88:91], v[196:211]
    s_waitcnt vmcnt(34)
    s_barrier
    ds_read_b128 a[224:227], v2 offset:16384
    s_add_u32 s63, s59, 24576
    buffer_load_dwordx4 a[108:111], v1, s[44:47], s63 offen offset:2048
    s_waitcnt lgkmcnt(3)
    v_mfma_f32_32x32x16_bf16 v[180:195], a[244:247], v[92:95], v[180:195]
    ds_read_b128 a[228:231], v2 offset:17408
    s_waitcnt lgkmcnt(3)
    v_mfma_f32_32x32x16_bf16 v[196:211], a[248:251], v[92:95], v[196:211]
    ds_read_b128 a[232:235], v2 offset:18432
    s_add_u32 s63, s58, 36864
    buffer_load_dwordx4 a[152:155], v1, s[44:47], s63 offen offset:2048
    s_waitcnt lgkmcnt(3)
    v_mfma_f32_32x32x16_bf16 v[180:195], a[252:255], v[96:99], v[180:195]
    ds_read_b128 a[236:239], v2 offset:19456
    s_waitcnt lgkmcnt(3)
    v_mfma_f32_32x32x16_bf16 v[196:211], a[224:227], v[96:99], v[196:211]
    ds_read_b128 a[240:243], v2 offset:20480
    s_add_u32 s63, s59, 36864
    buffer_load_dwordx4 a[156:159], v1, s[44:47], s63 offen offset:2048
    s_waitcnt lgkmcnt(3)
    v_mfma_f32_32x32x16_bf16 v[180:195], a[228:231], v[100:103], v[180:195]
    ds_read_b128 a[244:247], v2 offset:21504
    s_waitcnt lgkmcnt(3)
    v_mfma_f32_32x32x16_bf16 v[196:211], a[232:235], v[100:103], v[196:211]
    ds_read_b128 a[248:251], v2 offset:22528
    s_add_u32 s63, s58, 40960
    buffer_load_dwordx4 a[160:163], v1, s[44:47], s63 offen offset:0
    s_waitcnt lgkmcnt(3)
    v_mfma_f32_32x32x16_bf16 v[180:195], a[236:239], v[104:107], v[180:195]
    ds_read_b128 a[252:255], v2 offset:23552
    s_waitcnt lgkmcnt(3)
    v_mfma_f32_32x32x16_bf16 v[196:211], a[240:243], v[104:107], v[196:211]
    ds_read_b128 a[224:227], v2 offset:24576
    s_add_u32 s63, s59, 40960
    buffer_load_dwordx4 a[164:167], v1, s[44:47], s63 offen offset:0
    s_lshl_b32 s15, s48, 6
    s_lshl_b32 s61, s49, 2
    s_add_u32 s15, s15, s61
    s_add_u32 s15, s15, 32768
    s_waitcnt vmcnt(12)
    s_mov_b64 exec, 1
    buffer_store_dword v15, v1, s[44:47], s15 offen sc1
    s_mov_b64 exec, -1
    s_waitcnt lgkmcnt(3)
    v_mfma_f32_32x32x16_bf16 v[180:195], a[244:247], v[108:111], v[180:195]
    ds_read_b128 a[228:231], v2 offset:25600
    s_waitcnt lgkmcnt(3)
    v_mfma_f32_32x32x16_bf16 v[196:211], a[248:251], v[108:111], v[196:211]
    ds_read_b128 a[232:235], v2 offset:26624
    s_add_u32 s63, s58, 53248
    buffer_load_dwordx4 a[208:211], v1, s[44:47], s63 offen offset:0
    s_waitcnt lgkmcnt(3)
    v_mfma_f32_32x32x16_bf16 v[180:195], a[252:255], v[112:115], v[180:195]
    ds_read_b128 a[236:239], v2 offset:27648
    s_waitcnt lgkmcnt(3)
    v_mfma_f32_32x32x16_bf16 v[196:211], a[224:227], v[112:115], v[196:211]
    ds_read_b128 a[240:243], v2 offset:28672
    s_add_u32 s63, s59, 53248
    buffer_load_dwordx4 a[212:215], v1, s[44:47], s63 offen offset:0
    s_waitcnt lgkmcnt(3)
    v_mfma_f32_32x32x16_bf16 v[180:195], a[228:231], v[116:119], v[180:195]
    ds_read_b128 a[244:247], v2 offset:29696
    s_waitcnt lgkmcnt(3)
    v_mfma_f32_32x32x16_bf16 v[196:211], a[232:235], v[116:119], v[196:211]
    ds_read_b128 a[248:251], v2 offset:30720
    s_add_u32 s63, s58, 53248
    buffer_load_dwordx4 a[216:219], v1, s[44:47], s63 offen offset:2048
    s_waitcnt lgkmcnt(3)
    v_mfma_f32_32x32x16_bf16 v[180:195], a[236:239], v[120:123], v[180:195]
    ds_read_b128 a[252:255], v2 offset:31744
    s_waitcnt lgkmcnt(3)
    v_mfma_f32_32x32x16_bf16 v[196:211], a[240:243], v[120:123], v[196:211]
    s_barrier
    ds_read_b128 a[224:227], v2 offset:32768
    s_add_u32 s63, s59, 53248
    buffer_load_dwordx4 a[220:223], v1, s[44:47], s63 offen offset:2048
    s_waitcnt lgkmcnt(3)
    v_mfma_f32_32x32x16_bf16 v[180:195], a[244:247], v[124:127], v[180:195]
    ds_read_b128 a[228:231], v2 offset:33792
    s_waitcnt lgkmcnt(3)
    v_mfma_f32_32x32x16_bf16 v[196:211], a[248:251], v[124:127], v[196:211]
    ds_read_b128 a[232:235], v2 offset:34816
    s_waitcnt lgkmcnt(3)
    v_mfma_f32_32x32x16_bf16 v[180:195], a[252:255], v[128:131], v[180:195]
    ds_read_b128 a[236:239], v2 offset:35840
    s_waitcnt lgkmcnt(3)
    v_mfma_f32_32x32x16_bf16 v[196:211], a[224:227], v[128:131], v[196:211]
    ds_read_b128 a[240:243], v2 offset:36864
    s_waitcnt lgkmcnt(3)
    v_mfma_f32_32x32x16_bf16 v[212:227], a[228:231], v[16:19], 0
    ds_read_b128 a[244:247], v2 offset:37888
    s_waitcnt lgkmcnt(3)
    v_mfma_f32_32x32x16_bf16 v[228:243], a[232:235], v[16:19], 0
    ds_read_b128 a[248:251], v2 offset:38912
    s_nop 1
    v_max_f32 v180, 0, v180
    v_max_f32 v181, 0, v181
    v_max_f32 v182, 0, v182
    s_waitcnt lgkmcnt(3)
    v_mfma_f32_32x32x16_bf16 v[212:227], a[236:239], v[20:23], v[212:227]
    ds_read_b128 a[252:255], v2 offset:39936
    v_max_f32 v183, 0, v183
    v_max_f32 v184, 0, v184
    v_max_f32 v185, 0, v185
    s_waitcnt lgkmcnt(3)
    v_mfma_f32_32x32x16_bf16 v[228:243], a[240:243], v[20:23], v[228:243]
    ds_read_b128 a[224:227], v2 offset:40960
    v_max_f32 v186, 0, v186
    v_max_f32 v187, 0, v187
    v_mul_f32 v180, v180, v188
    s_waitcnt lgkmcnt(3)
    v_mfma_f32_32x32x16_bf16 v[212:227], a[244:247], v[24:27], v[212:227]
    ds_read_b128 a[228:231], v2 offset:41984
    v_mul_f32 v181, v181, v189
    v_mul_f32 v182, v182, v190
    v_mul_f32 v183, v183, v191
    s_waitcnt lgkmcnt(3)
    v_mfma_f32_32x32x16_bf16 v[228:243], a[248:251], v[24:27], v[228:243]
    ds_read_b128 a[232:235], v2 offset:43008
    v_mul_f32 v184, v184, v192
    v_mul_f32 v185, v185, v193
    v_mul_f32 v186, v186, v194
    s_waitcnt lgkmcnt(3)
    v_mfma_f32_32x32x16_bf16 v[212:227], a[252:255], v[28:31], v[212:227]
    ds_read_b128 a[236:239], v2 offset:44032
    v_mul_f32 v187, v187, v195
    v_cvt_pk_bf16_f32 v188, v180, v181
    v_cvt_pk_bf16_f32 v189, v182, v183
    s_waitcnt lgkmcnt(3)
    v_mfma_f32_32x32x16_bf16 v[228:243], a[224:227], v[28:31], v[228:243]
    ds_read_b128 a[240:243], v2 offset:45056
    v_cvt_pk_bf16_f32 v190, v184, v185
    v_cvt_pk_bf16_f32 v191, v186, v187
    buffer_store_dwordx4 v[188:191], v1, s[44:47], s13 offen offset:3072 sc1
    s_waitcnt lgkmcnt(3)
    v_mfma_f32_32x32x16_bf16 v[212:227], a[228:231], v[32:35], v[212:227]
    ds_read_b128 a[244:247], v2 offset:46080
    v_max_f32 v196, 0, v196
    v_max_f32 v197, 0, v197
    v_max_f32 v198, 0, v198
    s_waitcnt lgkmcnt(3)
    v_mfma_f32_32x32x16_bf16 v[228:243], a[232:235], v[32:35], v[228:243]
    ds_read_b128 a[248:251], v2 offset:47104
    v_max_f32 v199, 0, v199
    v_max_f32 v200, 0, v200
    v_max_f32 v201, 0, v201
    s_waitcnt lgkmcnt(3)
    v_mfma_f32_32x32x16_bf16 v[212:227], a[236:239], v[36:39], v[212:227]
    ds_read_b128 a[252:255], v2 offset:48128
    v_max_f32 v202, 0, v202
    v_max_f32 v203, 0, v203
    v_mul_f32 v196, v196, v204
    s_waitcnt lgkmcnt(3)
    v_mfma_f32_32x32x16_bf16 v[228:243], a[240:243], v[36:39], v[228:243]
    s_barrier
    ds_read_b128 a[224:227], v2 offset:49152
    v_mul_f32 v197, v197, v205
    v_mul_f32 v198, v198, v206
    v_mul_f32 v199, v199, v207
    s_waitcnt lgkmcnt(3)
    v_mfma_f32_32x32x16_bf16 v[212:227], a[244:247], v[40:43], v[212:227]
    ds_read_b128 a[228:231], v2 offset:50176
    v_mul_f32 v200, v200, v208
    v_mul_f32 v201, v201, v209
    v_mul_f32 v202, v202, v210
    s_waitcnt lgkmcnt(3)
    v_mfma_f32_32x32x16_bf16 v[228:243], a[248:251], v[40:43], v[228:243]
    ds_read_b128 a[232:235], v2 offset:51200
    v_mul_f32 v203, v203, v211
    v_cvt_pk_bf16_f32 v204, v196, v197
    v_cvt_pk_bf16_f32 v205, v198, v199
    s_waitcnt lgkmcnt(3)
    v_mfma_f32_32x32x16_bf16 v[212:227], a[252:255], v[44:47], v[212:227]
    ds_read_b128 a[236:239], v2 offset:52224
    v_cvt_pk_bf16_f32 v206, v200, v201
    v_cvt_pk_bf16_f32 v207, v202, v203
    buffer_store_dwordx4 v[204:207], v1, s[44:47], s14 offen offset:0 sc1
    s_waitcnt lgkmcnt(3)
    v_mfma_f32_32x32x16_bf16 v[228:243], a[224:227], v[44:47], v[228:243]
    ds_read_b128 a[240:243], v2 offset:53248
    s_waitcnt lgkmcnt(3)
    v_mfma_f32_32x32x16_bf16 v[212:227], a[228:231], v[48:51], v[212:227]
    ds_read_b128 a[244:247], v2 offset:54272
    s_waitcnt lgkmcnt(3)
    v_mfma_f32_32x32x16_bf16 v[228:243], a[232:235], v[48:51], v[228:243]
    ds_read_b128 a[248:251], v2 offset:55296
    s_waitcnt lgkmcnt(3)
    v_mfma_f32_32x32x16_bf16 v[212:227], a[236:239], v[52:55], v[212:227]
    ds_read_b128 a[252:255], v2 offset:56320
    s_waitcnt lgkmcnt(3)
    v_mfma_f32_32x32x16_bf16 v[228:243], a[240:243], v[52:55], v[228:243]
    ds_read_b128 a[224:227], v2 offset:57344
    s_waitcnt lgkmcnt(3)
    v_mfma_f32_32x32x16_bf16 v[212:227], a[244:247], v[56:59], v[212:227]
    ds_read_b128 a[228:231], v2 offset:58368
    s_waitcnt lgkmcnt(3)
    v_mfma_f32_32x32x16_bf16 v[228:243], a[248:251], v[56:59], v[228:243]
    ds_read_b128 a[232:235], v2 offset:59392
    s_waitcnt lgkmcnt(3)
    v_mfma_f32_32x32x16_bf16 v[212:227], a[252:255], v[60:63], v[212:227]
    ds_read_b128 a[236:239], v2 offset:60416
    s_waitcnt lgkmcnt(3)
    v_mfma_f32_32x32x16_bf16 v[228:243], a[224:227], v[60:63], v[228:243]
    ds_read_b128 a[240:243], v2 offset:61440
    s_waitcnt lgkmcnt(3)
    v_mfma_f32_32x32x16_bf16 v[212:227], a[228:231], v[64:67], v[212:227]
    ds_read_b128 a[244:247], v2 offset:62464
    s_waitcnt lgkmcnt(3)
    v_mfma_f32_32x32x16_bf16 v[228:243], a[232:235], v[64:67], v[228:243]
    ds_read_b128 a[248:251], v2 offset:63488
    s_waitcnt lgkmcnt(3)
    v_mfma_f32_32x32x16_bf16 v[212:227], a[236:239], v[68:71], v[212:227]
    ds_read_b128 a[252:255], v2 offset:64512
    s_waitcnt lgkmcnt(3)
    v_mfma_f32_32x32x16_bf16 v[228:243], a[240:243], v[68:71], v[228:243]
    ds_read_b128 a[224:227], v3 offset:0
    s_waitcnt lgkmcnt(3)
    v_mfma_f32_32x32x16_bf16 v[212:227], a[244:247], v[72:75], v[212:227]
    ds_read_b128 a[228:231], v3 offset:1024
    s_waitcnt lgkmcnt(3)
    v_mfma_f32_32x32x16_bf16 v[228:243], a[248:251], v[72:75], v[228:243]
    ds_read_b128 a[232:235], v3 offset:2048
    s_waitcnt lgkmcnt(3)
    v_mfma_f32_32x32x16_bf16 v[212:227], a[252:255], v[76:79], v[212:227]
    ds_read_b128 a[236:239], v3 offset:3072
    s_waitcnt lgkmcnt(3)
    v_mfma_f32_32x32x16_bf16 v[228:243], a[224:227], v[76:79], v[228:243]
    ds_read_b128 a[240:243], v3 offset:4096
    s_waitcnt lgkmcnt(3)
    v_mfma_f32_32x32x16_bf16 v[212:227], a[228:231], v[80:83], v[212:227]
    ds_read_b128 a[244:247], v3 offset:5120
    s_waitcnt lgkmcnt(3)
    v_mfma_f32_32x32x16_bf16 v[228:243], a[232:235], v[80:83], v[228:243]
    ds_read_b128 a[248:251], v3 offset:6144
    s_waitcnt lgkmcnt(3)
    v_mfma_f32_32x32x16_bf16 v[212:227], a[236:239], v[84:87], v[212:227]
    ds_read_b128 a[252:255], v3 offset:7168
    s_waitcnt lgkmcnt(3)
    v_mfma_f32_32x32x16_bf16 v[228:243], a[240:243], v[84:87], v[228:243]
    ds_read_b128 a[224:227], v3 offset:8192
    s_waitcnt lgkmcnt(3)
    v_mfma_f32_32x32x16_bf16 v[212:227], a[244:247], v[88:91], v[212:227]
    ds_read_b128 a[228:231], v3 offset:9216
    s_waitcnt lgkmcnt(3)
    v_mfma_f32_32x32x16_bf16 v[228:243], a[248:251], v[88:91], v[228:243]
    ds_read_b128 a[232:235], v3 offset:10240
    s_waitcnt lgkmcnt(3)
    v_mfma_f32_32x32x16_bf16 v[212:227], a[252:255], v[92:95], v[212:227]
    ds_read_b128 a[236:239], v3 offset:11264
    s_lshl_b32 s15, s48, 6
    s_lshl_b32 s61, s49, 2
    s_add_u32 s15, s15, s61
    s_add_u32 s15, s15, 36864
    s_waitcnt vmcnt(0)
    s_mov_b64 exec, 1
    buffer_store_dword v15, v1, s[44:47], s15 offen sc1
    s_mov_b64 exec, -1
    s_waitcnt lgkmcnt(3)
    v_mfma_f32_32x32x16_bf16 v[228:243], a[224:227], v[92:95], v[228:243]
    ds_read_b128 a[240:243], v3 offset:12288
    s_waitcnt lgkmcnt(3)
    v_mfma_f32_32x32x16_bf16 v[212:227], a[228:231], v[96:99], v[212:227]
    ds_read_b128 a[244:247], v3 offset:13312
    s_waitcnt lgkmcnt(3)
    v_mfma_f32_32x32x16_bf16 v[228:243], a[232:235], v[96:99], v[228:243]
    ds_read_b128 a[248:251], v3 offset:14336
    s_waitcnt lgkmcnt(3)
    v_mfma_f32_32x32x16_bf16 v[212:227], a[236:239], v[100:103], v[212:227]
    ds_read_b128 a[252:255], v3 offset:15360
    s_waitcnt lgkmcnt(3)
    v_mfma_f32_32x32x16_bf16 v[228:243], a[240:243], v[100:103], v[228:243]
    ds_read_b128 a[224:227], v3 offset:16384
    s_waitcnt lgkmcnt(3)
    v_mfma_f32_32x32x16_bf16 v[212:227], a[244:247], v[104:107], v[212:227]
    ds_read_b128 a[228:231], v3 offset:17408
    s_waitcnt lgkmcnt(3)
    v_mfma_f32_32x32x16_bf16 v[228:243], a[248:251], v[104:107], v[228:243]
    ds_read_b128 a[232:235], v3 offset:18432
    s_waitcnt lgkmcnt(3)
    v_mfma_f32_32x32x16_bf16 v[212:227], a[252:255], v[108:111], v[212:227]
    ds_read_b128 a[236:239], v3 offset:19456
    s_waitcnt lgkmcnt(3)
    v_mfma_f32_32x32x16_bf16 v[228:243], a[224:227], v[108:111], v[228:243]
    ds_read_b128 a[240:243], v3 offset:20480
    s_waitcnt lgkmcnt(3)
    v_mfma_f32_32x32x16_bf16 v[212:227], a[228:231], v[112:115], v[212:227]
    ds_read_b128 a[244:247], v3 offset:21504
    s_waitcnt lgkmcnt(3)
    v_mfma_f32_32x32x16_bf16 v[228:243], a[232:235], v[112:115], v[228:243]
    ds_read_b128 a[248:251], v3 offset:22528
    s_mov_b32 s38, 36864
    buffer_load_dword v13, v14, s[44:47], s38 offen sc1
    s_waitcnt lgkmcnt(3)
    v_mfma_f32_32x32x16_bf16 v[212:227], a[236:239], v[116:119], v[212:227]
    ds_read_b128 a[252:255], v3 offset:23552
    s_waitcnt lgkmcnt(3)
    v_mfma_f32_32x32x16_bf16 v[228:243], a[240:243], v[116:119], v[228:243]
    ds_read_b128 a[224:227], v3 offset:24576
    s_waitcnt lgkmcnt(3)
    v_mfma_f32_32x32x16_bf16 v[212:227], a[244:247], v[120:123], v[212:227]
    ds_read_b128 a[228:231], v3 offset:25600
    s_waitcnt lgkmcnt(3)
    v_mfma_f32_32x32x16_bf16 v[228:243], a[248:251], v[120:123], v[228:243]
    ds_read_b128 a[232:235], v3 offset:26624
    s_waitcnt lgkmcnt(3)
    v_mfma_f32_32x32x16_bf16 v[212:227], a[252:255], v[124:127], v[212:227]
    s_waitcnt lgkmcnt(2)
    v_mfma_f32_32x32x16_bf16 v[228:243], a[224:227], v[124:127], v[228:243]
    s_waitcnt lgkmcnt(1)
    v_mfma_f32_32x32x16_bf16 v[212:227], a[228:231], v[128:131], v[212:227]
    s_waitcnt lgkmcnt(0)
    v_mfma_f32_32x32x16_bf16 v[228:243], a[232:235], v[128:131], v[228:243]
    s_cmp_ge_u32 s51, 7
    s_cbranch_scc1 L_S0_nog2
    s_mul_i32 s7, s52, 112*1024
    s_mul_i32 s10, s3, 28*1024
    s_add_u32 s7, s7, s10
    s_add_u32 s7, s7, 11665408
    s_xor_b32 s9, s52, 1
    s_mul_i32 s9, s9, 112*1024
    s_add_u32 s9, s9, s10
    s_add_u32 s9, s9, 11665408
    s_mov_b32 s62, 0
L11_chk:
    s_waitcnt vmcnt(0)
    v_cmp_ne_u32 vcc, s42, v13
    s_add_u32 s62, s62, 1
    s_cmp_lt_u32 s62, 0x20000
    s_cselect_b64 s[64:65], vcc, 0
    s_cmp_eq_u64 s[64:65], 0
    s_cbranch_scc1 L11_ok
    s_sleep 1
    s_mov_b32 s38, 36864
    buffer_load_dword v13, v14, s[44:47], s38 offen sc1
    s_waitcnt vmcnt(0) lgkmcnt(0)
    s_branch L11_chk
L11_ok:
    s_add_u32 s63, s7, 0
    buffer_load_dwordx4 v[100:103], v1, s[44:47], s63 offen offset:0 sc1
    s_add_u32 s63, s9, 0
    buffer_load_dwordx4 v[104:107], v1, s[44:47], s63 offen offset:0 sc1
    s_add_u32 s63, s7, 0
    buffer_load_dwordx4 v[108:111], v1, s[44:47], s63 offen offset:1024 sc1
    s_add_u32 s63, s9, 0
    buffer_load_dwordx4 v[112:115], v1, s[44:47], s63 offen offset:1024 sc1
    s_add_u32 s63, s7, 0
    buffer_load_dwordx4 v[116:119], v1, s[44:47], s63 offen offset:2048 sc1
    s_add_u32 s63, s9, 0
    buffer_load_dwordx4 v[120:123], v1, s[44:47], s63 offen offset:2048 sc1
    v_max_f32 v212, 0, v212
    v_max_f32 v213, 0, v213
    v_max_f32 v214, 0, v214
    v_max_f32 v215, 0, v215
    v_max_f32 v216, 0, v216
    v_max_f32 v217, 0, v217
    v_max_f32 v218, 0, v218
    v_max_f32 v219, 0, v219
    v_mul_f32 v212, v212, v220
    v_mul_f32 v213, v213, v221
    v_mul_f32 v214, v214, v222
    v_mul_f32 v215, v215, v223
    v_mul_f32 v216, v216, v224
    v_mul_f32 v217, v217, v225
    v_mul_f32 v218, v218, v226
    v_mul_f32 v219, v219, v227
    v_cvt_pk_bf16_f32 v220, v212, v213
    v_cvt_pk_bf16_f32 v221, v214, v215
    v_cvt_pk_bf16_f32 v222, v216, v217
    v_cvt_pk_bf16_f32 v223, v218, v219
    buffer_store_dwordx4 v[220:223], v1, s[44:47], s14 offen offset:1024 sc1
    v_max_f32 v228, 0, v228
    v_max_f32 v229, 0, v229
    v_max_f32 v230, 0, v230
    v_max_f32 v231, 0, v231
    v_max_f32 v232, 0, v232
    v_max_f32 v233, 0, v233
    v_max_f32 v234, 0, v234
    v_max_f32 v235, 0, v235
    v_mul_f32 v228, v228, v236
    v_mul_f32 v229, v229, v237
    v_mul_f32 v230, v230, v238
    v_mul_f32 v231, v231, v239
    v_mul_f32 v232, v232, v240
    v_mul_f32 v233, v233, v241
    v_mul_f32 v234, v234, v242
    v_mul_f32 v235, v235, v243
    v_cvt_pk_bf16_f32 v236, v228, v229
    v_cvt_pk_bf16_f32 v237, v230, v231
    v_cvt_pk_bf16_f32 v238, v232, v233
    v_cvt_pk_bf16_f32 v239, v234, v235
    buffer_store_dwordx4 v[236:239], v1, s[44:47], s14 offen offset:2048 sc1
    s_add_u32 s63, s7, 4096
    buffer_load_dwordx4 v[124:127], v1, s[44:47], s63 offen offset:3072 sc1
    s_add_u32 s63, s9, 4096
    buffer_load_dwordx4 v[128:131], v1, s[44:47], s63 offen offset:3072 sc1
    s_waitcnt vmcnt(9)
    v_mfma_f32_32x32x16_bf16 v[16:31], a[0:3], v[100:103], 0
    s_add_u32 s63, s7, 8192
    buffer_load_dwordx4 v[132:135], v1, s[44:47], s63 offen offset:0 sc1
    v_mfma_f32_32x32x16_bf16 v[32:47], a[4:7], v[100:103], 0
    s_add_u32 s63, s9, 8192
    buffer_load_dwordx4 v[136:139], v1, s[44:47], s63 offen offset:0 sc1
    s_waitcnt vmcnt(10)
    v_mfma_f32_32x32x16_bf16 v[48:63], a[0:3], v[104:107], 0
    s_add_u32 s63, s7, 8192
    buffer_load_dwordx4 v[140:143], v1, s[44:47], s63 offen offset:1024 sc1
    v_mfma_f32_32x32x16_bf16 v[64:79], a[4:7], v[104:107], 0
    s_add_u32 s63, s9, 8192
    buffer_load_dwordx4 v[144:147], v1, s[44:47], s63 offen offset:1024 sc1
    s_waitcnt vmcnt(11)
    v_mfma_f32_32x32x16_bf16 v[16:31], a[8:11], v[108:111], v[16:31]
    s_add_u32 s63, s7, 12288
    buffer_load_dwordx4 v[148:151], v1, s[44:47], s63 offen offset:2048 sc1
    v_mfma_f32_32x32x16_bf16 v[32:47], a[12:15], v[108:111], v[32:47]
    s_add_u32 s63, s9, 12288
    buffer_load_dwordx4 v[152:155], v1, s[44:47], s63 offen offset:2048 sc1
    s_waitcnt vmcnt(12)
    v_mfma_f32_32x32x16_bf16 v[48:63], a[8:11], v[112:115], v[48:63]
    s_add_u32 s63, s7, 12288
    buffer_load_dwordx4 v[156:159], v1, s[44:47], s63 offen offset:3072 sc1
    v_mfma_f32_32x32x16_bf16 v[64:79], a[12:15], v[112:115], v[64:79]
    s_add_u32 s63, s9, 12288
    buffer_load_dwordx4 v[160:163], v1, s[44:47], s63 offen offset:3072 sc1
    s_waitcnt vmcnt(13)
    v_mfma_f32_32x32x16_bf16 v[16:31], a[16:19], v[116:119], v[16:31]
    s_add_u32 s63, s7, 16384
    buffer_load_dwordx4 v[164:167], v1, s[44:47], s63 offen offset:0 sc1
    v_mfma_f32_32x32x16_bf16 v[32:47], a[20:23], v[116:119], v[32:47]
    s_add_u32 s63, s9, 16384
    buffer_load_dwordx4 v[168:171], v1, s[44:47], s63 offen offset:0 sc1
    s_waitcnt vmcnt(14)
    v_mfma_f32_32x32x16_bf16 v[48:63], a[16:19], v[120:123], v[48:63]
    s_add_u32 s63, s7, 20480
    buffer_load_dwordx4 v[172:175], v1, s[44:47], s63 offen offset:1024 sc1
    v_mfma_f32_32x32x16_bf16 v[64:79], a[20:23], v[120:123], v[64:79]
    s_add_u32 s63, s9, 20480
    buffer_load_dwordx4 v[176:179], v1, s[44:47], s63 offen offset:1024 sc1
    s_waitcnt vmcnt(13)
    v_mfma_f32_32x32x16_bf16 v[16:31], a[56:59], v[124:127], v[16:31]
    s_add_u32 s63, s7, 20480
    buffer_load_dwordx4 v[180:183], v1, s[44:47], s63 offen offset:2048 sc1
    v_mfma_f32_32x32x16_bf16 v[32:47], a[60:63], v[124:127], v[32:47]
    s_add_u32 s63, s9, 20480
    buffer_load_dwordx4 v[184:187], v1, s[44:47], s63 offen offset:2048 sc1
    s_waitcnt vmcnt(14)
    v_mfma_f32_32x32x16_bf16 v[48:63], a[56:59], v[128:131], v[48:63]
    s_lshl_b32 s15, s48, 6
    s_lshl_b32 s61, s49, 2
    s_add_u32 s15, s15, s61
    s_add_u32 s15, s15, 40960
    s_mov_b64 exec, 1
    buffer_store_dword v15, v1, s[44:47], s15 offen sc1
    s_mov_b64 exec, -1
    s_add_u32 s63, s7, 20480
    buffer_load_dwordx4 v[188:191], v1, s[44:47], s63 offen offset:3072 sc1
    v_mfma_f32_32x32x16_bf16 v[64:79], a[60:63], v[128:131], v[64:79]
    s_add_u32 s63, s9, 20480
    buffer_load_dwordx4 v[192:195], v1, s[44:47], s63 offen offset:3072 sc1
    s_waitcnt vmcnt(16)
    v_mfma_f32_32x32x16_bf16 v[16:31], a[64:67], v[132:135], v[16:31]
    s_add_u32 s63, s7, 0
    buffer_load_dwordx4 v[196:199], v1, s[44:47], s63 offen offset:3072 sc1
    v_mfma_f32_32x32x16_bf16 v[32:47], a[68:71], v[132:135], v[32:47]
    s_add_u32 s63, s9, 0
    buffer_load_dwordx4 v[200:203], v1, s[44:47], s63 offen offset:3072 sc1
    s_waitcnt vmcnt(17)
    v_mfma_f32_32x32x16_bf16 v[48:63], a[64:67], v[136:139], v[48:63]
    s_add_u32 s63, s7, 4096
    buffer_load_dwordx4 v[204:207], v1, s[44:47], s63 offen offset:0 sc1
    v_mfma_f32_32x32x16_bf16 v[64:79], a[68:71], v[136:139], v[64:79]
    s_add_u32 s63, s9, 4096
    buffer_load_dwordx4 v[208:211], v1, s[44:47], s63 offen offset:0 sc1
    s_waitcnt vmcnt(18)
    v_mfma_f32_32x32x16_bf16 v[16:31], a[72:75], v[140:143], v[16:31]
    s_add_u32 s63, s7, 8192
    buffer_load_dwordx4 v[212:215], v1, s[44:47], s63 offen offset:2048 sc1
    v_mfma_f32_32x32x16_bf16 v[32:47], a[76:79], v[140:143], v[32:47]
    s_add_u32 s63, s9, 8192
    buffer_load_dwordx4 v[216:219], v1, s[44:47], s63 offen offset:2048 sc1
    s_waitcnt vmcnt(19)
    v_mfma_f32_32x32x16_bf16 v[48:63], a[72:75], v[144:147], v[48:63]
    s_add_u32 s63, s7, 8192
    buffer_load_dwordx4 v[220:223], v1, s[44:47], s63 offen offset:3072 sc1
    v_mfma_f32_32x32x16_bf16 v[64:79], a[76:79], v[144:147], v[64:79]
    s_add_u32 s63, s9, 8192
    buffer_load_dwordx4 v[224:227], v1, s[44:47], s63 offen offset:3072 sc1
    s_waitcnt vmcnt(20)
    v_mfma_f32_32x32x16_bf16 v[16:31], a[112:115], v[148:151], v[16:31]
    s_add_u32 s63, s7, 16384
    buffer_load_dwordx4 v[228:231], v1, s[44:47], s63 offen offset:1024 sc1
    v_mfma_f32_32x32x16_bf16 v[32:47], a[116:119], v[148:151], v[32:47]
    s_add_u32 s63, s9, 16384
    buffer_load_dwordx4 v[232:235], v1, s[44:47], s63 offen offset:1024 sc1
    s_waitcnt vmcnt(21)
    v_mfma_f32_32x32x16_bf16 v[48:63], a[112:115], v[152:155], v[48:63]
    s_mov_b32 s38, 40960
    buffer_load_dword v13, v14, s[44:47], s38 offen sc1
    v_mfma_f32_32x32x16_bf16 v[64:79], a[116:119], v[152:155], v[64:79]
    s_waitcnt vmcnt(21)
    v_mfma_f32_32x32x16_bf16 v[16:31], a[120:123], v[156:159], v[16:31]
    s_add_u32 s63, s7, 16384
    buffer_load_dwordx4 v[236:239], v1, s[44:47], s63 offen offset:2048 sc1
    v_mfma_f32_32x32x16_bf16 v[32:47], a[124:127], v[156:159], v[32:47]
    s_add_u32 s63, s9, 16384
    buffer_load_dwordx4 v[240:243], v1, s[44:47], s63 offen offset:2048 sc1
    s_waitcnt vmcnt(22)
    v_mfma_f32_32x32x16_bf16 v[48:63], a[120:123], v[160:163], v[48:63]
    v_mfma_f32_32x32x16_bf16 v[64:79], a[124:127], v[160:163], v[64:79]
    s_waitcnt vmcnt(21)
    v_mfma_f32_32x32x16_bf16 v[16:31], a[128:131], v[164:167], v[16:31]
    s_add_u32 s63, s7, 24576
    buffer_load_dwordx4 v[244:247], v1, s[44:47], s63 offen offset:0 sc1
    v_mfma_f32_32x32x16_bf16 v[32:47], a[132:135], v[164:167], v[32:47]
    s_add_u32 s63, s9, 24576
    buffer_load_dwordx4 v[248:251], v1, s[44:47], s63 offen offset:0 sc1
    s_waitcnt vmcnt(22)
    v_mfma_f32_32x32x16_bf16 v[48:63], a[128:131], v[168:171], v[48:63]
    v_mfma_f32_32x32x16_bf16 v[64:79], a[132:135], v[168:171], v[64:79]
    s_waitcnt vmcnt(21)
    v_mfma_f32_32x32x16_bf16 v[16:31], a[168:171], v[172:175], v[16:31]
    s_add_u32 s63, s7, 24576
    buffer_load_dwordx4 v[100:103], v1, s[44:47], s63 offen offset:1024 sc1
    v_mfma_f32_32x32x16_bf16 v[32:47], a[172:175], v[172:175], v[32:47]
    s_add_u32 s63, s9, 24576
    buffer_load_dwordx4 v[104:107], v1, s[44:47], s63 offen offset:1024 sc1
    s_waitcnt vmcnt(22)
    v_mfma_f32_32x32x16_bf16 v[48:63], a[168:171], v[176:179], v[48:63]
    s_mov_b32 s62, 0
L12_chk:
    s_waitcnt vmcnt(6)
    v_cmp_ne_u32 vcc, s42, v13
    s_add_u32 s62, s62, 1
    s_cmp_lt_u32 s62, 0x20000
    s_cselect_b64 s[64:65], vcc, 0
    s_cmp_eq_u64 s[64:65], 0
    s_cbranch_scc1 L12_ok
    s_sleep 1
    s_mov_b32 s38, 40960
    buffer_load_dword v13, v14, s[44:47], s38 offen sc1
    s_waitcnt vmcnt(0) lgkmcnt(0)
    s_branch L12_chk
L12_ok:
    v_mfma_f32_32x32x16_bf16 v[64:79], a[172:175], v[176:179], v[64:79]
    v_mfma_f32_32x32x16_bf16 v[16:31], a[176:179], v[180:183], v[16:31]
    s_add_u32 s63, s7, 4096
    buffer_load_dwordx4 v[108:111], v1, s[44:47], s63 offen offset:1024 sc1
    v_mfma_f32_32x32x16_bf16 v[32:47], a[180:183], v[180:183], v[32:47]
    s_add_u32 s63, s9, 4096
    buffer_load_dwordx4 v[112:115], v1, s[44:47], s63 offen offset:1024 sc1
    v_mfma_f32_32x32x16_bf16 v[48:63], a[176:179], v[184:187], v[48:63]
    v_mfma_f32_32x32x16_bf16 v[64:79], a[180:183], v[184:187], v[64:79]
    v_mfma_f32_32x32x16_bf16 v[16:31], a[184:187], v[188:191], v[16:31]
    s_add_u32 s63, s7, 4096
    buffer_load_dwordx4 v[116:119], v1, s[44:47], s63 offen offset:2048 sc1
    v_mfma_f32_32x32x16_bf16 v[32:47], a[188:191], v[188:191], v[32:47]
    s_add_u32 s63, s9, 4096
    buffer_load_dwordx4 v[120:123], v1, s[44:47], s63 offen offset:2048 sc1
    v_mfma_f32_32x32x16_bf16 v[48:63], a[184:187], v[192:195], v[48:63]
    v_mfma_f32_32x32x16_bf16 v[64:79], a[188:191], v[192:195], v[64:79]
    v_mfma_f32_32x32x16_bf16 v[16:31], a[24:27], v[196:199], v[16:31]
    s_add_u32 s63, s7, 12288
    buffer_load_dwordx4 v[124:127], v1, s[44:47], s63 offen offset:0 sc1
    v_mfma_f32_32x32x16_bf16 v[32:47], a[28:31], v[196:199], v[32:47]
    s_add_u32 s63, s9, 12288
    buffer_load_dwordx4 v[128:131], v1, s[44:47], s63 offen offset:0 sc1
    v_mfma_f32_32x32x16_bf16 v[48:63], a[24:27], v[200:203], v[48:63]
    v_mfma_f32_32x32x16_bf16 v[64:79], a[28:31], v[200:203], v[64:79]
    v_mfma_f32_32x32x16_bf16 v[16:31], a[32:35], v[204:207], v[16:31]
    s_add_u32 s63, s7, 12288
    buffer_load_dwordx4 v[132:135], v1, s[44:47], s63 offen offset:1024 sc1
    v_mfma_f32_32x32x16_bf16 v[32:47], a[36:39], v[204:207], v[32:47]
    s_add_u32 s63, s9, 12288
    buffer_load_dwordx4 v[136:139], v1, s[44:47], s63 offen offset:1024 sc1
    v_mfma_f32_32x32x16_bf16 v[48:63], a[32:35], v[208:211], v[48:63]
    v_mfma_f32_32x32x16_bf16 v[64:79], a[36:39], v[208:211], v[64:79]
    s_barrier
    v_mfma_f32_32x32x16_bf16 v[16:31], a[80:83], v[212:215], v[16:31]
    s_add_u32 s63, s7, 16384
    buffer_load_dwordx4 v[140:143], v1, s[44:47], s63 offen offset:3072 sc1
    v_mfma_f32_32x32x16_bf16 v[32:47], a[84:87], v[212:215], v[32:47]
    s_add_u32 s63, s9, 16384
    buffer_load_dwordx4 v[144:147], v1, s[44:47], s63 offen offset:3072 sc1
    v_mfma_f32_32x32x16_bf16 v[48:63], a[80:83], v[216:219], v[48:63]
    v_mfma_f32_32x32x16_bf16 v[64:79], a[84:87], v[216:219], v[64:79]
    v_mfma_f32_32x32x16_bf16 v[16:31], a[88:91], v[220:223], v[16:31]
    s_add_u32 s63, s7, 20480
    buffer_load_dwordx4 v[148:151], v1, s[44:47], s63 offen offset:0 sc1
    v_mfma_f32_32x32x16_bf16 v[32:47], a[92:95], v[220:223], v[32:47]
    s_add_u32 s63, s9, 20480
    buffer_load_dwordx4 v[152:155], v1, s[44:47], s63 offen offset:0 sc1
    v_mfma_f32_32x32x16_bf16 v[48:63], a[88:91], v[224:227], v[48:63]
    v_mfma_f32_32x32x16_bf16 v[64:79], a[92:95], v[224:227], v[64:79]
    v_mfma_f32_32x32x16_bf16 v[16:31], a[136:139], v[228:231], v[16:31]
    s_add_u32 s63, s7, 24576
    buffer_load_dwordx4 v[156:159], v1, s[44:47], s63 offen offset:2048 sc1
    v_mfma_f32_32x32x16_bf16 v[32:47], a[140:143], v[228:231], v[32:47]
    s_add_u32 s63, s9, 24576
    buffer_load_dwordx4 v[160:163], v1, s[44:47], s63 offen offset:2048 sc1
    v_mfma_f32_32x32x16_bf16 v[48:63], a[136:139], v[232:235], v[48:63]
    v_mfma_f32_32x32x16_bf16 v[64:79], a[140:143], v[232:235], v[64:79]
    s_waitcnt vmcnt(19)
    v_mfma_f32_32x32x16_bf16 v[16:31], a[144:147], v[236:239], v[16:31]
    s_add_u32 s63, s7, 24576
    buffer_load_dwordx4 v[164:167], v1, s[44:47], s63 offen offset:3072 sc1
    v_mfma_f32_32x32x16_bf16 v[32:47], a[148:151], v[236:239], v[32:47]
    s_add_u32 s63, s9, 24576
    buffer_load_dwordx4 v[168:171], v1, s[44:47], s63 offen offset:3072 sc1
    s_waitcnt vmcnt(20)
    v_mfma_f32_32x32x16_bf16 v[48:63], a[144:147], v[240:243], v[48:63]
    v_mfma_f32_32x32x16_bf16 v[64:79], a[148:151], v[240:243], v[64:79]
    s_waitcnt vmcnt(19)
    v_mfma_f32_32x32x16_bf16 v[16:31], a[192:195], v[244:247], v[16:31]
    s_add_u32 s10, s54, 4849664
    buffer_load_dwordx4 v[80:83], v12, s[44:47], s10 offen sc1
    buffer_load_dwordx4 v[84:87], v12, s[44:47], s10 offen offset:256 sc1
    v_lshrrev_b32 v6, 1, v8
    s_lshl_b32 s15, s52, 7
    s_add_u32 s15, s15, 65536
    buffer_load_dword v96, v6, s[44:47], s15 offen sc1
    s_add_u32 s10, s54, 19005440
    buffer_load_dwordx4 v[88:91], v12, s[44:47], s10 offen sc1
    buffer_load_dwordx4 v[92:95], v12, s[44:47], s10 offen offset:256 sc1
    v_mfma_f32_32x32x16_bf16 v[32:47], a[196:199], v[244:247], v[32:47]
    s_waitcnt vmcnt(23)
    v_mfma_f32_32x32x16_bf16 v[48:63], a[192:195], v[248:251], v[48:63]
    v_mfma_f32_32x32x16_bf16 v[64:79], a[196:199], v[248:251], v[64:79]
    s_waitcnt vmcnt(22)
    v_mfma_f32_32x32x16_bf16 v[16:31], a[200:203], v[100:103], v[16:31]
    v_mfma_f32_32x32x16_bf16 v[32:47], a[204:207], v[100:103], v[32:47]
    s_waitcnt vmcnt(21)
    v_mfma_f32_32x32x16_bf16 v[48:63], a[200:203], v[104:107], v[48:63]
    v_mfma_f32_32x32x16_bf16 v[64:79], a[204:207], v[104:107], v[64:79]
    s_waitcnt vmcnt(20)
    v_mfma_f32_32x32x16_bf16 v[16:31], a[40:43], v[108:111], v[16:31]
    v_mfma_f32_32x32x16_bf16 v[32:47], a[44:47], v[108:111], v[32:47]
    s_waitcnt vmcnt(19)
    v_mfma_f32_32x32x16_bf16 v[48:63], a[40:43], v[112:115], v[48:63]
    v_mfma_f32_32x32x16_bf16 v[64:79], a[44:47], v[112:115], v[64:79]
    s_waitcnt vmcnt(18)
    v_mfma_f32_32x32x16_bf16 v[16:31], a[48:51], v[116:119], v[16:31]
    v_mfma_f32_32x32x16_bf16 v[32:47], a[52:55], v[116:119], v[32:47]
    s_waitcnt vmcnt(17)
    v_mfma_f32_32x32x16_bf16 v[48:63], a[48:51], v[120:123], v[48:63]
    v_mfma_f32_32x32x16_bf16 v[64:79], a[52:55], v[120:123], v[64:79]
    s_waitcnt vmcnt(16)
    v_mfma_f32_32x32x16_bf16 v[16:31], a[96:99], v[124:127], v[16:31]
    v_mfma_f32_32x32x16_bf16 v[32:47], a[100:103], v[124:127], v[32:47]
    s_waitcnt vmcnt(15)
    v_mfma_f32_32x32x16_bf16 v[48:63], a[96:99], v[128:131], v[48:63]
    v_mfma_f32_32x32x16_bf16 v[64:79], a[100:103], v[128:131], v[64:79]
    s_waitcnt vmcnt(14)
    v_mfma_f32_32x32x16_bf16 v[16:31], a[104:107], v[132:135], v[16:31]
    v_mfma_f32_32x32x16_bf16 v[32:47], a[108:111], v[132:135], v[32:47]
    s_waitcnt vmcnt(13)
    v_mfma_f32_32x32x16_bf16 v[48:63], a[104:107], v[136:139], v[48:63]
    v_mfma_f32_32x32x16_bf16 v[64:79], a[108:111], v[136:139], v[64:79]
    s_waitcnt vmcnt(12)
    v_mfma_f32_32x32x16_bf16 v[16:31], a[152:155], v[140:143], v[16:31]
    v_mfma_f32_32x32x16_bf16 v[32:47], a[156:159], v[140:143], v[32:47]
    s_waitcnt vmcnt(11)
    v_mfma_f32_32x32x16_bf16 v[48:63], a[152:155], v[144:147], v[48:63]
    v_mfma_f32_32x32x16_bf16 v[64:79], a[156:159], v[144:147], v[64:79]
    s_waitcnt vmcnt(10)
    v_mfma_f32_32x32x16_bf16 v[32:47], a[164:167], v[148:151], v[32:47]
    s_waitcnt vmcnt(9)
    v_mfma_f32_32x32x16_bf16 v[48:63], a[160:163], v[152:155], v[48:63]
    v_mfma_f32_32x32x16_bf16 v[64:79], a[164:167], v[152:155], v[64:79]
    s_waitcnt vmcnt(8)
    v_mfma_f32_32x32x16_bf16 v[32:47], a[212:215], v[156:159], v[32:47]
    s_waitcnt vmcnt(7)
    v_mfma_f32_32x32x16_bf16 v[48:63], a[208:211], v[160:163], v[48:63]
    v_mfma_f32_32x32x16_bf16 v[64:79], a[212:215], v[160:163], v[64:79]
    s_waitcnt vmcnt(6)
    v_mfma_f32_32x32x16_bf16 v[32:47], a[220:223], v[164:167], v[32:47]
    s_waitcnt vmcnt(5)
    v_mfma_f32_32x32x16_bf16 v[48:63], a[216:219], v[168:171], v[48:63]
    v_mfma_f32_32x32x16_bf16 v[64:79], a[220:223], v[168:171], v[64:79]
    s_xor_b32 s10, s3, 1
    s_mul_i32 s10, s10, 12288
    s_add_u32 s10, s10, 114688
    v_add_u32 v4, s10, v1
    s_xor_b32 s10, s3, 2
    s_mul_i32 s10, s10, 12288
    s_add_u32 s10, s10, 118784
    v_add_u32 v5, s10, v1
    s_xor_b32 s10, s3, 3
    s_mul_i32 s10, s10, 12288
    s_add_u32 s10, s10, 122880
    v_add_u32 v6, s10, v1
    v_mfma_f32_32x32x16_bf16 v[16:31], a[160:163], v[148:151], v[16:31]
    ds_write_b128 v4, v[32:35] offset:0
    ds_write_b128 v4, v[36:39] offset:1024
    ds_write_b128 v4, v[40:43] offset:2048
    ds_write_b128 v4, v[44:47] offset:3072
    v_mfma_f32_32x32x16_bf16 v[16:31], a[208:211], v[156:159], v[16:31]
    ds_write_b128 v5, v[48:51] offset:0
    ds_write_b128 v5, v[52:55] offset:1024
    ds_write_b128 v5, v[56:59] offset:2048
    ds_write_b128 v5, v[60:63] offset:3072
    v_mfma_f32_32x32x16_bf16 v[16:31], a[216:219], v[164:167], v[16:31]
    ds_write_b128 v6, v[64:67] offset:0
    ds_write_b128 v6, v[68:71] offset:1024
    ds_write_b128 v6, v[72:75] offset:2048
    ds_write_b128 v6, v[76:79] offset:3072
    s_mul_i32 s10, s3, 12288
    s_add_u32 s10, s10, 114688
    v_add_u32 v7, s10, v1
    s_waitcnt lgkmcnt(0)
    s_barrier
    ds_read_b128 v[100:103], v7 offset:0
    ds_read_b128 v[104:107], v7 offset:1024
    ds_read_b128 v[108:111], v7 offset:2048
    ds_read_b128 v[112:115], v7 offset:3072
    ds_read_b128 v[116:119], v7 offset:4096
    ds_read_b128 v[120:123], v7 offset:5120
    ds_read_b128 v[124:127], v7 offset:6144
    ds_read_b128 v[128:131], v7 offset:7168
    ds_read_b128 v[132:135], v7 offset:8192
    ds_read_b128 v[136:139], v7 offset:9216
    ds_read_b128 v[140:143], v7 offset:10240
    ds_read_b128 v[144:147], v7 offset:11264
    s_waitcnt vmcnt(4)
    v_lshlrev_b32 v32, 16, v80
    v_and_b32 v33, s57, v80
    v_lshlrev_b32 v34, 16, v81
    v_and_b32 v35, s57, v81
    v_lshlrev_b32 v36, 16, v82
    v_and_b32 v37, s57, v82
    v_lshlrev_b32 v38, 16, v83
    v_and_b32 v39, s57, v83
    s_waitcnt vmcnt(3)
    v_lshlrev_b32 v40, 16, v84
    v_and_b32 v41, s57, v84
    v_lshlrev_b32 v42, 16, v85
    v_and_b32 v43, s57, v85
    v_lshlrev_b32 v44, 16, v86
    v_and_b32 v45, s57, v86
    v_lshlrev_b32 v46, 16, v87
    v_and_b32 v47, s57, v87
    s_waitcnt lgkmcnt(11)
    v_pk_add_f32 v[16:17], v[16:17], v[100:101]
    v_pk_add_f32 v[18:19], v[18:19], v[102:103]
    s_waitcnt lgkmcnt(10)
    v_pk_add_f32 v[20:21], v[20:21], v[104:105]
    v_pk_add_f32 v[22:23], v[22:23], v[106:107]
    s_waitcnt lgkmcnt(9)
    v_pk_add_f32 v[24:25], v[24:25], v[108:109]
    v_pk_add_f32 v[26:27], v[26:27], v[110:111]
    s_waitcnt lgkmcnt(8)
    v_pk_add_f32 v[28:29], v[28:29], v[112:113]
    v_pk_add_f32 v[30:31], v[30:31], v[114:115]
    s_waitcnt lgkmcnt(7)
    v_pk_add_f32 v[16:17], v[16:17], v[116:117]
    v_pk_add_f32 v[18:19], v[18:19], v[118:119]
    s_waitcnt lgkmcnt(6)
    v_pk_add_f32 v[20:21], v[20:21], v[120:121]
    v_pk_add_f32 v[22:23], v[22:23], v[122:123]
    s_waitcnt lgkmcnt(5)
    v_pk_add_f32 v[24:25], v[24:25], v[124:125]
    v_pk_add_f32 v[26:27], v[26:27], v[126:127]
    s_waitcnt lgkmcnt(4)
    v_pk_add_f32 v[28:29], v[28:29], v[128:129]
    v_pk_add_f32 v[30:31], v[30:31], v[130:131]
    s_waitcnt lgkmcnt(3)
    v_pk_add_f32 v[16:17], v[16:17], v[132:133]
    v_pk_add_f32 v[18:19], v[18:19], v[134:135]
    s_waitcnt lgkmcnt(2)
    v_pk_add_f32 v[20:21], v[20:21], v[136:137]
    v_pk_add_f32 v[22:23], v[22:23], v[138:139]
    s_waitcnt lgkmcnt(1)
    v_pk_add_f32 v[24:25], v[24:25], v[140:141]
    v_pk_add_f32 v[26:27], v[26:27], v[142:143]
    s_waitcnt lgkmcnt(0)
    v_pk_add_f32 v[28:29], v[28:29], v[144:145]
    v_pk_add_f32 v[30:31], v[30:31], v[146:147]
    s_waitcnt vmcnt(2)
    v_fmac_f32 v32, v96, v16
    v_fmac_f32 v33, v96, v17
    v_fmac_f32 v34, v96, v18
    v_fmac_f32 v35, v96, v19
    v_fmac_f32 v36, v96, v20
    v_fmac_f32 v37, v96, v21
    v_fmac_f32 v38, v96, v22
    v_fmac_f32 v39, v96, v23
    v_fmac_f32 v40, v96, v24
    v_fmac_f32 v41, v96, v25
    v_fmac_f32 v42, v96, v26
    v_fmac_f32 v43, v96, v27
    v_fmac_f32 v44, v96, v28
    v_fmac_f32 v45, v96, v29
    v_fmac_f32 v46, v96, v30
    v_fmac_f32 v47, v96, v31
    v_cvt_pk_bf16_f32 v80, v32, v33
    v_cvt_pk_bf16_f32 v81, v34, v35
    v_cvt_pk_bf16_f32 v82, v36, v37
    v_cvt_pk_bf16_f32 v83, v38, v39
    v_cvt_pk_bf16_f32 v84, v40, v41
    v_cvt_pk_bf16_f32 v85, v42, v43
    v_cvt_pk_bf16_f32 v86, v44, v45
    v_cvt_pk_bf16_f32 v87, v46, v47
    s_mul_i32 s10, s52, 14*512
    s_add_u32 s10, s10, 655360
    s_lshl_b32 s15, s53, 9
    s_add_u32 s15, s15, s10
    v_mov_b32 v4, 0
    v_mov_b32 v5, 0
    v_dot2c_f32_bf16 v4, s56, v80
    v_dot2c_f32_bf16 v5, v80, v80
    v_dot2c_f32_bf16 v4, s56, v81
    v_dot2c_f32_bf16 v5, v81, v81
    v_dot2c_f32_bf16 v4, s56, v82
    v_dot2c_f32_bf16 v5, v82, v82
    v_dot2c_f32_bf16 v4, s56, v83
    v_dot2c_f32_bf16 v5, v83, v83
    v_dot2c_f32_bf16 v4, s56, v84
    v_dot2c_f32_bf16 v5, v84, v84
    v_dot2c_f32_bf16 v4, s56, v85
    v_dot2c_f32_bf16 v5, v85, v85
    v_dot2c_f32_bf16 v4, s56, v86
    v_dot2c_f32_bf16 v5, v86, v86
    v_dot2c_f32_bf16 v4, s56, v87
    v_dot2c_f32_bf16 v5, v87, v87
    s_nop 1
    v_mov_b32 v6, v4
    s_nop 1
    v_permlane32_swap_b32 v4, v6
    v_add_f32 v4, v4, v6
    v_mov_b32 v6, v5
    s_nop 1
    v_permlane32_swap_b32 v5, v6
    v_add_f32 v5, v5, v6
    v_mov_b32 v6, v15
    v_lshlrev_b32 v10, 1, v8
    v_lshrrev_b32 v11, 5, v0
    v_mul_u32_u24 v11, 3584, v11
    v_add_u32 v11, v11, v10
    buffer_store_dwordx3 v[4:6], v10, s[44:47], s15 offen sc1
    v_lshlrev_b32 v32, 16, v80
    v_and_b32 v33, s57, v80
    s_waitcnt vmcnt(2)
    v_lshlrev_b32 v48, 16, v88
    v_and_b32 v49, s57, v88
    v_lshlrev_b32 v34, 16, v81
    v_and_b32 v35, s57, v81
    v_lshlrev_b32 v50, 16, v89
    v_and_b32 v51, s57, v89
    v_lshlrev_b32 v36, 16, v82
    v_and_b32 v37, s57, v82
    v_lshlrev_b32 v52, 16, v90
    v_and_b32 v53, s57, v90
    v_lshlrev_b32 v38, 16, v83
    v_and_b32 v39, s57, v83
    v_lshlrev_b32 v54, 16, v91
    v_and_b32 v55, s57, v91
    v_lshlrev_b32 v40, 16, v84
    v_and_b32 v41, s57, v84
    s_waitcnt vmcnt(1)
    v_lshlrev_b32 v56, 16, v92
    v_and_b32 v57, s57, v92
    v_lshlrev_b32 v42, 16, v85
    v_and_b32 v43, s57, v85
    v_lshlrev_b32 v58, 16, v93
    v_and_b32 v59, s57, v93
    v_lshlrev_b32 v44, 16, v86
    v_and_b32 v45, s57, v86
    v_lshlrev_b32 v60, 16, v94
    v_and_b32 v61, s57, v94
    v_lshlrev_b32 v46, 16, v87
    v_and_b32 v47, s57, v87
    v_lshlrev_b32 v62, 16, v95
    v_and_b32 v63, s57, v95
    buffer_load_dwordx3 v[100:102], v11, s[44:47], s10 offen offset:0 sc1
    buffer_load_dwordx3 v[104:106], v11, s[44:47], s10 offen offset:512 sc1
    buffer_load_dwordx3 v[108:110], v11, s[44:47], s10 offen offset:1024 sc1
    buffer_load_dwordx3 v[112:114], v11, s[44:47], s10 offen offset:1536 sc1
    buffer_load_dwordx3 v[116:118], v11, s[44:47], s10 offen offset:2048 sc1
    buffer_load_dwordx3 v[120:122], v11, s[44:47], s10 offen offset:2560 sc1
    buffer_load_dwordx3 v[124:126], v11, s[44:47], s10 offen offset:3072 sc1
    s_mov_b32 s62, 0
L13_chk:
    s_waitcnt vmcnt(6)
    v_xor_b32 v6, s42, v102
    s_waitcnt vmcnt(5)
    v_xor_b32 v7, s42, v106
    v_or_b32 v6, v6, v7
    s_waitcnt vmcnt(4)
    v_xor_b32 v7, s42, v110
    v_or_b32 v6, v6, v7
    s_waitcnt vmcnt(3)
    v_xor_b32 v7, s42, v114
    v_or_b32 v6, v6, v7
    s_waitcnt vmcnt(2)
    v_xor_b32 v7, s42, v118
    v_or_b32 v6, v6, v7
    s_waitcnt vmcnt(1)
    v_xor_b32 v7, s42, v122
    v_or_b32 v6, v6, v7
    s_waitcnt vmcnt(0)
    v_xor_b32 v7, s42, v126
    v_or_b32 v6, v6, v7
    v_cmp_ne_u32 vcc, 0, v6
    s_add_u32 s62, s62, 1
    s_cmp_lt_u32 s62, 0x20000
    s_cselect_b64 s[64:65], vcc, 0
    s_cmp_eq_u64 s[64:65], 0
    s_cbranch_scc1 L13_ok
    s_sleep 1
    buffer_load_dwordx3 v[100:102], v11, s[44:47], s10 offen offset:0 sc1
    buffer_load_dwordx3 v[104:106], v11, s[44:47], s10 offen offset:512 sc1
    buffer_load_dwordx3 v[108:110], v11, s[44:47], s10 offen offset:1024 sc1
    buffer_load_dwordx3 v[112:114], v11, s[44:47], s10 offen offset:1536 sc1
    buffer_load_dwordx3 v[116:118], v11, s[44:47], s10 offen offset:2048 sc1
    buffer_load_dwordx3 v[120:122], v11, s[44:47], s10 offen offset:2560 sc1
    buffer_load_dwordx3 v[124:126], v11, s[44:47], s10 offen offset:3072 sc1
    s_waitcnt vmcnt(0) lgkmcnt(0)
    s_branch L13_chk
L13_ok:
    v_add_f32 v100, v100, v104
    v_add_f32 v101, v101, v105
    v_add_f32 v100, v100, v108
    v_add_f32 v101, v101, v109
    v_add_f32 v100, v100, v112
    v_add_f32 v101, v101, v113
    v_add_f32 v100, v100, v116
    v_add_f32 v101, v101, v117
    v_add_f32 v100, v100, v120
    v_add_f32 v101, v101, v121
    v_add_f32 v100, v100, v124
    v_add_f32 v101, v101, v125
    v_mov_b32 v6, v100
    s_nop 1
    v_permlane32_swap_b32 v100, v6
    v_add_f32 v100, v100, v6
    v_mov_b32 v6, v101
    s_nop 1
    v_permlane32_swap_b32 v101, v6
    v_add_f32 v101, v101, v6
    v_mul_f32 v6, 0x3b124925, v100
    v_mul_f32 v7, 0x3b124925, v101
    v_fma_f32 v7, -v6, v6, v7
    v_max_f32 v7, 0, v7
    v_add_f32 v7, 0x3727c5ac, v7
    v_rsq_f32 v7, v7
    s_nop 0
    v_mul_f32 v6, v6, v7
    v_fma_f32 v16, v32, v7, -v6
    v_fmac_f32 v32, v16, v48
    v_fma_f32 v17, v33, v7, -v6
    v_fmac_f32 v33, v17, v49
    v_fma_f32 v18, v34, v7, -v6
    v_fmac_f32 v34, v18, v50
    v_fma_f32 v19, v35, v7, -v6
    v_fmac_f32 v35, v19, v51
    v_fma_f32 v20, v36, v7, -v6
    v_fmac_f32 v36, v20, v52
    v_fma_f32 v21, v37, v7, -v6
    v_fmac_f32 v37, v21, v53
    v_fma_f32 v22, v38, v7, -v6
    v_fmac_f32 v38, v22, v54
    v_fma_f32 v23, v39, v7, -v6
    v_fmac_f32 v39, v23, v55
    v_fma_f32 v24, v40, v7, -v6
    v_fmac_f32 v40, v24, v56
    v_fma_f32 v25, v41, v7, -v6
    v_fmac_f32 v41, v25, v57
    v_fma_f32 v26, v42, v7, -v6
    v_fmac_f32 v42, v26, v58
    v_fma_f32 v27, v43, v7, -v6
    v_fmac_f32 v43, v27, v59
    v_fma_f32 v28, v44, v7, -v6
    v_fmac_f32 v44, v28, v60
    v_fma_f32 v29, v45, v7, -v6
    v_fmac_f32 v45, v29, v61
    v_fma_f32 v30, v46, v7, -v6
    v_fmac_f32 v46, v30, v62
    v_fma_f32 v31, v47, v7, -v6
    v_fmac_f32 v47, v31, v63
    v_cvt_pk_bf16_f32 v80, v32, v33
    v_cvt_pk_bf16_f32 v81, v34, v35
    v_cvt_pk_bf16_f32 v82, v36, v37
    v_cvt_pk_bf16_f32 v83, v38, v39
    v_cvt_pk_bf16_f32 v84, v40, v41
    v_cvt_pk_bf16_f32 v85, v42, v43
    v_cvt_pk_bf16_f32 v86, v44, v45
    v_cvt_pk_bf16_f32 v87, v46, v47
    s_add_u32 s10, s54, 4849664
    buffer_store_dwordx4 v[80:83], v12, s[44:47], s10 offen sc1
    buffer_store_dwordx4 v[84:87], v12, s[44:47], s10 offen offset:256 sc1
    v_mov_b32 v4, 0
    v_mov_b32 v5, 0
    v_dot2c_f32_bf16 v4, s56, v80
    v_dot2c_f32_bf16 v5, v80, v80
    v_dot2c_f32_bf16 v4, s56, v81
    v_dot2c_f32_bf16 v5, v81, v81
    v_dot2c_f32_bf16 v4, s56, v82
    v_dot2c_f32_bf16 v5, v82, v82
    v_dot2c_f32_bf16 v4, s56, v83
    v_dot2c_f32_bf16 v5, v83, v83
    v_dot2c_f32_bf16 v4, s56, v84
    v_dot2c_f32_bf16 v5, v84, v84
    v_dot2c_f32_bf16 v4, s56, v85
    v_dot2c_f32_bf16 v5, v85, v85
    v_dot2c_f32_bf16 v4, s56, v86
    v_dot2c_f32_bf16 v5, v86, v86
    v_dot2c_f32_bf16 v4, s56, v87
    v_dot2c_f32_bf16 v5, v87, v87
    s_nop 1
    v_mov_b32 v6, v4
    s_nop 1
    v_permlane32_swap_b32 v4, v6
    v_add_f32 v4, v4, v6
    v_mov_b32 v6, v5
    s_nop 1
    v_permlane32_swap_b32 v5, v6
    v_add_f32 v5, v5, v6
    s_lshl_b32 s10, s52, 12
    s_lshl_b32 s15, s53, 6
    s_add_u32 s15, s15, s10
    s_add_u32 s15, s15, 131072
    s_mov_b32 exec_hi, 0
    buffer_store_dwordx2 v[4:5], v9, s[44:47], s15 offen sc1
    s_mov_b32 exec_hi, -1
    s_lshl_b32 s15, s52, 6
    s_lshl_b32 s10, s53, 2
    s_add_u32 s15, s15, s10
    s_add_u32 s15, s15, 24576
    s_waitcnt vmcnt(0)
    s_mov_b64 exec, 1
    buffer_store_dword v15, v1, s[44:47], s15 offen sc1
    s_mov_b64 exec, -1
    s_nop 0
    s_branch L_S0_join
L_S0_nog2:
    s_nop 7
    v_max_f32 v212, 0, v212
    v_max_f32 v213, 0, v213
    v_max_f32 v214, 0, v214
    v_max_f32 v215, 0, v215
    v_max_f32 v216, 0, v216
    v_max_f32 v217, 0, v217
    v_max_f32 v218, 0, v218
    v_max_f32 v219, 0, v219
    v_mul_f32 v212, v212, v220
    v_mul_f32 v213, v213, v221
    v_mul_f32 v214, v214, v222
    v_mul_f32 v215, v215, v223
    v_mul_f32 v216, v216, v224
    v_mul_f32 v217, v217, v225
    v_mul_f32 v218, v218, v226
    v_mul_f32 v219, v219, v227
    v_cvt_pk_bf16_f32 v220, v212, v213
    v_cvt_pk_bf16_f32 v221, v214, v215
    v_cvt_pk_bf16_f32 v222, v216, v217
    v_cvt_pk_bf16_f32 v223, v218, v219
    buffer_store_dwordx4 v[220:223], v1, s[44:47], s14 offen offset:1024 sc1
    v_max_f32 v228, 0, v228
    v_max_f32 v229, 0, v229
    v_max_f32 v230, 0, v230
    v_max_f32 v231, 0, v231
    v_max_f32 v232, 0, v232
    v_max_f32 v233, 0, v233
    v_max_f32 v234, 0, v234
    v_max_f32 v235, 0, v235
    v_mul_f32 v228, v228, v236
    v_mul_f32 v229, v229, v237
    v_mul_f32 v230, v230, v238
    v_mul_f32 v231, v231, v239
    v_mul_f32 v232, v232, v240
    v_mul_f32 v233, v233, v241
    v_mul_f32 v234, v234, v242
    v_mul_f32 v235, v235, v243
    v_cvt_pk_bf16_f32 v236, v228, v229
    v_cvt_pk_bf16_f32 v237, v230, v231
    v_cvt_pk_bf16_f32 v238, v232, v233
    v_cvt_pk_bf16_f32 v239, v234, v235
    buffer_store_dwordx4 v[236:239], v1, s[44:47], s14 offen offset:2048 sc1
    s_lshl_b32 s15, s48, 6
    s_lshl_b32 s61, s49, 2
    s_add_u32 s15, s15, s61
    s_add_u32 s15, s15, 40960
    s_waitcnt vmcnt(0)
    s_mov_b64 exec, 1
    buffer_store_dword v15, v1, s[44:47], s15 offen sc1
    s_mov_b64 exec, -1
    s_and_b32 s10, s66, 1
    s_lshl_b32 s10, s10, 1
    s_add_u32 s10, s10, s49
    s_sub_u32 s10, s10, 14
    s_lshl_b32 s10, s10, 2
    s_add_u32 s10, s10, s3
    s_mul_i32 s10, s10, 207872
    s_add_u32 s10, s10, 8323072
    v_lshlrev_b32 v6, 7, v0
    buffer_load_dword v100, v6, s[44:47], s10 offen
    s_add_u32 s10, s10, 8192
    buffer_load_dword v101, v6, s[44:47], s10 offen
    s_add_u32 s10, s10, 8192
    buffer_load_dword v102, v6, s[44:47], s10 offen
    s_add_u32 s10, s10, 8192
    buffer_load_dword v103, v6, s[44:47], s10 offen
    s_add_u32 s10, s10, 8192
    buffer_load_dword v104, v6, s[44:47], s10 offen
    s_add_u32 s10, s10, 8192
    buffer_load_dword v105, v6, s[44:47], s10 offen
    s_add_u32 s10, s10, 122880
    buffer_load_dword v106, v6, s[44:47], s10 offen
    s_add_u32 s10, s10, 8192
    buffer_load_dword v107, v6, s[44:47], s10 offen
    s_add_u32 s10, s10, 8192
    buffer_load_dword v108, v6, s[44:47], s10 offen
    s_add_u32 s10, s10, 8192
    buffer_load_dword v109, v6, s[44:47], s10 offen
    s_add_u32 s10, s10, 8192
    buffer_load_dword v110, v6, s[44:47], s10 offen
    s_add_u32 s10, s10, 8192
    buffer_load_dword v111, v6, s[44:47], s10 offen
    s_add_u32 s10, s10, 8192
    s_waitcnt vmcnt(0) lgkmcnt(0)
L_S0_join:
    s_mul_i32 s7, s48, 28672
    s_add_u32 s7, s7, 4849664
    s_lshl_b32 s60, s48, 12
    s_add_u32 s60, s60, 131072
    s_barrier
    s_add_u32 s10, s55, 114688
    s_mov_b32 m0, s10
    s_add_u32 s11, s8, 0
    buffer_load_dwordx4 v1, s[44:47], s11 offen offset:0 lds
    buffer_load_dwordx4 v1, s[44:47], s11 offen offset:1024 lds
    buffer_load_dwordx4 v1, s[44:47], s11 offen offset:2048 lds
    buffer_load_dwordx4 v1, s[44:47], s11 offen offset:3072 lds
    s_add_u32 s10, s55, 131072
    s_mov_b32 m0, s10
    s_add_u32 s11, s8, 16384
    buffer_load_dwordx4 v1, s[44:47], s11 offen offset:0 lds
    buffer_load_dwordx4 v1, s[44:47], s11 offen offset:1024 lds
    buffer_load_dwordx4 v1, s[44:47], s11 offen offset:2048 lds
    buffer_load_dwordx4 v1, s[44:47], s11 offen offset:3072 lds
    s_add_u32 s10, s55, 147456
    s_mov_b32 m0, s10
    s_add_u32 s11, s8, 32768
    buffer_load_dwordx4 v1, s[44:47], s11 offen offset:0 lds
    buffer_load_dwordx4 v1, s[44:47], s11 offen offset:1024 lds
    buffer_load_dwordx4 v1, s[44:47], s11 offen offset:2048 lds
    buffer_load_dwordx4 v1, s[44:47], s11 offen offset:3072 lds
    v_min_u32 v7, 13, v0
    v_lshlrev_b32 v7, 2, v7
    s_lshl_b32 s38, s48, 6
    s_add_u32 s38, s38, 24576
    buffer_load_dword v6, v7, s[44:47], s38 offen sc1
    s_mov_b32 s62, 0
L14_chk:
    s_waitcnt vmcnt(0)
    v_cmp_ne_u32 vcc, s42, v6
    s_add_u32 s62, s62, 1
    s_cmp_lt_u32 s62, 0x20000
    s_cselect_b64 s[64:65], vcc, 0
    s_cmp_eq_u64 s[64:65], 0
    s_cbranch_scc1 L14_ok
    s_sleep 1
    buffer_load_dword v6, v7, s[44:47], s38 offen sc1
    s_waitcnt vmcnt(0) lgkmcnt(0)
    s_branch L14_chk
L14_ok:
    buffer_load_dwordx4 v[16:19], v12, s[44:47], s7 offen offset:0 sc1
    buffer_load_dwordx4 v[20:23], v12, s[44:47], s7 offen offset:256 sc1
    buffer_load_dwordx4 v[24:27], v12, s[44:47], s7 offen offset:512 sc1
    buffer_load_dwordx4 v[28:31], v12, s[44:47], s7 offen offset:768 sc1
    buffer_load_dwordx4 v[32:35], v12, s[44:47], s7 offen offset:1024 sc1
    buffer_load_dwordx4 v[36:39], v12, s[44:47], s7 offen offset:1280 sc1
    buffer_load_dwordx4 v[40:43], v12, s[44:47], s7 offen offset:1536 sc1
    buffer_load_dwordx4 v[44:47], v12, s[44:47], s7 offen offset:1792 sc1
    buffer_load_dwordx4 v[48:51], v12, s[44:47], s7 offen offset:2048 sc1
    s_barrier
    ds_read_b128 a[224:227], v2 offset:49152
    ds_read_b128 a[228:231], v2 offset:50176
    ds_read_b128 a[232:235], v2 offset:51200
    ds_read_b128 a[236:239], v2 offset:52224
    s_waitcnt vmcnt(8) lgkmcnt(3)
    v_mfma_f32_32x32x16_bf16 v[132:147], a[224:227], v[16:19], 0
    ds_read_b128 a[240:243], v2 offset:53248
    buffer_load_dwordx4 v[52:55], v12, s[44:47], s7 offen offset:2304 sc1
    s_waitcnt lgkmcnt(3)
    v_mfma_f32_32x32x16_bf16 v[148:163], a[228:231], v[16:19], 0
    ds_read_b128 a[244:247], v2 offset:54272
    s_waitcnt lgkmcnt(3)
    v_mfma_f32_32x32x16_bf16 v[164:179], a[232:235], v[16:19], 0
    ds_read_b128 a[248:251], v2 offset:55296
    s_waitcnt vmcnt(8) lgkmcnt(3)
    v_mfma_f32_32x32x16_bf16 v[132:147], a[236:239], v[20:23], v[132:147]
    ds_read_b128 a[252:255], v2 offset:56320
    buffer_load_dwordx4 v[56:59], v12, s[44:47], s7 offen offset:2560 sc1
    s_waitcnt lgkmcnt(3)
    v_mfma_f32_32x32x16_bf16 v[148:163], a[240:243], v[20:23], v[148:163]
    ds_read_b128 a[224:227], v2 offset:57344
    s_waitcnt lgkmcnt(3)
    v_mfma_f32_32x32x16_bf16 v[164:179], a[244:247], v[20:23], v[164:179]
    ds_read_b128 a[228:231], v2 offset:58368
    s_waitcnt vmcnt(8) lgkmcnt(3)
    v_mfma_f32_32x32x16_bf16 v[132:147], a[248:251], v[24:27], v[132:147]
    ds_read_b128 a[232:235], v2 offset:59392
    buffer_load_dwordx4 v[60:63], v12, s[44:47], s7 offen offset:2816 sc1
    s_waitcnt lgkmcnt(3)
    v_mfma_f32_32x32x16_bf16 v[148:163], a[252:255], v[24:27], v[148:163]
    ds_read_b128 a[236:239], v2 offset:60416
    s_waitcnt lgkmcnt(3)
    v_mfma_f32_32x32x16_bf16 v[164:179], a[224:227], v[24:27], v[164:179]
    ds_read_b128 a[240:243], v2 offset:61440
    s_waitcnt vmcnt(8) lgkmcnt(3)
    v_mfma_f32_32x32x16_bf16 v[132:147], a[228:231], v[28:31], v[132:147]
    ds_read_b128 a[244:247], v2 offset:62464
    buffer_load_dwordx4 v[64:67], v12, s[44:47], s7 offen offset:3072 sc1
    s_waitcnt lgkmcnt(3)
    v_mfma_f32_32x32x16_bf16 v[148:163], a[232:235], v[28:31], v[148:163]
    ds_read_b128 a[248:251], v2 offset:63488
    s_waitcnt lgkmcnt(3)
    v_mfma_f32_32x32x16_bf16 v[164:179], a[236:239], v[28:31], v[164:179]
    ds_read_b128 a[252:255], v2 offset:64512
    s_waitcnt vmcnt(8) lgkmcnt(3)
    v_mfma_f32_32x32x16_bf16 v[132:147], a[240:243], v[32:35], v[132:147]
    ds_read_b128 a[224:227], v3 offset:0
    buffer_load_dwordx4 v[68:71], v12, s[44:47], s7 offen offset:3328 sc1
    s_waitcnt lgkmcnt(3)
    v_mfma_f32_32x32x16_bf16 v[148:163], a[244:247], v[32:35], v[148:163]
    ds_read_b128 a[228:231], v3 offset:1024
    s_waitcnt lgkmcnt(3)
    v_mfma_f32_32x32x16_bf16 v[164:179], a[248:251], v[32:35], v[164:179]
    ds_read_b128 a[232:235], v3 offset:2048
    s_waitcnt vmcnt(8) lgkmcnt(3)
    v_mfma_f32_32x32x16_bf16 v[132:147], a[252:255], v[36:39], v[132:147]
    ds_read_b128 a[236:239], v3 offset:3072
    buffer_load_dwordx4 v[72:75], v12, s[44:47], s7 offen offset:3584 sc1
    s_waitcnt lgkmcnt(3)
    v_mfma_f32_32x32x16_bf16 v[148:163], a[224:227], v[36:39], v[148:163]
    ds_read_b128 a[240:243], v3 offset:4096
    s_waitcnt lgkmcnt(3)
    v_mfma_f32_32x32x16_bf16 v[164:179], a[228:231], v[36:39], v[164:179]
    ds_read_b128 a[244:247], v3 offset:5120
    s_waitcnt vmcnt(8) lgkmcnt(3)
    v_mfma_f32_32x32x16_bf16 v[132:147], a[232:235], v[40:43], v[132:147]
    ds_read_b128 a[248:251], v3 offset:6144
    buffer_load_dwordx4 v[76:79], v12, s[44:47], s7 offen offset:3840 sc1
    s_waitcnt lgkmcnt(3)
    v_mfma_f32_32x32x16_bf16 v[148:163], a[236:239], v[40:43], v[148:163]
    ds_read_b128 a[252:255], v3 offset:7168
    s_waitcnt lgkmcnt(3)
    v_mfma_f32_32x32x16_bf16 v[164:179], a[240:243], v[40:43], v[164:179]
    ds_read_b128 a[224:227], v3 offset:8192
    s_waitcnt vmcnt(8) lgkmcnt(3)
    v_mfma_f32_32x32x16_bf16 v[132:147], a[244:247], v[44:47], v[132:147]
    ds_read_b128 a[228:231], v3 offset:9216
    s_add_u32 s7, s7, 4096
    buffer_load_dwordx4 v[80:83], v12, s[44:47], s7 offen offset:0 sc1
    s_waitcnt lgkmcnt(3)
    v_mfma_f32_32x32x16_bf16 v[148:163], a[248:251], v[44:47], v[148:163]
    ds_read_b128 a[232:235], v3 offset:10240
    s_waitcnt lgkmcnt(3)
    v_mfma_f32_32x32x16_bf16 v[164:179], a[252:255], v[44:47], v[164:179]
    ds_read_b128 a[236:239], v3 offset:11264
    s_waitcnt vmcnt(8) lgkmcnt(3)
    v_mfma_f32_32x32x16_bf16 v[132:147], a[224:227], v[48:51], v[132:147]
    ds_read_b128 a[240:243], v3 offset:12288
    buffer_load_dwordx4 v[84:87], v12, s[44:47], s7 offen offset:256 sc1
    s_waitcnt lgkmcnt(3)
    v_mfma_f32_32x32x16_bf16 v[148:163], a[228:231], v[48:51], v[148:163]
    ds_read_b128 a[244:247], v3 offset:13312
    s_waitcnt lgkmcnt(3)
    v_mfma_f32_32x32x16_bf16 v[164:179], a[232:235], v[48:51], v[164:179]
    ds_read_b128 a[248:251], v3 offset:14336
    s_waitcnt vmcnt(8) lgkmcnt(3)
    v_mfma_f32_32x32x16_bf16 v[132:147], a[236:239], v[52:55], v[132:147]
    ds_read_b128 a[252:255], v3 offset:15360
    buffer_load_dwordx4 v[88:91], v12, s[44:47], s7 offen offset:512 sc1
    s_waitcnt lgkmcnt(3)
    v_mfma_f32_32x32x16_bf16 v[148:163], a[240:243], v[52:55], v[148:163]
    ds_read_b128 a[224:227], v3 offset:16384
    s_waitcnt lgkmcnt(3)
    v_mfma_f32_32x32x16_bf16 v[164:179], a[244:247], v[52:55], v[164:179]
    ds_read_b128 a[228:231], v3 offset:17408
    s_waitcnt vmcnt(8) lgkmcnt(3)
    v_mfma_f32_32x32x16_bf16 v[132:147], a[248:251], v[56:59], v[132:147]
    ds_read_b128 a[232:235], v3 offset:18432
    buffer_load_dwordx4 v[92:95], v12, s[44:47], s7 offen offset:768 sc1
    s_waitcnt lgkmcnt(3)
    v_mfma_f32_32x32x16_bf16 v[148:163], a[252:255], v[56:59], v[148:163]
    ds_read_b128 a[236:239], v3 offset:19456
    s_waitcnt lgkmcnt(3)
    v_mfma_f32_32x32x16_bf16 v[164:179], a[224:227], v[56:59], v[164:179]
    ds_read_b128 a[240:243], v3 offset:20480
    buffer_load_dwordx2 v[244:245], v9, s[44:47], s60 offen offset:0 sc1
    buffer_load_dwordx2 v[246:247], v9, s[44:47], s60 offen offset:64 sc1
    buffer_load_dwordx2 v[248:249], v9, s[44:47], s60 offen offset:128 sc1
    buffer_load_dwordx2 v[250:251], v9, s[44:47], s60 offen offset:192 sc1
    buffer_load_dwordx2 v[252:253], v9, s[44:47], s60 offen offset:256 sc1
    buffer_load_dwordx2 v[254:255], v9, s[44:47], s60 offen offset:320 sc1
    buffer_load_dwordx2 v[10:11], v9, s[44:47], s60 offen offset:384 sc1
    s_waitcnt vmcnt(15) lgkmcnt(3)
    v_mfma_f32_32x32x16_bf16 v[132:147], a[228:231], v[60:63], v[132:147]
    ds_read_b128 a[244:247], v3 offset:21504
    buffer_load_dwordx4 v[96:99], v12, s[44:47], s7 offen offset:1024 sc1
    s_waitcnt lgkmcnt(3)
    v_mfma_f32_32x32x16_bf16 v[148:163], a[232:235], v[60:63], v[148:163]
    ds_read_b128 a[248:251], v3 offset:22528
    s_waitcnt lgkmcnt(3)
    v_mfma_f32_32x32x16_bf16 v[164:179], a[236:239], v[60:63], v[164:179]
    ds_read_b128 a[252:255], v3 offset:23552
    s_waitcnt vmcnt(15) lgkmcnt(3)
    v_mfma_f32_32x32x16_bf16 v[132:147], a[240:243], v[64:67], v[132:147]
    ds_read_b128 a[224:227], v3 offset:24576
    buffer_load_dwordx4 v[100:103], v12, s[44:47], s7 offen offset:1280 sc1
    s_waitcnt lgkmcnt(3)
    v_mfma_f32_32x32x16_bf16 v[148:163], a[244:247], v[64:67], v[148:163]
    ds_read_b128 a[228:231], v3 offset:25600
    s_waitcnt lgkmcnt(3)
    v_mfma_f32_32x32x16_bf16 v[164:179], a[248:251], v[64:67], v[164:179]
    ds_read_b128 a[232:235], v3 offset:26624
    s_waitcnt vmcnt(15) lgkmcnt(3)
    v_mfma_f32_32x32x16_bf16 v[132:147], a[252:255], v[68:71], v[132:147]
    ds_read_b128 a[236:239], v3 offset:27648
    buffer_load_dwordx4 v[104:107], v12, s[44:47], s7 offen offset:1536 sc1
    s_waitcnt lgkmcnt(3)
    v_mfma_f32_32x32x16_bf16 v[148:163], a[224:227], v[68:71], v[148:163]
    ds_read_b128 a[240:243], v3 offset:28672
    s_waitcnt lgkmcnt(3)
    v_mfma_f32_32x32x16_bf16 v[164:179], a[228:231], v[68:71], v[164:179]
    ds_read_b128 a[244:247], v3 offset:29696
    s_waitcnt vmcnt(15) lgkmcnt(3)
    v_mfma_f32_32x32x16_bf16 v[132:147], a[232:235], v[72:75], v[132:147]
    ds_read_b128 a[248:251], v3 offset:30720
    buffer_load_dwordx4 v[108:111], v12, s[44:47], s7 offen offset:1792 sc1
    s_waitcnt lgkmcnt(3)
    v_mfma_f32_32x32x16_bf16 v[148:163], a[236:239], v[72:75], v[148:163]
    ds_read_b128 a[252:255], v3 offset:31744
    s_waitcnt lgkmcnt(3)
    v_mfma_f32_32x32x16_bf16 v[164:179], a[240:243], v[72:75], v[164:179]
    ds_read_b128 a[224:227], v1 offset:0
    s_waitcnt vmcnt(15) lgkmcnt(3)
    v_mfma_f32_32x32x16_bf16 v[132:147], a[244:247], v[76:79], v[132:147]
    ds_read_b128 a[228:231], v1 offset:1024
    buffer_load_dwordx4 v[112:115], v12, s[44:47], s7 offen offset:2048 sc1
    s_waitcnt lgkmcnt(3)
    v_mfma_f32_32x32x16_bf16 v[148:163], a[248:251], v[76:79], v[148:163]
    ds_read_b128 a[232:235], v1 offset:2048
    s_waitcnt lgkmcnt(3)
    v_mfma_f32_32x32x16_bf16 v[164:179], a[252:255], v[76:79], v[164:179]
    ds_read_b128 a[236:239], v1 offset:3072
    s_waitcnt vmcnt(15) lgkmcnt(3)
    v_mfma_f32_32x32x16_bf16 v[132:147], a[224:227], v[80:83], v[132:147]
    ds_read_b128 a[240:243], v1 offset:4096
    buffer_load_dwordx4 v[116:119], v12, s[44:47], s7 offen offset:2304 sc1
    s_waitcnt lgkmcnt(3)
    v_mfma_f32_32x32x16_bf16 v[148:163], a[228:231], v[80:83], v[148:163]
    s_barrier
    ds_read_b128 a[244:247], v1 offset:5120
    s_waitcnt lgkmcnt(3)
    v_mfma_f32_32x32x16_bf16 v[164:179], a[232:235], v[80:83], v[164:179]
    ds_read_b128 a[248:251], v1 offset:6144
    s_waitcnt vmcnt(15) lgkmcnt(3)
    v_mfma_f32_32x32x16_bf16 v[132:147], a[236:239], v[84:87], v[132:147]
    ds_read_b128 a[252:255], v1 offset:7168
    buffer_load_dwordx4 v[120:123], v12, s[44:47], s7 offen offset:2560 sc1
    s_waitcnt lgkmcnt(3)
    v_mfma_f32_32x32x16_bf16 v[148:163], a[240:243], v[84:87], v[148:163]
    ds_read_b128 a[224:227], v1 offset:8192
    s_waitcnt lgkmcnt(3)
    v_mfma_f32_32x32x16_bf16 v[164:179], a[244:247], v[84:87], v[164:179]
    ds_read_b128 a[228:231], v1 offset:9216
    s_waitcnt vmcnt(15) lgkmcnt(3)
    v_mfma_f32_32x32x16_bf16 v[132:147], a[248:251], v[88:91], v[132:147]
    ds_read_b128 a[232:235], v1 offset:10240
    buffer_load_dwordx4 v[124:127], v12, s[44:47], s7 offen offset:2816 sc1
    s_waitcnt lgkmcnt(3)
    v_mfma_f32_32x32x16_bf16 v[148:163], a[252:255], v[88:91], v[148:163]
    ds_read_b128 a[236:239], v1 offset:11264
    s_waitcnt lgkmcnt(3)
    v_mfma_f32_32x32x16_bf16 v[164:179], a[224:227], v[88:91], v[164:179]
    ds_read_b128 a[240:243], v1 offset:12288
    s_add_u32 s10, s55, 114688
    s_mov_b32 m0, s10
    s_add_u32 s11, s8, 163840
    buffer_load_dwordx4 v1, s[44:47], s11 offen offset:0 lds
    s_waitcnt vmcnt(16) lgkmcnt(3)
    v_mfma_f32_32x32x16_bf16 v[132:147], a[228:231], v[92:95], v[132:147]
    ds_read_b128 a[244:247], v1 offset:13312
    s_waitcnt vmcnt(14)
    v_add_f32 v244, v244, v246
    v_add_f32 v245, v245, v247
    s_waitcnt vmcnt(13)
    v_add_f32 v244, v244, v248
    s_waitcnt lgkmcnt(3)
    v_mfma_f32_32x32x16_bf16 v[148:163], a[232:235], v[92:95], v[148:163]
    ds_read_b128 a[248:251], v1 offset:14336
    buffer_load_dwordx4 v1, s[44:47], s11 offen offset:1024 lds
    v_add_f32 v245, v245, v249
    s_waitcnt vmcnt(13)
    v_add_f32 v244, v244, v250
    v_add_f32 v245, v245, v251
    s_waitcnt lgkmcnt(3)
    v_mfma_f32_32x32x16_bf16 v[164:179], a[236:239], v[92:95], v[164:179]
    ds_read_b128 a[252:255], v1 offset:15360
    s_waitcnt vmcnt(12)
    v_add_f32 v244, v244, v252
    v_add_f32 v245, v245, v253
    s_waitcnt vmcnt(11)
    v_add_f32 v244, v244, v254
    s_waitcnt vmcnt(9) lgkmcnt(3)
    v_mfma_f32_32x32x16_bf16 v[132:147], a[240:243], v[96:99], v[132:147]
    ds_read_b128 a[224:227], v1 offset:16384
    buffer_load_dwordx4 v1, s[44:47], s11 offen offset:2048 lds
    v_add_f32 v245, v245, v255
    v_add_f32 v4, v244, v10
    v_add_f32 v5, v245, v11
    s_waitcnt lgkmcnt(3)
    v_mfma_f32_32x32x16_bf16 v[148:163], a[244:247], v[96:99], v[148:163]
    ds_read_b128 a[228:231], v1 offset:17408
    v_mov_b32 v6, v4
    s_nop 1
    v_permlane32_swap_b32 v4, v6
    v_add_f32 v4, v4, v6
    s_waitcnt lgkmcnt(3)
    v_mfma_f32_32x32x16_bf16 v[164:179], a[248:251], v[96:99], v[164:179]
    ds_read_b128 a[232:235], v1 offset:18432
    buffer_load_dwordx4 v1, s[44:47], s11 offen offset:3072 lds
    v_mov_b32 v6, v5
    s_nop 1
    v_permlane32_swap_b32 v5, v6
    v_add_f32 v5, v5, v6
    s_waitcnt vmcnt(10) lgkmcnt(3)
    v_mfma_f32_32x32x16_bf16 v[132:147], a[252:255], v[100:103], v[132:147]
    ds_read_b128 a[236:239], v1 offset:19456
    v_mul_f32 v4, 0xbb124925, v4
    v_mul_f32 v5, 0x3b124925, v5
    v_fma_f32 v5, -v4, v4, v5
    s_waitcnt lgkmcnt(3)
    v_mfma_f32_32x32x16_bf16 v[148:163], a[224:227], v[100:103], v[148:163]
    ds_read_b128 a[240:243], v1 offset:20480
    s_add_u32 s10, s55, 131072
    s_mov_b32 m0, s10
    s_add_u32 s11, s8, 180224
    buffer_load_dwordx4 v1, s[44:47], s11 offen offset:0 lds
    v_max_f32 v5, 0, v5
    v_add_f32 v5, 0x3727c5ac, v5
    v_rcp_f32 v5, v5
    s_waitcnt lgkmcnt(3)
    v_mfma_f32_32x32x16_bf16 v[164:179], a[228:231], v[100:103], v[164:179]
    ds_read_b128 a[244:247], v1 offset:21504
    v_cvt_pk_bf16_f32 v128, v4, v4
    v_lshlrev_b32 v6, 16, v128
    v_sub_f32 v6, v4, v6
    s_waitcnt vmcnt(10) lgkmcnt(3)
    v_mfma_f32_32x32x16_bf16 v[132:147], a[232:235], v[104:107], v[132:147]
    ds_read_b128 a[248:251], v1 offset:22528
    buffer_load_dwordx4 v1, s[44:47], s11 offen offset:1024 lds
    v_cvt_pk_bf16_f32 v129, v6, v6
    v_mov_b32 v130, v128
    v_mov_b32 v131, v129
    s_waitcnt lgkmcnt(3)
    v_mfma_f32_32x32x16_bf16 v[148:163], a[236:239], v[104:107], v[148:163]
    ds_read_b128 a[252:255], v1 offset:23552
    v_lshrrev_b32 v6, 1, v8
    s_lshl_b32 s15, s48, 7
    s_add_u32 s15, s15, 65536
    s_waitcnt lgkmcnt(3)
    v_mfma_f32_32x32x16_bf16 v[164:179], a[240:243], v[104:107], v[164:179]
    ds_read_b128 a[224:227], v1 offset:24576
    buffer_load_dwordx4 v1, s[44:47], s11 offen offset:2048 lds
    buffer_store_dword v5, v6, s[44:47], s15 offen sc1
    s_waitcnt vmcnt(12) lgkmcnt(3)
    v_mfma_f32_32x32x16_bf16 v[132:147], a[244:247], v[108:111], v[132:147]
    ds_read_b128 a[228:231], v1 offset:25600
    s_waitcnt lgkmcnt(3)
    v_mfma_f32_32x32x16_bf16 v[148:163], a[248:251], v[108:111], v[148:163]
    ds_read_b128 a[232:235], v1 offset:26624
    buffer_load_dwordx4 v1, s[44:47], s11 offen offset:3072 lds
    s_waitcnt lgkmcnt(3)
    v_mfma_f32_32x32x16_bf16 v[164:179], a[252:255], v[108:111], v[164:179]
    ds_read_b128 a[236:239], v1 offset:27648
    s_waitcnt vmcnt(12) lgkmcnt(3)
    v_mfma_f32_32x32x16_bf16 v[132:147], a[224:227], v[112:115], v[132:147]
    ds_read_b128 a[240:243], v1 offset:28672
    s_add_u32 s10, s55, 147456
    s_mov_b32 m0, s10
    s_add_u32 s11, s8, 196608
    buffer_load_dwordx4 v1, s[44:47], s11 offen offset:0 lds
    s_waitcnt lgkmcnt(3)
    v_mfma_f32_32x32x16_bf16 v[148:163], a[228:231], v[112:115], v[148:163]
    ds_read_b128 a[244:247], v1 offset:29696
    s_waitcnt lgkmcnt(3)
    v_mfma_f32_32x32x16_bf16 v[164:179], a[232:235], v[112:115], v[164:179]
    ds_read_b128 a[248:251], v1 offset:30720
    buffer_load_dwordx4 v1, s[44:47], s11 offen offset:1024 lds
    s_waitcnt vmcnt(13) lgkmcnt(3)
    v_mfma_f32_32x32x16_bf16 v[132:147], a[236:239], v[116:119], v[132:147]
    ds_read_b128 a[252:255], v1 offset:31744
    s_waitcnt lgkmcnt(3)
    v_mfma_f32_32x32x16_bf16 v[148:163], a[240:243], v[116:119], v[148:163]
    ds_read_b128 a[224:227], v1 offset:32768
    buffer_load_dwordx4 v1, s[44:47], s11 offen offset:2048 lds
    s_waitcnt lgkmcnt(3)
    v_mfma_f32_32x32x16_bf16 v[164:179], a[244:247], v[116:119], v[164:179]
    ds_read_b128 a[228:231], v1 offset:33792
    s_waitcnt vmcnt(13) lgkmcnt(3)
    v_mfma_f32_32x32x16_bf16 v[132:147], a[248:251], v[120:123], v[132:147]
    ds_read_b128 a[232:235], v1 offset:34816
    buffer_load_dwordx4 v1, s[44:47], s11 offen offset:3072 lds
    s_waitcnt lgkmcnt(3)
    v_mfma_f32_32x32x16_bf16 v[148:163], a[252:255], v[120:123], v[148:163]
    ds_read_b128 a[236:239], v1 offset:35840
    s_waitcnt lgkmcnt(3)
    v_mfma_f32_32x32x16_bf16 v[164:179], a[224:227], v[120:123], v[164:179]
    ds_read_b128 a[240:243], v1 offset:36864
    s_waitcnt vmcnt(13) lgkmcnt(3)
    v_mfma_f32_32x32x16_bf16 v[132:147], a[228:231], v[124:127], v[132:147]
    ds_read_b128 a[244:247], v1 offset:37888
    s_waitcnt lgkmcnt(3)
    v_mfma_f32_32x32x16_bf16 v[148:163], a[232:235], v[124:127], v[148:163]
    ds_read_b128 a[248:251], v1 offset:38912
    s_waitcnt lgkmcnt(3)
    v_mfma_f32_32x32x16_bf16 v[164:179], a[236:239], v[124:127], v[164:179]
    ds_read_b128 a[252:255], v1 offset:39936
    s_waitcnt lgkmcnt(3)
    v_mfma_f32_32x32x16_bf16 v[132:147], a[240:243], v[128:131], v[132:147]
    ds_read_b128 a[224:227], v1 offset:40960
    s_waitcnt lgkmcnt(3)
    v_mfma_f32_32x32x16_bf16 v[148:163], a[244:247], v[128:131], v[148:163]
    ds_read_b128 a[228:231], v1 offset:41984
    s_waitcnt lgkmcnt(3)
    v_mfma_f32_32x32x16_bf16 v[164:179], a[248:251], v[128:131], v[164:179]
    ds_read_b128 a[232:235], v1 offset:43008
    s_waitcnt lgkmcnt(3)
    v_mfma_f32_32x32x16_bf16 v[180:195], a[252:255], v[16:19], 0
    ds_read_b128 a[236:239], v1 offset:44032
    s_waitcnt lgkmcnt(3)
    v_mfma_f32_32x32x16_bf16 v[196:211], a[224:227], v[16:19], 0
    ds_read_b128 a[240:243], v1 offset:45056
    v_max_f32 v132, 0, v132
    v_max_f32 v133, 0, v133
    v_max_f32 v134, 0, v134
    s_waitcnt lgkmcnt(3)
    v_mfma_f32_32x32x16_bf16 v[180:195], a[228:231], v[20:23], v[180:195]
    ds_read_b128 a[244:247], v1 offset:46080
    v_max_f32 v135, 0, v135
    v_max_f32 v136, 0, v136
    v_max_f32 v137, 0, v137
    s_waitcnt lgkmcnt(3)
    v_mfma_f32_32x32x16_bf16 v[196:211], a[232:235], v[20:23], v[196:211]
    ds_read_b128 a[248:251], v1 offset:47104
    v_max_f32 v138, 0, v138
    v_max_f32 v139, 0, v139
    v_mul_f32 v132, v132, v140
    s_waitcnt lgkmcnt(3)
    v_mfma_f32_32x32x16_bf16 v[180:195], a[236:239], v[24:27], v[180:195]
    ds_read_b128 a[252:255], v1 offset:48128
    v_mul_f32 v133, v133, v141
    v_mul_f32 v134, v134, v142
    v_mul_f32 v135, v135, v143
    s_waitcnt lgkmcnt(3)
    v_mfma_f32_32x32x16_bf16 v[196:211], a[240:243], v[24:27], v[196:211]
    ds_read_b128 a[224:227], v1 offset:49152
    v_mul_f32 v136, v136, v144
    v_mul_f32 v137, v137, v145
    v_mul_f32 v138, v138, v146
    s_waitcnt lgkmcnt(3)
    v_mfma_f32_32x32x16_bf16 v[180:195], a[244:247], v[28:31], v[180:195]
    ds_read_b128 a[228:231], v1 offset:50176
    v_mul_f32 v139, v139, v147
    v_cvt_pk_bf16_f32 v140, v132, v133
    v_cvt_pk_bf16_f32 v141, v134, v135
    s_waitcnt lgkmcnt(3)
    v_mfma_f32_32x32x16_bf16 v[196:211], a[248:251], v[28:31], v[196:211]
    ds_read_b128 a[232:235], v1 offset:51200
    v_cvt_pk_bf16_f32 v142, v136, v137
    v_cvt_pk_bf16_f32 v143, v138, v139
    buffer_store_dwordx4 v[140:143], v1, s[44:47], s13 offen offset:0 sc1
    s_waitcnt lgkmcnt(3)
    v_mfma_f32_32x32x16_bf16 v[180:195], a[252:255], v[32:35], v[180:195]
    ds_read_b128 a[236:239], v1 offset:52224
    v_max_f32 v148, 0, v148
    v_max_f32 v149, 0, v149
    v_max_f32 v150, 0, v150
    s_waitcnt lgkmcnt(3)
    v_mfma_f32_32x32x16_bf16 v[196:211], a[224:227], v[32:35], v[196:211]
    ds_read_b128 a[240:243], v1 offset:53248
    v_max_f32 v151, 0, v151
    v_max_f32 v152, 0, v152
    v_max_f32 v153, 0, v153
    s_waitcnt lgkmcnt(3)
    v_mfma_f32_32x32x16_bf16 v[180:195], a[228:231], v[36:39], v[180:195]
    ds_read_b128 a[244:247], v1 offset:54272
    v_max_f32 v154, 0, v154
    v_max_f32 v155, 0, v155
    v_mul_f32 v148, v148, v156
    s_waitcnt lgkmcnt(3)
    v_mfma_f32_32x32x16_bf16 v[196:211], a[232:235], v[36:39], v[196:211]
    ds_read_b128 a[248:251], v1 offset:55296
    v_mul_f32 v149, v149, v157
    v_mul_f32 v150, v150, v158
    v_mul_f32 v151, v151, v159
    s_waitcnt lgkmcnt(3)
    v_mfma_f32_32x32x16_bf16 v[180:195], a[236:239], v[40:43], v[180:195]
    ds_read_b128 a[252:255], v1 offset:56320
    v_mul_f32 v152, v152, v160
    v_mul_f32 v153, v153, v161
    v_mul_f32 v154, v154, v162
    s_waitcnt lgkmcnt(3)
    v_mfma_f32_32x32x16_bf16 v[196:211], a[240:243], v[40:43], v[196:211]
    ds_read_b128 a[224:227], v1 offset:57344
    v_mul_f32 v155, v155, v163
    v_cvt_pk_bf16_f32 v156, v148, v149
    v_cvt_pk_bf16_f32 v157, v150, v151
    s_waitcnt lgkmcnt(3)
    v_mfma_f32_32x32x16_bf16 v[180:195], a[244:247], v[44:47], v[180:195]
    ds_read_b128 a[228:231], v1 offset:58368
    v_cvt_pk_bf16_f32 v158, v152, v153
    v_cvt_pk_bf16_f32 v159, v154, v155
    buffer_store_dwordx4 v[156:159], v1, s[44:47], s13 offen offset:1024 sc1
    s_waitcnt lgkmcnt(3)
    v_mfma_f32_32x32x16_bf16 v[196:211], a[248:251], v[44:47], v[196:211]
    ds_read_b128 a[232:235], v1 offset:59392
    v_max_f32 v164, 0, v164
    v_max_f32 v165, 0, v165
    v_max_f32 v166, 0, v166
    s_waitcnt lgkmcnt(3)
    v_mfma_f32_32x32x16_bf16 v[180:195], a[252:255], v[48:51], v[180:195]
    ds_read_b128 a[236:239], v1 offset:60416
    v_max_f32 v167, 0, v167
    v_max_f32 v168, 0, v168
    v_max_f32 v169, 0, v169
    s_waitcnt lgkmcnt(3)
    v_mfma_f32_32x32x16_bf16 v[196:211], a[224:227], v[48:51], v[196:211]
    ds_read_b128 a[240:243], v1 offset:61440
    v_max_f32 v170, 0, v170
    v_max_f32 v171, 0, v171
    v_mul_f32 v164, v164, v172
    s_waitcnt lgkmcnt(3)
    v_mfma_f32_32x32x16_bf16 v[180:195], a[228:231], v[52:55], v[180:195]
    ds_read_b128 a[244:247], v1 offset:62464
    v_mul_f32 v165, v165, v173
    v_mul_f32 v166, v166, v174
    v_mul_f32 v167, v167, v175
    s_waitcnt lgkmcnt(3)
    v_mfma_f32_32x32x16_bf16 v[196:211], a[232:235], v[52:55], v[196:211]
    ds_read_b128 a[248:251], v1 offset:63488
    v_mul_f32 v168, v168, v176
    v_mul_f32 v169, v169, v177
    v_mul_f32 v170, v170, v178
    s_waitcnt lgkmcnt(3)
    v_mfma_f32_32x32x16_bf16 v[180:195], a[236:239], v[56:59], v[180:195]
    ds_read_b128 a[252:255], v1 offset:64512
    v_mul_f32 v171, v171, v179
    v_cvt_pk_bf16_f32 v172, v164, v165
    v_cvt_pk_bf16_f32 v173, v166, v167
    s_waitcnt lgkmcnt(3)
    v_mfma_f32_32x32x16_bf16 v[196:211], a[240:243], v[56:59], v[196:211]
    ds_read_b128 a[224:227], v2 offset:0
    v_cvt_pk_bf16_f32 v174, v168, v169
    v_cvt_pk_bf16_f32 v175, v170, v171
    buffer_store_dwordx4 v[172:175], v1, s[44:47], s13 offen offset:2048 sc1
    s_waitcnt lgkmcnt(3)
    v_mfma_f32_32x32x16_bf16 v[180:195], a[244:247], v[60:63], v[180:195]
    ds_read_b128 a[228:231], v2 offset:1024
    s_waitcnt lgkmcnt(3)
    v_mfma_f32_32x32x16_bf16 v[196:211], a[248:251], v[60:63], v[196:211]
    ds_read_b128 a[232:235], v2 offset:2048
    s_waitcnt lgkmcnt(3)
    v_mfma_f32_32x32x16_bf16 v[180:195], a[252:255], v[64:67], v[180:195]
    ds_read_b128 a[236:239], v2 offset:3072
    s_waitcnt lgkmcnt(3)
    v_mfma_f32_32x32x16_bf16 v[196:211], a[224:227], v[64:67], v[196:211]
    ds_read_b128 a[240:243], v2 offset:4096
    s_waitcnt lgkmcnt(3)
    v_mfma_f32_32x32x16_bf16 v[180:195], a[228:231], v[68:71], v[180:195]
    ds_read_b128 a[244:247], v2 offset:5120
    s_waitcnt lgkmcnt(3)
    v_mfma_f32_32x32x16_bf16 v[196:211], a[232:235], v[68:71], v[196:211]
    ds_read_b128 a[248:251], v2 offset:6144
    s_waitcnt lgkmcnt(3)
    v_mfma_f32_32x32x16_bf16 v[180:195], a[236:239], v[72:75], v[180:195]
    ds_read_b128 a[252:255], v2 offset:7168
    s_waitcnt lgkmcnt(3)
    v_mfma_f32_32x32x16_bf16 v[196:211], a[240:243], v[72:75], v[196:211]
    ds_read_b128 a[224:227], v2 offset:8192
    s_waitcnt lgkmcnt(3)
    v_mfma_f32_32x32x16_bf16 v[180:195], a[244:247], v[76:79], v[180:195]
    ds_read_b128 a[228:231], v2 offset:9216
    s_waitcnt lgkmcnt(3)
    v_mfma_f32_32x32x16_bf16 v[196:211], a[248:251], v[76:79], v[196:211]
    ds_read_b128 a[232:235], v2 offset:10240
    s_waitcnt lgkmcnt(3)
    v_mfma_f32_32x32x16_bf16 v[180:195], a[252:255], v[80:83], v[180:195]
    ds_read_b128 a[236:239], v2 offset:11264
    s_waitcnt lgkmcnt(3)
    v_mfma_f32_32x32x16_bf16 v[196:211], a[224:227], v[80:83], v[196:211]
    ds_read_b128 a[240:243], v2 offset:12288
    s_waitcnt lgkmcnt(3)
    v_mfma_f32_32x32x16_bf16 v[180:195], a[228:231], v[84:87], v[180:195]
    ds_read_b128 a[244:247], v2 offset:13312
    s_waitcnt lgkmcnt(3)
    v_mfma_f32_32x32x16_bf16 v[196:211], a[232:235], v[84:87], v[196:211]
    ds_read_b128 a[248:251], v2 offset:14336
    s_waitcnt lgkmcnt(3)
    v_mfma_f32_32x32x16_bf16 v[180:195], a[236:239], v[88:91], v[180:195]
    ds_read_b128 a[252:255], v2 offset:15360
    s_waitcnt lgkmcnt(3)
    v_mfma_f32_32x32x16_bf16 v[196:211], a[240:243], v[88:91], v[196:211]
    ds_read_b128 a[224:227], v2 offset:16384
    s_waitcnt lgkmcnt(3)
    v_mfma_f32_32x32x16_bf16 v[180:195], a[244:247], v[92:95], v[180:195]
    ds_read_b128 a[228:231], v2 offset:17408
    s_waitcnt lgkmcnt(3)
    v_mfma_f32_32x32x16_bf16 v[196:211], a[248:251], v[92:95], v[196:211]
    ds_read_b128 a[232:235], v2 offset:18432
    s_waitcnt lgkmcnt(3)
    v_mfma_f32_32x32x16_bf16 v[180:195], a[252:255], v[96:99], v[180:195]
    ds_read_b128 a[236:239], v2 offset:19456
    s_waitcnt lgkmcnt(3)
    v_mfma_f32_32x32x16_bf16 v[196:211], a[224:227], v[96:99], v[196:211]
    ds_read_b128 a[240:243], v2 offset:20480
    s_waitcnt lgkmcnt(3)
    v_mfma_f32_32x32x16_bf16 v[180:195], a[228:231], v[100:103], v[180:195]
    ds_read_b128 a[244:247], v2 offset:21504
    s_waitcnt lgkmcnt(3)
    v_mfma_f32_32x32x16_bf16 v[196:211], a[232:235], v[100:103], v[196:211]
    ds_read_b128 a[248:251], v2 offset:22528
    s_waitcnt lgkmcnt(3)
    v_mfma_f32_32x32x16_bf16 v[180:195], a[236:239], v[104:107], v[180:195]
    ds_read_b128 a[252:255], v2 offset:23552
    s_waitcnt lgkmcnt(3)
    v_mfma_f32_32x32x16_bf16 v[196:211], a[240:243], v[104:107], v[196:211]
    ds_read_b128 a[224:227], v2 offset:24576
    s_lshl_b32 s15, s48, 6
    s_lshl_b32 s61, s49, 2
    s_add_u32 s15, s15, s61
    s_add_u32 s15, s15, 49152
    s_waitcnt vmcnt(0)
    s_mov_b64 exec, 1
    buffer_store_dword v15, v1, s[44:47], s15 offen sc1
    s_mov_b64 exec, -1
    s_waitcnt lgkmcnt(3)
    v_mfma_f32_32x32x16_bf16 v[180:195], a[244:247], v[108:111], v[180:195]
    ds_read_b128 a[228:231], v2 offset:25600
    s_waitcnt lgkmcnt(3)
    v_mfma_f32_32x32x16_bf16 v[196:211], a[248:251], v[108:111], v[196:211]
    ds_read_b128 a[232:235], v2 offset:26624
    s_waitcnt lgkmcnt(3)
    v_mfma_f32_32x32x16_bf16 v[180:195], a[252:255], v[112:115], v[180:195]
    ds_read_b128 a[236:239], v2 offset:27648
    s_waitcnt lgkmcnt(3)
    v_mfma_f32_32x32x16_bf16 v[196:211], a[224:227], v[112:115], v[196:211]
    ds_read_b128 a[240:243], v2 offset:28672
    s_waitcnt lgkmcnt(3)
    v_mfma_f32_32x32x16_bf16 v[180:195], a[228:231], v[116:119], v[180:195]
    ds_read_b128 a[244:247], v2 offset:29696
    s_waitcnt lgkmcnt(3)
    v_mfma_f32_32x32x16_bf16 v[196:211], a[232:235], v[116:119], v[196:211]
    ds_read_b128 a[248:251], v2 offset:30720
    s_waitcnt lgkmcnt(3)
    v_mfma_f32_32x32x16_bf16 v[180:195], a[236:239], v[120:123], v[180:195]
    ds_read_b128 a[252:255], v2 offset:31744
    s_waitcnt lgkmcnt(3)
    v_mfma_f32_32x32x16_bf16 v[196:211], a[240:243], v[120:123], v[196:211]
    ds_read_b128 a[224:227], v2 offset:32768
    s_waitcnt lgkmcnt(3)
    v_mfma_f32_32x32x16_bf16 v[180:195], a[244:247], v[124:127], v[180:195]
    ds_read_b128 a[228:231], v2 offset:33792
    s_waitcnt lgkmcnt(3)
    v_mfma_f32_32x32x16_bf16 v[196:211], a[248:251], v[124:127], v[196:211]
    ds_read_b128 a[232:235], v2 offset:34816
    s_waitcnt lgkmcnt(3)
    v_mfma_f32_32x32x16_bf16 v[180:195], a[252:255], v[128:131], v[180:195]
    ds_read_b128 a[236:239], v2 offset:35840
    s_waitcnt lgkmcnt(3)
    v_mfma_f32_32x32x16_bf16 v[196:211], a[224:227], v[128:131], v[196:211]
    ds_read_b128 a[240:243], v2 offset:36864
    s_waitcnt lgkmcnt(3)
    v_mfma_f32_32x32x16_bf16 v[212:227], a[228:231], v[16:19], 0
    ds_read_b128 a[244:247], v2 offset:37888
    s_waitcnt lgkmcnt(3)
    v_mfma_f32_32x32x16_bf16 v[228:243], a[232:235], v[16:19], 0
    ds_read_b128 a[248:251], v2 offset:38912
    s_nop 1
    v_max_f32 v180, 0, v180
    v_max_f32 v181, 0, v181
    v_max_f32 v182, 0, v182
    s_waitcnt lgkmcnt(3)
    v_mfma_f32_32x32x16_bf16 v[212:227], a[236:239], v[20:23], v[212:227]
    ds_read_b128 a[252:255], v2 offset:39936
    v_max_f32 v183, 0, v183
    v_max_f32 v184, 0, v184
    v_max_f32 v185, 0, v185
    s_waitcnt lgkmcnt(3)
    v_mfma_f32_32x32x16_bf16 v[228:243], a[240:243], v[20:23], v[228:243]
    ds_read_b128 a[224:227], v2 offset:40960
    v_max_f32 v186, 0, v186
    v_max_f32 v187, 0, v187
    v_mul_f32 v180, v180, v188
    s_waitcnt lgkmcnt(3)
    v_mfma_f32_32x32x16_bf16 v[212:227], a[244:247], v[24:27], v[212:227]
    ds_read_b128 a[228:231], v2 offset:41984
    v_mul_f32 v181, v181, v189
    v_mul_f32 v182, v182, v190
    v_mul_f32 v183, v183, v191
    s_waitcnt lgkmcnt(3)
    v_mfma_f32_32x32x16_bf16 v[228:243], a[248:251], v[24:27], v[228:243]
    ds_read_b128 a[232:235], v2 offset:43008
    v_mul_f32 v184, v184, v192
    v_mul_f32 v185, v185, v193
    v_mul_f32 v186, v186, v194
    s_waitcnt lgkmcnt(3)
    v_mfma_f32_32x32x16_bf16 v[212:227], a[252:255], v[28:31], v[212:227]
    ds_read_b128 a[236:239], v2 offset:44032
    v_mul_f32 v187, v187, v195
    v_cvt_pk_bf16_f32 v188, v180, v181
    v_cvt_pk_bf16_f32 v189, v182, v183
    s_waitcnt lgkmcnt(3)
    v_mfma_f32_32x32x16_bf16 v[228:243], a[224:227], v[28:31], v[228:243]
    ds_read_b128 a[240:243], v2 offset:45056
    v_cvt_pk_bf16_f32 v190, v184, v185
    v_cvt_pk_bf16_f32 v191, v186, v187
    buffer_store_dwordx4 v[188:191], v1, s[44:47], s13 offen offset:3072 sc1
    s_waitcnt lgkmcnt(3)
    v_mfma_f32_32x32x16_bf16 v[212:227], a[228:231], v[32:35], v[212:227]
    ds_read_b128 a[244:247], v2 offset:46080
    v_max_f32 v196, 0, v196
    v_max_f32 v197, 0, v197
    v_max_f32 v198, 0, v198
    s_waitcnt lgkmcnt(3)
    v_mfma_f32_32x32x16_bf16 v[228:243], a[232:235], v[32:35], v[228:243]
    ds_read_b128 a[248:251], v2 offset:47104
    v_max_f32 v199, 0, v199
    v_max_f32 v200, 0, v200
    v_max_f32 v201, 0, v201
    s_waitcnt lgkmcnt(3)
    v_mfma_f32_32x32x16_bf16 v[212:227], a[236:239], v[36:39], v[212:227]
    ds_read_b128 a[252:255], v2 offset:48128
    v_max_f32 v202, 0, v202
    v_max_f32 v203, 0, v203
    v_mul_f32 v196, v196, v204
    s_waitcnt lgkmcnt(3)
    v_mfma_f32_32x32x16_bf16 v[228:243], a[240:243], v[36:39], v[228:243]
    s_barrier
    ds_read_b128 a[224:227], v2 offset:49152
    v_mul_f32 v197, v197, v205
    v_mul_f32 v198, v198, v206
    v_mul_f32 v199, v199, v207
    s_waitcnt lgkmcnt(3)
    v_mfma_f32_32x32x16_bf16 v[212:227], a[244:247], v[40:43], v[212:227]
    ds_read_b128 a[228:231], v2 offset:50176
    v_mul_f32 v200, v200, v208
    v_mul_f32 v201, v201, v209
    v_mul_f32 v202, v202, v210
    s_waitcnt lgkmcnt(3)
    v_mfma_f32_32x32x16_bf16 v[228:243], a[248:251], v[40:43], v[228:243]
    ds_read_b128 a[232:235], v2 offset:51200
    v_mul_f32 v203, v203, v211
    v_cvt_pk_bf16_f32 v204, v196, v197
    v_cvt_pk_bf16_f32 v205, v198, v199
    s_waitcnt lgkmcnt(3)
    v_mfma_f32_32x32x16_bf16 v[212:227], a[252:255], v[44:47], v[212:227]
    ds_read_b128 a[236:239], v2 offset:52224
    v_cvt_pk_bf16_f32 v206, v200, v201
    v_cvt_pk_bf16_f32 v207, v202, v203
    buffer_store_dwordx4 v[204:207], v1, s[44:47], s14 offen offset:0 sc1
    s_waitcnt lgkmcnt(3)
    v_mfma_f32_32x32x16_bf16 v[228:243], a[224:227], v[44:47], v[228:243]
    ds_read_b128 a[240:243], v2 offset:53248
    s_waitcnt lgkmcnt(3)
    v_mfma_f32_32x32x16_bf16 v[212:227], a[228:231], v[48:51], v[212:227]
    ds_read_b128 a[244:247], v2 offset:54272
    s_waitcnt lgkmcnt(3)
    v_mfma_f32_32x32x16_bf16 v[228:243], a[232:235], v[48:51], v[228:243]
    ds_read_b128 a[248:251], v2 offset:55296
    s_waitcnt lgkmcnt(3)
    v_mfma_f32_32x32x16_bf16 v[212:227], a[236:239], v[52:55], v[212:227]
    ds_read_b128 a[252:255], v2 offset:56320
    s_waitcnt lgkmcnt(3)
    v_mfma_f32_32x32x16_bf16 v[228:243], a[240:243], v[52:55], v[228:243]
    ds_read_b128 a[224:227], v2 offset:57344
    s_waitcnt lgkmcnt(3)
    v_mfma_f32_32x32x16_bf16 v[212:227], a[244:247], v[56:59], v[212:227]
    ds_read_b128 a[228:231], v2 offset:58368
    s_waitcnt lgkmcnt(3)
    v_mfma_f32_32x32x16_bf16 v[228:243], a[248:251], v[56:59], v[228:243]
    ds_read_b128 a[232:235], v2 offset:59392
    s_waitcnt lgkmcnt(3)
    v_mfma_f32_32x32x16_bf16 v[212:227], a[252:255], v[60:63], v[212:227]
    ds_read_b128 a[236:239], v2 offset:60416
    s_waitcnt lgkmcnt(3)
    v_mfma_f32_32x32x16_bf16 v[228:243], a[224:227], v[60:63], v[228:243]
    ds_read_b128 a[240:243], v2 offset:61440
    s_waitcnt lgkmcnt(3)
    v_mfma_f32_32x32x16_bf16 v[212:227], a[228:231], v[64:67], v[212:227]
    ds_read_b128 a[244:247], v2 offset:62464
    s_waitcnt lgkmcnt(3)
    v_mfma_f32_32x32x16_bf16 v[228:243], a[232:235], v[64:67], v[228:243]
    ds_read_b128 a[248:251], v2 offset:63488
    s_waitcnt lgkmcnt(3)
    v_mfma_f32_32x32x16_bf16 v[212:227], a[236:239], v[68:71], v[212:227]
    ds_read_b128 a[252:255], v2 offset:64512
    s_waitcnt lgkmcnt(3)
    v_mfma_f32_32x32x16_bf16 v[228:243], a[240:243], v[68:71], v[228:243]
    ds_read_b128 a[224:227], v3 offset:0
    s_waitcnt lgkmcnt(3)
    v_mfma_f32_32x32x16_bf16 v[212:227], a[244:247], v[72:75], v[212:227]
    ds_read_b128 a[228:231], v3 offset:1024
    s_waitcnt lgkmcnt(3)
    v_mfma_f32_32x32x16_bf16 v[228:243], a[248:251], v[72:75], v[228:243]
    ds_read_b128 a[232:235], v3 offset:2048
    s_waitcnt lgkmcnt(3)
    v_mfma_f32_32x32x16_bf16 v[212:227], a[252:255], v[76:79], v[212:227]
    ds_read_b128 a[236:239], v3 offset:3072
    s_waitcnt lgkmcnt(3)
    v_mfma_f32_32x32x16_bf16 v[228:243], a[224:227], v[76:79], v[228:243]
    ds_read_b128 a[240:243], v3 offset:4096
    s_waitcnt lgkmcnt(3)
    v_mfma_f32_32x32x16_bf16 v[212:227], a[228:231], v[80:83], v[212:227]
    ds_read_b128 a[244:247], v3 offset:5120
    s_waitcnt lgkmcnt(3)
    v_mfma_f32_32x32x16_bf16 v[228:243], a[232:235], v[80:83], v[228:243]
    ds_read_b128 a[248:251], v3 offset:6144
    s_waitcnt lgkmcnt(3)
    v_mfma_f32_32x32x16_bf16 v[212:227], a[236:239], v[84:87], v[212:227]
    ds_read_b128 a[252:255], v3 offset:7168
    s_waitcnt lgkmcnt(3)
    v_mfma_f32_32x32x16_bf16 v[228:243], a[240:243], v[84:87], v[228:243]
    ds_read_b128 a[224:227], v3 offset:8192
    s_waitcnt lgkmcnt(3)
    v_mfma_f32_32x32x16_bf16 v[212:227], a[244:247], v[88:91], v[212:227]
    ds_read_b128 a[228:231], v3 offset:9216
    s_waitcnt lgkmcnt(3)
    v_mfma_f32_32x32x16_bf16 v[228:243], a[248:251], v[88:91], v[228:243]
    ds_read_b128 a[232:235], v3 offset:10240
    s_waitcnt lgkmcnt(3)
    v_mfma_f32_32x32x16_bf16 v[212:227], a[252:255], v[92:95], v[212:227]
    ds_read_b128 a[236:239], v3 offset:11264
    s_lshl_b32 s15, s48, 6
    s_lshl_b32 s61, s49, 2
    s_add_u32 s15, s15, s61
    s_add_u32 s15, s15, 53248
    s_waitcnt vmcnt(0)
    s_mov_b64 exec, 1
    buffer_store_dword v15, v1, s[44:47], s15 offen sc1
    s_mov_b64 exec, -1
    s_waitcnt lgkmcnt(3)
    v_mfma_f32_32x32x16_bf16 v[228:243], a[224:227], v[92:95], v[228:243]
    ds_read_b128 a[240:243], v3 offset:12288
    s_waitcnt lgkmcnt(3)
    v_mfma_f32_32x32x16_bf16 v[212:227], a[228:231], v[96:99], v[212:227]
    ds_read_b128 a[244:247], v3 offset:13312
    s_waitcnt lgkmcnt(3)
    v_mfma_f32_32x32x16_bf16 v[228:243], a[232:235], v[96:99], v[228:243]
    ds_read_b128 a[248:251], v3 offset:14336
    s_waitcnt lgkmcnt(3)
    v_mfma_f32_32x32x16_bf16 v[212:227], a[236:239], v[100:103], v[212:227]
    ds_read_b128 a[252:255], v3 offset:15360
    s_waitcnt lgkmcnt(3)
    v_mfma_f32_32x32x16_bf16 v[228:243], a[240:243], v[100:103], v[228:243]
    ds_read_b128 a[224:227], v3 offset:16384
    s_waitcnt lgkmcnt(3)
    v_mfma_f32_32x32x16_bf16 v[212:227], a[244:247], v[104:107], v[212:227]
    ds_read_b128 a[228:231], v3 offset:17408
    s_waitcnt lgkmcnt(3)
    v_mfma_f32_32x32x16_bf16 v[228:243], a[248:251], v[104:107], v[228:243]
    ds_read_b128 a[232:235], v3 offset:18432
    s_waitcnt lgkmcnt(3)
    v_mfma_f32_32x32x16_bf16 v[212:227], a[252:255], v[108:111], v[212:227]
    ds_read_b128 a[236:239], v3 offset:19456
    s_waitcnt lgkmcnt(3)
    v_mfma_f32_32x32x16_bf16 v[228:243], a[224:227], v[108:111], v[228:243]
    ds_read_b128 a[240:243], v3 offset:20480
    s_waitcnt lgkmcnt(3)
    v_mfma_f32_32x32x16_bf16 v[212:227], a[228:231], v[112:115], v[212:227]
    ds_read_b128 a[244:247], v3 offset:21504
    s_waitcnt lgkmcnt(3)
    v_mfma_f32_32x32x16_bf16 v[228:243], a[232:235], v[112:115], v[228:243]
    ds_read_b128 a[248:251], v3 offset:22528
    s_mov_b32 s38, 53248
    buffer_load_dword v13, v14, s[44:47], s38 offen sc1
    s_waitcnt lgkmcnt(3)
    v_mfma_f32_32x32x16_bf16 v[212:227], a[236:239], v[116:119], v[212:227]
    ds_read_b128 a[252:255], v3 offset:23552
    s_waitcnt lgkmcnt(3)
    v_mfma_f32_32x32x16_bf16 v[228:243], a[240:243], v[116:119], v[228:243]
    ds_read_b128 a[224:227], v3 offset:24576
    s_waitcnt lgkmcnt(3)
    v_mfma_f32_32x32x16_bf16 v[212:227], a[244:247], v[120:123], v[212:227]
    ds_read_b128 a[228:231], v3 offset:25600
    s_waitcnt lgkmcnt(3)
    v_mfma_f32_32x32x16_bf16 v[228:243], a[248:251], v[120:123], v[228:243]
    ds_read_b128 a[232:235], v3 offset:26624
    s_waitcnt lgkmcnt(3)
    v_mfma_f32_32x32x16_bf16 v[212:227], a[252:255], v[124:127], v[212:227]
    s_waitcnt lgkmcnt(2)
    v_mfma_f32_32x32x16_bf16 v[228:243], a[224:227], v[124:127], v[228:243]
    s_waitcnt lgkmcnt(1)
    v_mfma_f32_32x32x16_bf16 v[212:227], a[228:231], v[128:131], v[212:227]
    s_waitcnt lgkmcnt(0)
    v_mfma_f32_32x32x16_bf16 v[228:243], a[232:235], v[128:131], v[228:243]
    s_cmp_ge_u32 s51, 7
    s_cbranch_scc1 L_S1_nog2
    s_mul_i32 s7, s52, 112*1024
    s_mul_i32 s10, s3, 28*1024
    s_add_u32 s7, s7, s10
    s_add_u32 s7, s7, 11665408
    s_xor_b32 s9, s52, 1
    s_mul_i32 s9, s9, 112*1024
    s_add_u32 s9, s9, s10
    s_add_u32 s9, s9, 11665408
    s_mov_b32 s62, 0
L15_chk:
    s_waitcnt vmcnt(0)
    v_cmp_ne_u32 vcc, s42, v13
    s_add_u32 s62, s62, 1
    s_cmp_lt_u32 s62, 0x20000
    s_cselect_b64 s[64:65], vcc, 0
    s_cmp_eq_u64 s[64:65], 0
    s_cbranch_scc1 L15_ok
    s_sleep 1
    s_mov_b32 s38, 53248
    buffer_load_dword v13, v14, s[44:47], s38 offen sc1
    s_waitcnt vmcnt(0) lgkmcnt(0)
    s_branch L15_chk
L15_ok:
    s_add_u32 s63, s7, 0
    buffer_load_dwordx4 v[100:103], v1, s[44:47], s63 offen offset:0 sc1
    s_add_u32 s63, s9, 0
    buffer_load_dwordx4 v[104:107], v1, s[44:47], s63 offen offset:0 sc1
    s_add_u32 s63, s7, 0
    buffer_load_dwordx4 v[108:111], v1, s[44:47], s63 offen offset:1024 sc1
    s_add_u32 s63, s9, 0
    buffer_load_dwordx4 v[112:115], v1, s[44:47], s63 offen offset:1024 sc1
    s_add_u32 s63, s7, 0
    buffer_load_dwordx4 v[116:119], v1, s[44:47], s63 offen offset:2048 sc1
    s_add_u32 s63, s9, 0
    buffer_load_dwordx4 v[120:123], v1, s[44:47], s63 offen offset:2048 sc1
    v_max_f32 v212, 0, v212
    v_max_f32 v213, 0, v213
    v_max_f32 v214, 0, v214
    v_max_f32 v215, 0, v215
    v_max_f32 v216, 0, v216
    v_max_f32 v217, 0, v217
    v_max_f32 v218, 0, v218
    v_max_f32 v219, 0, v219
    v_mul_f32 v212, v212, v220
    v_mul_f32 v213, v213, v221
    v_mul_f32 v214, v214, v222
    v_mul_f32 v215, v215, v223
    v_mul_f32 v216, v216, v224
    v_mul_f32 v217, v217, v225
    v_mul_f32 v218, v218, v226
    v_mul_f32 v219, v219, v227
    v_cvt_pk_bf16_f32 v220, v212, v213
    v_cvt_pk_bf16_f32 v221, v214, v215
    v_cvt_pk_bf16_f32 v222, v216, v217
    v_cvt_pk_bf16_f32 v223, v218, v219
    buffer_store_dwordx4 v[220:223], v1, s[44:47], s14 offen offset:1024 sc1
    v_max_f32 v228, 0, v228
    v_max_f32 v229, 0, v229
    v_max_f32 v230, 0, v230
    v_max_f32 v231, 0, v231
    v_max_f32 v232, 0, v232
    v_max_f32 v233, 0, v233
    v_max_f32 v234, 0, v234
    v_max_f32 v235, 0, v235
    v_mul_f32 v228, v228, v236
    v_mul_f32 v229, v229, v237
    v_mul_f32 v230, v230, v238
    v_mul_f32 v231, v231, v239
    v_mul_f32 v232, v232, v240
    v_mul_f32 v233, v233, v241
    v_mul_f32 v234, v234, v242
    v_mul_f32 v235, v235, v243
    v_cvt_pk_bf16_f32 v236, v228, v229
    v_cvt_pk_bf16_f32 v237, v230, v231
    v_cvt_pk_bf16_f32 v238, v232, v233
    v_cvt_pk_bf16_f32 v239, v234, v235
    buffer_store_dwordx4 v[236:239], v1, s[44:47], s14 offen offset:2048 sc1
    s_add_u32 s63, s7, 4096
    buffer_load_dwordx4 v[124:127], v1, s[44:47], s63 offen offset:3072 sc1
    s_add_u32 s63, s9, 4096
    buffer_load_dwordx4 v[128:131], v1, s[44:47], s63 offen offset:3072 sc1
    s_waitcnt vmcnt(9)
    v_mfma_f32_32x32x16_bf16 v[16:31], a[0:3], v[100:103], 0
    s_add_u32 s63, s7, 8192
    buffer_load_dwordx4 v[132:135], v1, s[44:47], s63 offen offset:0 sc1
    v_mfma_f32_32x32x16_bf16 v[32:47], a[4:7], v[100:103], 0
    s_add_u32 s63, s9, 8192
    buffer_load_dwordx4 v[136:139], v1, s[44:47], s63 offen offset:0 sc1
    s_waitcnt vmcnt(10)
    v_mfma_f32_32x32x16_bf16 v[48:63], a[0:3], v[104:107], 0
    s_add_u32 s63, s7, 8192
    buffer_load_dwordx4 v[140:143], v1, s[44:47], s63 offen offset:1024 sc1
    v_mfma_f32_32x32x16_bf16 v[64:79], a[4:7], v[104:107], 0
    s_add_u32 s63, s9, 8192
    buffer_load_dwordx4 v[144:147], v1, s[44:47], s63 offen offset:1024 sc1
    s_waitcnt vmcnt(11)
    v_mfma_f32_32x32x16_bf16 v[16:31], a[8:11], v[108:111], v[16:31]
    s_add_u32 s63, s7, 12288
    buffer_load_dwordx4 v[148:151], v1, s[44:47], s63 offen offset:2048 sc1
    v_mfma_f32_32x32x16_bf16 v[32:47], a[12:15], v[108:111], v[32:47]
    s_add_u32 s63, s9, 12288
    buffer_load_dwordx4 v[152:155], v1, s[44:47], s63 offen offset:2048 sc1
    s_waitcnt vmcnt(12)
    v_mfma_f32_32x32x16_bf16 v[48:63], a[8:11], v[112:115], v[48:63]
    s_add_u32 s63, s7, 12288
    buffer_load_dwordx4 v[156:159], v1, s[44:47], s63 offen offset:3072 sc1
    v_mfma_f32_32x32x16_bf16 v[64:79], a[12:15], v[112:115], v[64:79]
    s_add_u32 s63, s9, 12288
    buffer_load_dwordx4 v[160:163], v1, s[44:47], s63 offen offset:3072 sc1
    s_waitcnt vmcnt(13)
    v_mfma_f32_32x32x16_bf16 v[16:31], a[16:19], v[116:119], v[16:31]
    s_add_u32 s63, s7, 16384
    buffer_load_dwordx4 v[164:167], v1, s[44:47], s63 offen offset:0 sc1
    v_mfma_f32_32x32x16_bf16 v[32:47], a[20:23], v[116:119], v[32:47]
    s_add_u32 s63, s9, 16384
    buffer_load_dwordx4 v[168:171], v1, s[44:47], s63 offen offset:0 sc1
    s_waitcnt vmcnt(14)
    v_mfma_f32_32x32x16_bf16 v[48:63], a[16:19], v[120:123], v[48:63]
    s_add_u32 s63, s7, 20480
    buffer_load_dwordx4 v[172:175], v1, s[44:47], s63 offen offset:1024 sc1
    v_mfma_f32_32x32x16_bf16 v[64:79], a[20:23], v[120:123], v[64:79]
    s_add_u32 s63, s9, 20480
    buffer_load_dwordx4 v[176:179], v1, s[44:47], s63 offen offset:1024 sc1
    s_waitcnt vmcnt(13)
    v_mfma_f32_32x32x16_bf16 v[16:31], a[56:59], v[124:127], v[16:31]
    s_add_u32 s63, s7, 20480
    buffer_load_dwordx4 v[180:183], v1, s[44:47], s63 offen offset:2048 sc1
    v_mfma_f32_32x32x16_bf16 v[32:47], a[60:63], v[124:127], v[32:47]
    s_add_u32 s63, s9, 20480
    buffer_load_dwordx4 v[184:187], v1, s[44:47], s63 offen offset:2048 sc1
    s_waitcnt vmcnt(14)
    v_mfma_f32_32x32x16_bf16 v[48:63], a[56:59], v[128:131], v[48:63]
    s_lshl_b32 s15, s48, 6
    s_lshl_b32 s61, s49, 2
    s_add_u32 s15, s15, s61
    s_add_u32 s15, s15, 57344
    s_mov_b64 exec, 1
    buffer_store_dword v15, v1, s[44:47], s15 offen sc1
    s_mov_b64 exec, -1
    s_add_u32 s63, s7, 20480
    buffer_load_dwordx4 v[188:191], v1, s[44:47], s63 offen offset:3072 sc1
    v_mfma_f32_32x32x16_bf16 v[64:79], a[60:63], v[128:131], v[64:79]
    s_add_u32 s63, s9, 20480
    buffer_load_dwordx4 v[192:195], v1, s[44:47], s63 offen offset:3072 sc1
    s_waitcnt vmcnt(16)
    v_mfma_f32_32x32x16_bf16 v[16:31], a[64:67], v[132:135], v[16:31]
    s_add_u32 s63, s7, 0
    buffer_load_dwordx4 v[196:199], v1, s[44:47], s63 offen offset:3072 sc1
    v_mfma_f32_32x32x16_bf16 v[32:47], a[68:71], v[132:135], v[32:47]
    s_add_u32 s63, s9, 0
    buffer_load_dwordx4 v[200:203], v1, s[44:47], s63 offen offset:3072 sc1
    s_waitcnt vmcnt(17)
    v_mfma_f32_32x32x16_bf16 v[48:63], a[64:67], v[136:139], v[48:63]
    s_add_u32 s63, s7, 4096
    buffer_load_dwordx4 v[204:207], v1, s[44:47], s63 offen offset:0 sc1
    v_mfma_f32_32x32x16_bf16 v[64:79], a[68:71], v[136:139], v[64:79]
    s_add_u32 s63, s9, 4096
    buffer_load_dwordx4 v[208:211], v1, s[44:47], s63 offen offset:0 sc1
    s_waitcnt vmcnt(18)
    v_mfma_f32_32x32x16_bf16 v[16:31], a[72:75], v[140:143], v[16:31]
    s_add_u32 s63, s7, 8192
    buffer_load_dwordx4 v[212:215], v1, s[44:47], s63 offen offset:2048 sc1
    v_mfma_f32_32x32x16_bf16 v[32:47], a[76:79], v[140:143], v[32:47]
    s_add_u32 s63, s9, 8192
    buffer_load_dwordx4 v[216:219], v1, s[44:47], s63 offen offset:2048 sc1
    s_waitcnt vmcnt(19)
    v_mfma_f32_32x32x16_bf16 v[48:63], a[72:75], v[144:147], v[48:63]
    s_add_u32 s63, s7, 8192
    buffer_load_dwordx4 v[220:223], v1, s[44:47], s63 offen offset:3072 sc1
    v_mfma_f32_32x32x16_bf16 v[64:79], a[76:79], v[144:147], v[64:79]
    s_add_u32 s63, s9, 8192
    buffer_load_dwordx4 v[224:227], v1, s[44:47], s63 offen offset:3072 sc1
    s_waitcnt vmcnt(20)
    v_mfma_f32_32x32x16_bf16 v[16:31], a[112:115], v[148:151], v[16:31]
    s_add_u32 s63, s7, 16384
    buffer_load_dwordx4 v[228:231], v1, s[44:47], s63 offen offset:1024 sc1
    v_mfma_f32_32x32x16_bf16 v[32:47], a[116:119], v[148:151], v[32:47]
    s_add_u32 s63, s9, 16384
    buffer_load_dwordx4 v[232:235], v1, s[44:47], s63 offen offset:1024 sc1
    s_waitcnt vmcnt(21)
    v_mfma_f32_32x32x16_bf16 v[48:63], a[112:115], v[152:155], v[48:63]
    s_mov_b32 s38, 57344
    buffer_load_dword v13, v14, s[44:47], s38 offen sc1
    v_mfma_f32_32x32x16_bf16 v[64:79], a[116:119], v[152:155], v[64:79]
    s_waitcnt vmcnt(21)
    v_mfma_f32_32x32x16_bf16 v[16:31], a[120:123], v[156:159], v[16:31]
    s_add_u32 s63, s7, 16384
    buffer_load_dwordx4 v[236:239], v1, s[44:47], s63 offen offset:2048 sc1
    v_mfma_f32_32x32x16_bf16 v[32:47], a[124:127], v[156:159], v[32:47]
    s_add_u32 s63, s9, 16384
    buffer_load_dwordx4 v[240:243], v1, s[44:47], s63 offen offset:2048 sc1
    s_waitcnt vmcnt(22)
    v_mfma_f32_32x32x16_bf16 v[48:63], a[120:123], v[160:163], v[48:63]
    v_mfma_f32_32x32x16_bf16 v[64:79], a[124:127], v[160:163], v[64:79]
    s_waitcnt vmcnt(21)
    v_mfma_f32_32x32x16_bf16 v[16:31], a[128:131], v[164:167], v[16:31]
    s_add_u32 s63, s7, 24576
    buffer_load_dwordx4 v[244:247], v1, s[44:47], s63 offen offset:0 sc1
    v_mfma_f32_32x32x16_bf16 v[32:47], a[132:135], v[164:167], v[32:47]
    s_add_u32 s63, s9, 24576
    buffer_load_dwordx4 v[248:251], v1, s[44:47], s63 offen offset:0 sc1
    s_waitcnt vmcnt(22)
    v_mfma_f32_32x32x16_bf16 v[48:63], a[128:131], v[168:171], v[48:63]
    v_mfma_f32_32x32x16_bf16 v[64:79], a[132:135], v[168:171], v[64:79]
    s_waitcnt vmcnt(21)
    v_mfma_f32_32x32x16_bf16 v[16:31], a[168:171], v[172:175], v[16:31]
    s_add_u32 s63, s7, 24576
    buffer_load_dwordx4 v[100:103], v1, s[44:47], s63 offen offset:1024 sc1
    v_mfma_f32_32x32x16_bf16 v[32:47], a[172:175], v[172:175], v[32:47]
    s_add_u32 s63, s9, 24576
    buffer_load_dwordx4 v[104:107], v1, s[44:47], s63 offen offset:1024 sc1
    s_waitcnt vmcnt(22)
    v_mfma_f32_32x32x16_bf16 v[48:63], a[168:171], v[176:179], v[48:63]
    s_mov_b32 s62, 0
L16_chk:
    s_waitcnt vmcnt(6)
    v_cmp_ne_u32 vcc, s42, v13
    s_add_u32 s62, s62, 1
    s_cmp_lt_u32 s62, 0x20000
    s_cselect_b64 s[64:65], vcc, 0
    s_cmp_eq_u64 s[64:65], 0
    s_cbranch_scc1 L16_ok
    s_sleep 1
    s_mov_b32 s38, 57344
    buffer_load_dword v13, v14, s[44:47], s38 offen sc1
    s_waitcnt vmcnt(0) lgkmcnt(0)
    s_branch L16_chk
L16_ok:
    v_mfma_f32_32x32x16_bf16 v[64:79], a[172:175], v[176:179], v[64:79]
    v_mfma_f32_32x32x16_bf16 v[16:31], a[176:179], v[180:183], v[16:31]
    s_add_u32 s63, s7, 4096
    buffer_load_dwordx4 v[108:111], v1, s[44:47], s63 offen offset:1024 sc1
    v_mfma_f32_32x32x16_bf16 v[32:47], a[180:183], v[180:183], v[32:47]
    s_add_u32 s63, s9, 4096
    buffer_load_dwordx4 v[112:115], v1, s[44:47], s63 offen offset:1024 sc1
    v_mfma_f32_32x32x16_bf16 v[48:63], a[176:179], v[184:187], v[48:63]
    v_mfma_f32_32x32x16_bf16 v[64:79], a[180:183], v[184:187], v[64:79]
    v_mfma_f32_32x32x16_bf16 v[16:31], a[184:187], v[188:191], v[16:31]
    s_add_u32 s63, s7, 4096
    buffer_load_dwordx4 v[116:119], v1, s[44:47], s63 offen offset:2048 sc1
    v_mfma_f32_32x32x16_bf16 v[32:47], a[188:191], v[188:191], v[32:47]
    s_add_u32 s63, s9, 4096
    buffer_load_dwordx4 v[120:123], v1, s[44:47], s63 offen offset:2048 sc1
    v_mfma_f32_32x32x16_bf16 v[48:63], a[184:187], v[192:195], v[48:63]
    v_mfma_f32_32x32x16_bf16 v[64:79], a[188:191], v[192:195], v[64:79]
    v_mfma_f32_32x32x16_bf16 v[16:31], a[24:27], v[196:199], v[16:31]
    s_add_u32 s63, s7, 12288
    buffer_load_dwordx4 v[124:127], v1, s[44:47], s63 offen offset:0 sc1
    v_mfma_f32_32x32x16_bf16 v[32:47], a[28:31], v[196:199], v[32:47]
    s_add_u32 s63, s9, 12288
    buffer_load_dwordx4 v[128:131], v1, s[44:47], s63 offen offset:0 sc1
    v_mfma_f32_32x32x16_bf16 v[48:63], a[24:27], v[200:203], v[48:63]
    v_mfma_f32_32x32x16_bf16 v[64:79], a[28:31], v[200:203], v[64:79]
    v_mfma_f32_32x32x16_bf16 v[16:31], a[32:35], v[204:207], v[16:31]
    s_add_u32 s63, s7, 12288
    buffer_load_dwordx4 v[132:135], v1, s[44:47], s63 offen offset:1024 sc1
    v_mfma_f32_32x32x16_bf16 v[32:47], a[36:39], v[204:207], v[32:47]
    s_add_u32 s63, s9, 12288
    buffer_load_dwordx4 v[136:139], v1, s[44:47], s63 offen offset:1024 sc1
    v_mfma_f32_32x32x16_bf16 v[48:63], a[32:35], v[208:211], v[48:63]
    v_mfma_f32_32x32x16_bf16 v[64:79], a[36:39], v[208:211], v[64:79]
    s_barrier
    v_mfma_f32_32x32x16_bf16 v[16:31], a[80:83], v[212:215], v[16:31]
    s_add_u32 s63, s7, 16384
    buffer_load_dwordx4 v[140:143], v1, s[44:47], s63 offen offset:3072 sc1
    v_mfma_f32_32x32x16_bf16 v[32:47], a[84:87], v[212:215], v[32:47]
    s_add_u32 s63, s9, 16384
    buffer_load_dwordx4 v[144:147], v1, s[44:47], s63 offen offset:3072 sc1
    v_mfma_f32_32x32x16_bf16 v[48:63], a[80:83], v[216:219], v[48:63]
    v_mfma_f32_32x32x16_bf16 v[64:79], a[84:87], v[216:219], v[64:79]
    v_mfma_f32_32x32x16_bf16 v[16:31], a[88:91], v[220:223], v[16:31]
    s_add_u32 s63, s7, 20480
    buffer_load_dwordx4 v[148:151], v1, s[44:47], s63 offen offset:0 sc1
    v_mfma_f32_32x32x16_bf16 v[32:47], a[92:95], v[220:223], v[32:47]
    s_add_u32 s63, s9, 20480
    buffer_load_dwordx4 v[152:155], v1, s[44:47], s63 offen offset:0 sc1
    v_mfma_f32_32x32x16_bf16 v[48:63], a[88:91], v[224:227], v[48:63]
    v_mfma_f32_32x32x16_bf16 v[64:79], a[92:95], v[224:227], v[64:79]
    v_mfma_f32_32x32x16_bf16 v[16:31], a[136:139], v[228:231], v[16:31]
    s_add_u32 s63, s7, 24576
    buffer_load_dwordx4 v[156:159], v1, s[44:47], s63 offen offset:2048 sc1
    v_mfma_f32_32x32x16_bf16 v[32:47], a[140:143], v[228:231], v[32:47]
    s_add_u32 s63, s9, 24576
    buffer_load_dwordx4 v[160:163], v1, s[44:47], s63 offen offset:2048 sc1
    v_mfma_f32_32x32x16_bf16 v[48:63], a[136:139], v[232:235], v[48:63]
    v_mfma_f32_32x32x16_bf16 v[64:79], a[140:143], v[232:235], v[64:79]
    s_waitcnt vmcnt(19)
    v_mfma_f32_32x32x16_bf16 v[16:31], a[144:147], v[236:239], v[16:31]
    s_add_u32 s63, s7, 24576
    buffer_load_dwordx4 v[164:167], v1, s[44:47], s63 offen offset:3072 sc1
    v_mfma_f32_32x32x16_bf16 v[32:47], a[148:151], v[236:239], v[32:47]
    s_add_u32 s63, s9, 24576
    buffer_load_dwordx4 v[168:171], v1, s[44:47], s63 offen offset:3072 sc1
    s_waitcnt vmcnt(20)
    v_mfma_f32_32x32x16_bf16 v[48:63], a[144:147], v[240:243], v[48:63]
    v_mfma_f32_32x32x16_bf16 v[64:79], a[148:151], v[240:243], v[64:79]
    s_waitcnt vmcnt(19)
    v_mfma_f32_32x32x16_bf16 v[16:31], a[192:195], v[244:247], v[16:31]
    s_add_u32 s10, s54, 4849664
    buffer_load_dwordx4 v[80:83], v12, s[44:47], s10 offen sc1
    buffer_load_dwordx4 v[84:87], v12, s[44:47], s10 offen offset:256 sc1
    v_lshrrev_b32 v6, 1, v8
    s_lshl_b32 s15, s52, 7
    s_add_u32 s15, s15, 65536
    buffer_load_dword v96, v6, s[44:47], s15 offen sc1
    v_mfma_f32_32x32x16_bf16 v[32:47], a[196:199], v[244:247], v[32:47]
    s_waitcnt vmcnt(21)
    v_mfma_f32_32x32x16_bf16 v[48:63], a[192:195], v[248:251], v[48:63]
    v_mfma_f32_32x32x16_bf16 v[64:79], a[196:199], v[248:251], v[64:79]
    s_waitcnt vmcnt(20)
    v_mfma_f32_32x32x16_bf16 v[16:31], a[200:203], v[100:103], v[16:31]
    v_mfma_f32_32x32x16_bf16 v[32:47], a[204:207], v[100:103], v[32:47]
    s_waitcnt vmcnt(19)
    v_mfma_f32_32x32x16_bf16 v[48:63], a[200:203], v[104:107], v[48:63]
    v_mfma_f32_32x32x16_bf16 v[64:79], a[204:207], v[104:107], v[64:79]
    s_waitcnt vmcnt(18)
    v_mfma_f32_32x32x16_bf16 v[16:31], a[40:43], v[108:111], v[16:31]
    v_mfma_f32_32x32x16_bf16 v[32:47], a[44:47], v[108:111], v[32:47]
    s_waitcnt vmcnt(17)
    v_mfma_f32_32x32x16_bf16 v[48:63], a[40:43], v[112:115], v[48:63]
    v_mfma_f32_32x32x16_bf16 v[64:79], a[44:47], v[112:115], v[64:79]
    s_waitcnt vmcnt(16)
    v_mfma_f32_32x32x16_bf16 v[16:31], a[48:51], v[116:119], v[16:31]
    v_mfma_f32_32x32x16_bf16 v[32:47], a[52:55], v[116:119], v[32:47]
    s_waitcnt vmcnt(15)
    v_mfma_f32_32x32x16_bf16 v[48:63], a[48:51], v[120:123], v[48:63]
    v_mfma_f32_32x32x16_bf16 v[64:79], a[52:55], v[120:123], v[64:79]
    s_waitcnt vmcnt(14)
    v_mfma_f32_32x32x16_bf16 v[16:31], a[96:99], v[124:127], v[16:31]
    v_mfma_f32_32x32x16_bf16 v[32:47], a[100:103], v[124:127], v[32:47]
    s_waitcnt vmcnt(13)
    v_mfma_f32_32x32x16_bf16 v[48:63], a[96:99], v[128:131], v[48:63]
    v_mfma_f32_32x32x16_bf16 v[64:79], a[100:103], v[128:131], v[64:79]
    s_waitcnt vmcnt(12)
    v_mfma_f32_32x32x16_bf16 v[16:31], a[104:107], v[132:135], v[16:31]
    v_mfma_f32_32x32x16_bf16 v[32:47], a[108:111], v[132:135], v[32:47]
    s_waitcnt vmcnt(11)
    v_mfma_f32_32x32x16_bf16 v[48:63], a[104:107], v[136:139], v[48:63]
    v_mfma_f32_32x32x16_bf16 v[64:79], a[108:111], v[136:139], v[64:79]
    s_waitcnt vmcnt(10)
    v_mfma_f32_32x32x16_bf16 v[16:31], a[152:155], v[140:143], v[16:31]
    v_mfma_f32_32x32x16_bf16 v[32:47], a[156:159], v[140:143], v[32:47]
    s_waitcnt vmcnt(9)
    v_mfma_f32_32x32x16_bf16 v[48:63], a[152:155], v[144:147], v[48:63]
    v_mfma_f32_32x32x16_bf16 v[64:79], a[156:159], v[144:147], v[64:79]
    s_waitcnt vmcnt(8)
    v_mfma_f32_32x32x16_bf16 v[32:47], a[164:167], v[148:151], v[32:47]
    s_waitcnt vmcnt(7)
    v_mfma_f32_32x32x16_bf16 v[48:63], a[160:163], v[152:155], v[48:63]
    v_mfma_f32_32x32x16_bf16 v[64:79], a[164:167], v[152:155], v[64:79]
    s_waitcnt vmcnt(6)
    v_mfma_f32_32x32x16_bf16 v[32:47], a[212:215], v[156:159], v[32:47]
    s_waitcnt vmcnt(5)
    v_mfma_f32_32x32x16_bf16 v[48:63], a[208:211], v[160:163], v[48:63]
    v_mfma_f32_32x32x16_bf16 v[64:79], a[212:215], v[160:163], v[64:79]
    s_waitcnt vmcnt(4)
    v_mfma_f32_32x32x16_bf16 v[32:47], a[220:223], v[164:167], v[32:47]
    s_waitcnt vmcnt(3)
    v_mfma_f32_32x32x16_bf16 v[48:63], a[216:219], v[168:171], v[48:63]
    v_mfma_f32_32x32x16_bf16 v[64:79], a[220:223], v[168:171], v[64:79]
    s_xor_b32 s10, s3, 1
    s_mul_i32 s10, s10, 12288
    s_add_u32 s10, s10, 114688
    v_add_u32 v4, s10, v1
    s_xor_b32 s10, s3, 2
    s_mul_i32 s10, s10, 12288
    s_add_u32 s10, s10, 118784
    v_add_u32 v5, s10, v1
    s_xor_b32 s10, s3, 3
    s_mul_i32 s10, s10, 12288
    s_add_u32 s10, s10, 122880
    v_add_u32 v6, s10, v1
    v_mfma_f32_32x32x16_bf16 v[16:31], a[160:163], v[148:151], v[16:31]
    ds_write_b128 v4, v[32:35] offset:0
    ds_write_b128 v4, v[36:39] offset:1024
    ds_write_b128 v4, v[40:43] offset:2048
    ds_write_b128 v4, v[44:47] offset:3072
    v_mfma_f32_32x32x16_bf16 v[16:31], a[208:211], v[156:159], v[16:31]
    ds_write_b128 v5, v[48:51] offset:0
    ds_write_b128 v5, v[52:55] offset:1024
    ds_write_b128 v5, v[56:59] offset:2048
    ds_write_b128 v5, v[60:63] offset:3072
    v_mfma_f32_32x32x16_bf16 v[16:31], a[216:219], v[164:167], v[16:31]
    ds_write_b128 v6, v[64:67] offset:0
    ds_write_b128 v6, v[68:71] offset:1024
    ds_write_b128 v6, v[72:75] offset:2048
    ds_write_b128 v6, v[76:79] offset:3072
    s_mul_i32 s10, s3, 12288
    s_add_u32 s10, s10, 114688
    v_add_u32 v7, s10, v1
    s_waitcnt lgkmcnt(0)
    s_barrier
    ds_read_b128 v[100:103], v7 offset:0
    ds_read_b128 v[104:107], v7 offset:1024
    ds_read_b128 v[108:111], v7 offset:2048
    ds_read_b128 v[112:115], v7 offset:3072
    ds_read_b128 v[116:119], v7 offset:4096
    ds_read_b128 v[120:123], v7 offset:5120
    ds_read_b128 v[124:127], v7 offset:6144
    ds_read_b128 v[128:131], v7 offset:7168
    ds_read_b128 v[132:135], v7 offset:8192
    ds_read_b128 v[136:139], v7 offset:9216
    ds_read_b128 v[140:143], v7 offset:10240
    ds_read_b128 v[144:147], v7 offset:11264
    s_waitcnt vmcnt(2)
    v_lshlrev_b32 v32, 16, v80
    v_and_b32 v33, s57, v80
    v_lshlrev_b32 v34, 16, v81
    v_and_b32 v35, s57, v81
    v_lshlrev_b32 v36, 16, v82
    v_and_b32 v37, s57, v82
    v_lshlrev_b32 v38, 16, v83
    v_and_b32 v39, s57, v83
    s_waitcnt vmcnt(1)
    v_lshlrev_b32 v40, 16, v84
    v_and_b32 v41, s57, v84
    v_lshlrev_b32 v42, 16, v85
    v_and_b32 v43, s57, v85
    v_lshlrev_b32 v44, 16, v86
    v_and_b32 v45, s57, v86
    v_lshlrev_b32 v46, 16, v87
    v_and_b32 v47, s57, v87
    s_waitcnt lgkmcnt(11)
    v_pk_add_f32 v[16:17], v[16:17], v[100:101]
    v_pk_add_f32 v[18:19], v[18:19], v[102:103]
    s_waitcnt lgkmcnt(10)
    v_pk_add_f32 v[20:21], v[20:21], v[104:105]
    v_pk_add_f32 v[22:23], v[22:23], v[106:107]
    s_waitcnt lgkmcnt(9)
    v_pk_add_f32 v[24:25], v[24:25], v[108:109]
    v_pk_add_f32 v[26:27], v[26:27], v[110:111]
    s_waitcnt lgkmcnt(8)
    v_pk_add_f32 v[28:29], v[28:29], v[112:113]
    v_pk_add_f32 v[30:31], v[30:31], v[114:115]
    s_waitcnt lgkmcnt(7)
    v_pk_add_f32 v[16:17], v[16:17], v[116:117]
    v_pk_add_f32 v[18:19], v[18:19], v[118:119]
    s_waitcnt lgkmcnt(6)
    v_pk_add_f32 v[20:21], v[20:21], v[120:121]
    v_pk_add_f32 v[22:23], v[22:23], v[122:123]
    s_waitcnt lgkmcnt(5)
    v_pk_add_f32 v[24:25], v[24:25], v[124:125]
    v_pk_add_f32 v[26:27], v[26:27], v[126:127]
    s_waitcnt lgkmcnt(4)
    v_pk_add_f32 v[28:29], v[28:29], v[128:129]
    v_pk_add_f32 v[30:31], v[30:31], v[130:131]
    s_waitcnt lgkmcnt(3)
    v_pk_add_f32 v[16:17], v[16:17], v[132:133]
    v_pk_add_f32 v[18:19], v[18:19], v[134:135]
    s_waitcnt lgkmcnt(2)
    v_pk_add_f32 v[20:21], v[20:21], v[136:137]
    v_pk_add_f32 v[22:23], v[22:23], v[138:139]
    s_waitcnt lgkmcnt(1)
    v_pk_add_f32 v[24:25], v[24:25], v[140:141]
    v_pk_add_f32 v[26:27], v[26:27], v[142:143]
    s_waitcnt lgkmcnt(0)
    v_pk_add_f32 v[28:29], v[28:29], v[144:145]
    v_pk_add_f32 v[30:31], v[30:31], v[146:147]
    s_waitcnt vmcnt(0)
    v_fmac_f32 v32, v96, v16
    v_fmac_f32 v33, v96, v17
    v_fmac_f32 v34, v96, v18
    v_fmac_f32 v35, v96, v19
    v_fmac_f32 v36, v96, v20
    v_fmac_f32 v37, v96, v21
    v_fmac_f32 v38, v96, v22
    v_fmac_f32 v39, v96, v23
    v_fmac_f32 v40, v96, v24
    v_fmac_f32 v41, v96, v25
    v_fmac_f32 v42, v96, v26
    v_fmac_f32 v43, v96, v27
    v_fmac_f32 v44, v96, v28
    v_fmac_f32 v45, v96, v29
    v_fmac_f32 v46, v96, v30
    v_fmac_f32 v47, v96, v31
    v_cvt_pk_bf16_f32 v80, v32, v33
    v_cvt_pk_bf16_f32 v81, v34, v35
    v_cvt_pk_bf16_f32 v82, v36, v37
    v_cvt_pk_bf16_f32 v83, v38, v39
    v_cvt_pk_bf16_f32 v84, v40, v41
    v_cvt_pk_bf16_f32 v85, v42, v43
    v_cvt_pk_bf16_f32 v86, v44, v45
    v_cvt_pk_bf16_f32 v87, v46, v47
    s_lshl_b32 s10, s52, 5
    v_and_b32 v6, 31, v0
    v_add_u32 v6, s10, v6
    v_mul_u32_u24 v6, 896, v6
    v_lshrrev_b32 v7, 5, v0
    v_lshl_add_u32 v6, v7, 4, v6
    s_lshl_b32 s10, s53, 6
    buffer_store_dwordx4 v[80:83], v6, s[68:71], s10 offen
    buffer_store_dwordx4 v[84:87], v6, s[68:71], s10 offen offset:32
    s_endpgm
L_S1_nog2:
    s_nop 7
    v_max_f32 v212, 0, v212
    v_max_f32 v213, 0, v213
    v_max_f32 v214, 0, v214
    v_max_f32 v215, 0, v215
    v_max_f32 v216, 0, v216
    v_max_f32 v217, 0, v217
    v_max_f32 v218, 0, v218
    v_max_f32 v219, 0, v219
    v_mul_f32 v212, v212, v220
    v_mul_f32 v213, v213, v221
    v_mul_f32 v214, v214, v222
    v_mul_f32 v215, v215, v223
    v_mul_f32 v216, v216, v224
    v_mul_f32 v217, v217, v225
    v_mul_f32 v218, v218, v226
    v_mul_f32 v219, v219, v227
    v_cvt_pk_bf16_f32 v220, v212, v213
    v_cvt_pk_bf16_f32 v221, v214, v215
    v_cvt_pk_bf16_f32 v222, v216, v217
    v_cvt_pk_bf16_f32 v223, v218, v219
    buffer_store_dwordx4 v[220:223], v1, s[44:47], s14 offen offset:1024 sc1
    v_max_f32 v228, 0, v228
    v_max_f32 v229, 0, v229
    v_max_f32 v230, 0, v230
    v_max_f32 v231, 0, v231
    v_max_f32 v232, 0, v232
    v_max_f32 v233, 0, v233
    v_max_f32 v234, 0, v234
    v_max_f32 v235, 0, v235
    v_mul_f32 v228, v228, v236
    v_mul_f32 v229, v229, v237
    v_mul_f32 v230, v230, v238
    v_mul_f32 v231, v231, v239
    v_mul_f32 v232, v232, v240
    v_mul_f32 v233, v233, v241
    v_mul_f32 v234, v234, v242
    v_mul_f32 v235, v235, v243
    v_cvt_pk_bf16_f32 v236, v228, v229
    v_cvt_pk_bf16_f32 v237, v230, v231
    v_cvt_pk_bf16_f32 v238, v232, v233
    v_cvt_pk_bf16_f32 v239, v234, v235
    buffer_store_dwordx4 v[236:239], v1, s[44:47], s14 offen offset:2048 sc1
    s_lshl_b32 s15, s48, 6
    s_lshl_b32 s61, s49, 2
    s_add_u32 s15, s15, s61
    s_add_u32 s15, s15, 57344
    s_waitcnt vmcnt(0)
    s_mov_b64 exec, 1
    buffer_store_dword v15, v1, s[44:47], s15 offen sc1
    s_mov_b64 exec, -1
    s_endpgm
L_end2:
    s_endpgm

.section .rodata,"a"
.p2align 6
.amdhsa_kernel prep_kernel
  .amdhsa_next_free_vgpr 256
  .amdhsa_next_free_sgpr 102
  .amdhsa_accum_offset 256
  .amdhsa_group_segment_fixed_size 0
  .amdhsa_kernarg_size 104
  .amdhsa_user_sgpr_count 2
  .amdhsa_user_sgpr_kernarg_segment_ptr 1
  .amdhsa_system_sgpr_workgroup_id_x 1
  .amdhsa_float_denorm_mode_32 3
.end_amdhsa_kernel
.p2align 6
.amdhsa_kernel main_kernel
  .amdhsa_next_free_vgpr 512
  .amdhsa_next_free_sgpr 102
  .amdhsa_accum_offset 256
  .amdhsa_group_segment_fixed_size 0
  .amdhsa_kernarg_size 104
  .amdhsa_user_sgpr_count 2
  .amdhsa_user_sgpr_kernarg_segment_ptr 1
  .amdhsa_system_sgpr_workgroup_id_x 1
  .amdhsa_float_denorm_mode_32 3
.end_amdhsa_kernel
```
